```python
import torch

def _softmax(x, axis=-1):
    return torch.softmax(x, dim=axis)

def _gelu(x):
    return torch.nn.functional.gelu(x, approximate='tanh')

def _silu(x):
    return torch.nn.functional.silu(x)

def _sigmoid(x):
    return torch.sigmoid(x)

def _layernorm(x, axis=-1, eps=1e-05):
    m = x.mean(dim=axis, keepdim=True)
    v = x.var(dim=axis, keepdim=True, unbiased=False)
    return (x - m) / torch.sqrt(v + eps)

def _scatter_add(tgt, idx, src, axis=0):
    return tgt.clone().index_add_(axis, idx, src)

def _segment_sum(src, seg, n):
    out = torch.zeros((n,) + src.shape[1:], dtype=src.dtype)
    return out.index_add_(0, seg, src)

def _pad(x, pw):
    flat = tuple((v for pair in reversed(pw) for v in pair))
    return torch.nn.functional.pad(x, flat)
kernel_name = 'adaLN_cond__mha_block__moe_arch_mod__prompt'

def setup_inputs():

    _w = lambda a: (lambda t: t.to(torch.bfloat16) if t.is_floating_point() else t)(torch.as_tensor(a))

    def _A_setup():
        B, S, D, H = (1, 2048, 1024, 32)
        return {'x': _w((lambda *s: torch.randn(*s, dtype=torch.bfloat16) * 0.05)(B, S, D)), 'wqkv': _w((lambda *s: torch.randn(*s, dtype=torch.bfloat16) * 0.05)(D, 3 * D)), 'wo': _w((lambda *s: torch.randn(*s, dtype=torch.bfloat16) * 0.05)(D, D))}
    _A_in = _A_setup()

    def _B_setup():
        B, S, D, F, C = (1, 2048, 1024, 3584, 1)
        return {'x': _w((lambda *s: torch.randn(*s, dtype=torch.bfloat16) * 0.05)(B, S, D)), 'w_r': _w((lambda *s: torch.randn(*s, dtype=torch.bfloat16) * 0.05)(D)), 'w_gate': _w((lambda *s: torch.randn(*s, dtype=torch.bfloat16) * 0.05)(D, F)), 'w_up': _w((lambda *s: torch.randn(*s, dtype=torch.bfloat16) * 0.05)(D, F)), 'w_down': _w((lambda *s: torch.randn(*s, dtype=torch.bfloat16) * 0.05)(F, D))}
    _B_in = _B_setup()
    return {'A_x': _A_in['x'], 'A_wqkv': _A_in['wqkv'], 'A_wo': _A_in['wo'], 'B_x': _B_in['x'], 'B_w_r': _B_in['w_r'], 'B_w_gate': _B_in['w_gate'], 'B_w_up': _B_in['w_up'], 'B_w_down': _B_in['w_down'], 'c': _w((lambda *s: torch.randn(*s, dtype=torch.bfloat16) * 0.1)(1, 1024) * 8.0), 'w_mod': _w((lambda *s: torch.randn(*s, dtype=torch.bfloat16) * 0.1)(1024, 6 * 1024) * 1024 ** (-0.5) * 8.0)}

def reference(A_x, A_wqkv, A_wo, B_x, B_w_r, B_w_gate, B_w_up, B_w_down, c, w_mod):

    def _A_ref(x, wqkv, wo):
        B, S, D = x.shape
        H = 32
        Dh = D // H
        qkv = (lambda x, *d: x.permute(*d))((x @ wqkv).reshape(B, S, 3, H, Dh), 2, 0, 3, 1, 4)
        q, k, v = (qkv[0], qkv[1], qkv[2])
        scores = torch.einsum('bhqd,bhkd->bhqk', q, k) * Dh ** (-0.5)
        p = _softmax(scores, axis=-1)
        o = torch.einsum('bhqk,bhkd->bhqd', p, v)
        return (lambda x, *d: x.permute(*d))(o, 0, 2, 1, 3).reshape(B, S, D) @ wo

    def _B_ref(x, w_r, w_gate, w_up, w_down):
        B, S, D = x.shape
        C = 1
        r = x @ w_r
        idx = torch.argsort(-r, axis=-1)[:, :C]
        idx_e = (lambda x, n, axis: torch.repeat_interleave(x, n, dim=axis))(idx.reshape(B, C, 1), D, axis=2)
        x_sel = (lambda x, i, axis: torch.take_along_dim(x, i, dim=axis))(x, idx_e, axis=1)
        g = _silu(x_sel @ w_gate)
        u = x_sel @ w_up
        y = g * u @ w_down
        r_sel = _sigmoid((lambda x, i, axis: torch.take_along_dim(x, i, dim=axis))(r, idx, axis=1))
        y = y * r_sel.reshape(B, C, 1)
        b_off = (torch.arange(B) * S).reshape(B, 1)
        flat_idx = (idx + b_off).reshape(B * C)
        zero = (x * 0.0).reshape(B * S, D)
        upd = _scatter_add(zero, flat_idx, y.reshape(B * C, D), axis=0)
        return x + upd.reshape(B, S, D)
    x = A_x
    mod = (_silu(c) @ w_mod).reshape(c.shape[0], 6, 1, -1)
    sa, ca, ga, sb, cb, gb = (mod[:, 0].clone(), mod[:, 1].clone(), mod[:, 2].clone(), mod[:, 3].clone(), mod[:, 4].clone(), mod[:, 5].clone())
    h = _layernorm(x, axis=-1) * (1 + ca) + sa
    x = x + ga * _A_ref(h, A_wqkv, A_wo)
    h = _layernorm(x, axis=-1) * (1 + cb) + sb
    x = x + gb * _B_ref(h, B_w_r, B_w_gate, B_w_up, B_w_down)
    return x
```

```asm
; @launch kernel=qkv_kernel grid=(256,1,1) block=(512,1,1) lds=163840
.amdgcn_target "amdgcn-amd-amdhsa--gfx950"
.text
.globl qkv_kernel
.p2align 8
.type qkv_kernel,@function
qkv_kernel:
    s_cmp_ge_u32 s2, 256
    s_cbranch_scc1 qkv_kernel_end

    s_load_dwordx2 s[4:5], s[0:1], 64
    s_load_dwordx2 s[6:7], s[0:1], 72
    s_load_dwordx2 s[8:9], s[0:1], 88
    s_load_dwordx2 s[10:11], s[0:1], 96
    s_load_dwordx4 s[36:39], s[0:1], 0
    s_memrealtime s[56:57]
    v_lshrrev_b32 v1, 6, v0
    v_and_b32 v2, 63, v0
    v_lshlrev_b32 v5, 4, v2
    v_readfirstlane_b32 s18, v1
    s_and_b32 s20, s2, 7
    s_lshr_b32 s21, s2, 3
    s_lshr_b32 s22, s21, 3
    s_lshl_b32 s22, s22, 3
    s_and_b32 s23, s20, 7
    s_add_u32 s16, s22, s23
    s_and_b32 s17, s21, 7
    s_lshr_b32 s23, s20, 3
    s_lshl_b32 s23, s23, 3
    s_add_u32 s17, s17, s23
    s_lshl_b32 s22, s20, 7
    v_lshrrev_b32 v3, 2, v2
    v_and_b32 v3, 7, v3
    v_lshl_add_u32 v3, v1, 5, v3
    v_add_u32 v3, s22, v3
    s_mov_b32 s22, 12288
    v_mul_lo_u32 v7, v3, s22
    v_lshrrev_b32 v4, 5, v2
    v_lshl_add_u32 v7, v4, 11, v7
    v_and_b32 v4, 3, v2
    v_lshl_add_u32 v7, v4, 4, v7
    v_lshlrev_b32 v6, 1, v3
    s_lshl_b32 s23, s21, 6
    s_add_u32 s24, s23, 98304
    s_add_u32 s25, s23, 196608
    s_add_u32 s26, s23, 294912
    s_mov_b32 s70, 262144
    v_mov_b32 v19, 150528
    v_mov_b32 v10, 0
    v_mov_b32 v11, 0
    s_waitcnt lgkmcnt(0)

    s_getreg_b32 s71, hwreg(HW_REG_XCC_ID, 0, 4)
    s_add_u32 s71, s71, 1
    s_lshl_b32 s71, s71, 27

    s_and_b32 s16, s21, 3
    s_lshl_b32 s17, s20, 2
    s_add_u32 s16, s16, s17
    s_lshr_b32 s17, s21, 2

    s_mov_b32 s12, s10
    s_and_b32 s13, s11, 0xffff
    s_mov_b32 s14, 268435456
    s_mov_b32 s15, 0x00020000
    s_mov_b32 s52, s38
    s_and_b32 s53, s39, 0xffff
    s_mov_b32 s54, 6291456
    s_mov_b32 s55, 0x00020000
    s_cmp_ge_u32 s18, 4
    s_cbranch_scc1 fr_helper

    s_mov_b32 s44, s6
    s_and_b32 s45, s7, 0xffff
    s_mov_b32 s46, 12582912
    s_mov_b32 s47, 0x00020000
    s_mov_b32 s40, s4
    s_and_b32 s41, s5, 0xffff
    s_mov_b32 s42, 2048
    s_mov_b32 s43, 0x00020000
    buffer_load_dwordx4 v[24:27], v7, s[44:47], s23 offen
    buffer_load_dwordx4 v[28:31], v7, s[44:47], s24 offen
    buffer_load_dwordx4 v[32:35], v7, s[44:47], s25 offen
    buffer_load_dwordx4 v[36:39], v7, s[44:47], s26 offen
    buffer_load_ushort v20, v6, s[40:43], 0 offen offset:0
    buffer_load_ushort v21, v6, s[40:43], 0 offen offset:16
    buffer_load_ushort v22, v6, s[40:43], 0 offen offset:32
    buffer_load_ushort v23, v6, s[40:43], 0 offen offset:48
    s_cmp_lg_u32 s18, 0
    s_cbranch_scc1 fr_n1
    ds_write_b64 v19, v[10:11]
    ds_write_b64 v19, v[10:11] offset:16
    ds_write_b64 v19, v[10:11] offset:24
    s_waitcnt vmcnt(0)
    s_branch fr_n2
    fr_n1:
    s_sub_u32 s32, s18, 1

    s_cmp_ge_u32 s32, 3
    s_cselect_b32 s34, 1, 0
    s_mul_i32 s33, s34, 3
    s_sub_u32 s32, s32, s33
    s_mul_i32 s33, s21, 196608
    s_lshl_b32 s35, s32, 11
    s_add_u32 s33, s33, s35
    s_lshl_b32 s35, s20, 8
    s_add_u32 s33, s33, s35
    s_lshl_b32 s35, s34, 7
    s_add_u32 s33, s33, s35
    v_lshrrev_b32 v60, 3, v2
    s_mov_b32 s35, 6144
    v_mul_lo_u32 v62, v60, s35
    v_and_b32 v61, 7, v2
    v_lshl_add_u32 v62, v61, 4, v62

    buffer_load_dwordx4 v[64:67], v62, s[52:55], s33 offen
    s_add_u32 s33, s33, 49152
    buffer_load_dwordx4 v[68:71], v62, s[52:55], s33 offen
    s_add_u32 s33, s33, 49152
    buffer_load_dwordx4 v[72:75], v62, s[52:55], s33 offen
    s_add_u32 s33, s33, 49152
    buffer_load_dwordx4 v[76:79], v62, s[52:55], s33 offen
    s_waitcnt vmcnt(4)
    fr_n2:
    s_mov_b32 s22, 0xbfb8aa3b

    v_lshlrev_b32 v20, 16, v20
    v_lshlrev_b32 v21, 16, v21
    v_lshlrev_b32 v22, 16, v22
    v_lshlrev_b32 v23, 16, v23
    v_mul_f32 v40, s22, v20
    v_mul_f32 v41, s22, v21
    v_mul_f32 v42, s22, v22
    v_mul_f32 v43, s22, v23
    v_exp_f32 v40, v40
    v_exp_f32 v41, v41
    v_exp_f32 v42, v42
    v_exp_f32 v43, v43
    v_add_f32 v40, 1.0, v40
    v_add_f32 v41, 1.0, v41
    v_add_f32 v42, 1.0, v42
    v_add_f32 v43, 1.0, v43
    v_rcp_f32 v40, v40
    v_rcp_f32 v41, v41
    v_rcp_f32 v42, v42
    v_rcp_f32 v43, v43
    v_mul_f32 v20, v20, v40
    v_mul_f32 v21, v21, v41
    v_mul_f32 v22, v22, v42
    v_mul_f32 v23, v23, v43
    v_cvt_pk_bf16_f32 v20, v20, v20
    v_cvt_pk_bf16_f32 v21, v21, v21
    v_cvt_pk_bf16_f32 v22, v22, v22
    v_cvt_pk_bf16_f32 v23, v23, v23
    v_lshlrev_b32 v20, 16, v20
    v_lshlrev_b32 v21, 16, v21
    v_lshlrev_b32 v22, 16, v22
    v_lshlrev_b32 v23, 16, v23

    v_lshlrev_b32 v48, 16, v24
    v_and_b32 v49, 0xffff0000, v24
    v_lshlrev_b32 v50, 16, v25
    v_and_b32 v51, 0xffff0000, v25
    v_lshlrev_b32 v52, 16, v26
    v_and_b32 v53, 0xffff0000, v26
    v_lshlrev_b32 v54, 16, v27
    v_and_b32 v55, 0xffff0000, v27
    v_mul_f32 v40, v20, v48
    v_mul_f32 v41, v20, v49
    v_mul_f32 v42, v20, v50
    v_mul_f32 v43, v20, v51
    v_mul_f32 v44, v20, v52
    v_mul_f32 v45, v20, v53
    v_mul_f32 v46, v20, v54
    v_mul_f32 v47, v20, v55
    v_lshlrev_b32 v48, 16, v28
    v_and_b32 v49, 0xffff0000, v28
    v_lshlrev_b32 v50, 16, v29
    v_and_b32 v51, 0xffff0000, v29
    v_lshlrev_b32 v52, 16, v30
    v_and_b32 v53, 0xffff0000, v30
    v_lshlrev_b32 v54, 16, v31
    v_and_b32 v55, 0xffff0000, v31
    v_fmac_f32 v40, v21, v48
    v_fmac_f32 v41, v21, v49
    v_fmac_f32 v42, v21, v50
    v_fmac_f32 v43, v21, v51
    v_fmac_f32 v44, v21, v52
    v_fmac_f32 v45, v21, v53
    v_fmac_f32 v46, v21, v54
    v_fmac_f32 v47, v21, v55
    v_lshlrev_b32 v48, 16, v32
    v_and_b32 v49, 0xffff0000, v32
    v_lshlrev_b32 v50, 16, v33
    v_and_b32 v51, 0xffff0000, v33
    v_lshlrev_b32 v52, 16, v34
    v_and_b32 v53, 0xffff0000, v34
    v_lshlrev_b32 v54, 16, v35
    v_and_b32 v55, 0xffff0000, v35
    v_fmac_f32 v40, v22, v48
    v_fmac_f32 v41, v22, v49
    v_fmac_f32 v42, v22, v50
    v_fmac_f32 v43, v22, v51
    v_fmac_f32 v44, v22, v52
    v_fmac_f32 v45, v22, v53
    v_fmac_f32 v46, v22, v54
    v_fmac_f32 v47, v22, v55
    v_lshlrev_b32 v48, 16, v36
    v_and_b32 v49, 0xffff0000, v36
    v_lshlrev_b32 v50, 16, v37
    v_and_b32 v51, 0xffff0000, v37
    v_lshlrev_b32 v52, 16, v38
    v_and_b32 v53, 0xffff0000, v38
    v_lshlrev_b32 v54, 16, v39
    v_and_b32 v55, 0xffff0000, v39
    v_fmac_f32 v40, v23, v48
    v_fmac_f32 v41, v23, v49
    v_fmac_f32 v42, v23, v50
    v_fmac_f32 v43, v23, v51
    v_fmac_f32 v44, v23, v52
    v_fmac_f32 v45, v23, v53
    v_fmac_f32 v46, v23, v54
    v_fmac_f32 v47, v23, v55
    s_nop 1
    v_add_f32_dpp v48, v40, v40 row_ror:4 row_mask:0xf bank_mask:0xf
    v_add_f32_dpp v49, v41, v41 row_ror:4 row_mask:0xf bank_mask:0xf
    v_add_f32_dpp v50, v42, v42 row_ror:4 row_mask:0xf bank_mask:0xf
    v_add_f32_dpp v51, v43, v43 row_ror:4 row_mask:0xf bank_mask:0xf
    v_add_f32_dpp v52, v44, v44 row_ror:4 row_mask:0xf bank_mask:0xf
    v_add_f32_dpp v53, v45, v45 row_ror:4 row_mask:0xf bank_mask:0xf
    v_add_f32_dpp v54, v46, v46 row_ror:4 row_mask:0xf bank_mask:0xf
    v_add_f32_dpp v55, v47, v47 row_ror:4 row_mask:0xf bank_mask:0xf
    v_add_f32_dpp v40, v48, v48 row_ror:8 row_mask:0xf bank_mask:0xf
    v_add_f32_dpp v41, v49, v49 row_ror:8 row_mask:0xf bank_mask:0xf
    v_add_f32_dpp v42, v50, v50 row_ror:8 row_mask:0xf bank_mask:0xf
    v_add_f32_dpp v43, v51, v51 row_ror:8 row_mask:0xf bank_mask:0xf
    v_add_f32_dpp v44, v52, v52 row_ror:8 row_mask:0xf bank_mask:0xf
    v_add_f32_dpp v45, v53, v53 row_ror:8 row_mask:0xf bank_mask:0xf
    v_add_f32_dpp v46, v54, v54 row_ror:8 row_mask:0xf bank_mask:0xf
    v_add_f32_dpp v47, v55, v55 row_ror:8 row_mask:0xf bank_mask:0xf
    v_mov_b32 v48, v40
    v_mov_b32 v49, v41
    v_mov_b32 v50, v42
    v_mov_b32 v51, v43
    v_mov_b32 v52, v44
    v_mov_b32 v53, v45
    v_mov_b32 v54, v46
    v_mov_b32 v55, v47
    s_nop 1
    v_permlane16_swap_b32 v40, v48
    v_permlane16_swap_b32 v41, v49
    v_permlane16_swap_b32 v42, v50
    v_permlane16_swap_b32 v43, v51
    v_permlane16_swap_b32 v44, v52
    v_permlane16_swap_b32 v45, v53
    v_permlane16_swap_b32 v46, v54
    v_permlane16_swap_b32 v47, v55
    v_add_f32 v40, v40, v48
    v_add_f32 v41, v41, v49
    v_add_f32 v42, v42, v50
    v_add_f32 v43, v43, v51
    v_add_f32 v44, v44, v52
    v_add_f32 v45, v45, v53
    v_add_f32 v46, v46, v54
    v_add_f32 v47, v47, v55
    v_lshrrev_b32 v4, 5, v2
    v_lshlrev_b32 v3, 8, v1
    v_lshl_add_u32 v3, v4, 7, v3
    v_and_b32 v4, 3, v2
    v_lshl_add_u32 v3, v4, 5, v3
    v_add_u32 v3, 147456, v3
    s_mov_b32 s22, 15
    s_mov_b32 s23, 15
    s_mov_b64 exec, s[22:23]
    ds_write_b128 v3, v[40:43]
    ds_write_b128 v3, v[44:47] offset:16
    s_mov_b64 exec, -1
    s_cmp_lg_u32 s18, 0
    s_cbranch_scc1 fr_bias
    v_lshlrev_b32 v3, 2, v2
    v_add_u32 v3, 147456, v3
    s_lshl_b32 s22, s21, 12
    s_add_u32 s22, s22, 262144
    s_lshl_b32 s23, s20, 9
    s_add_u32 s23, s23, s22
    v_lshlrev_b32 v4, 3, v2
    v_lshrrev_b32 v6, 4, v2
    v_and_b32 v6, 1, v6
    v_lshlrev_b32 v6, 7, v6
    v_and_b32 v7, 3, v2
    v_lshl_add_u32 v6, v7, 5, v6
    v_lshrrev_b32 v7, 2, v2
    v_and_b32 v7, 3, v7
    v_lshl_add_u32 v6, v7, 2, v6
    v_add_u32 v6, 149504, v6
    s_lshr_b32 s24, s16, 2
    s_lshl_b32 s24, s24, 12
    s_add_u32 s24, s24, 2752512
    v_and_b32 v31, 31, v2
    v_lshlrev_b32 v31, 7, v31
    s_lshl_b32 s25, s20, 12
    s_add_u32 s25, s25, 2818048
    v_and_b32 v7, 16, v2
    v_cmp_ne_u32 s[62:63], 0, v7
    s_waitcnt lgkmcnt(0)
    s_barrier

    ds_read_b32 v56, v3 offset:0
    ds_read_b32 v57, v3 offset:256
    ds_read_b32 v58, v3 offset:512
    ds_read_b32 v59, v3 offset:768
    ds_read_b64 v[34:35], v19 offset:8
    s_waitcnt lgkmcnt(0)
    v_mov_b32 v28, v34
    v_xor_b32 v29, s71, v35
    v_readfirstlane_b32 s72, v34
    v_readfirstlane_b32 s73, v35
    v_add_f32 v56, v56, v57
    v_add_f32 v58, v58, v59
    v_add_f32 v56, v56, v58
    v_mov_b32 v32, v56
    s_nop 1
    v_mov_b32_dpp v33, v56 quad_perm:[1,0,3,2] row_mask:0xf bank_mask:0xf
    s_mov_b32 s60, 0x55555555
    s_mov_b32 s61, 0x55555555
    s_mov_b64 exec, s[60:61]
    buffer_store_dwordx4 v[32:35], v4, s[12:15], s23 offen sc1
    s_mov_b64 exec, -1
    v_mov_b32 v30, 0x07ffffff
    fr_poll1:
    buffer_load_dwordx4 v[40:43], v5, s[12:15], s22 offen sc1
    buffer_load_dwordx4 v[44:47], v5, s[12:15], s22 offen offset:1024 sc1
    buffer_load_dwordx4 v[48:51], v5, s[12:15], s22 offen offset:2048 sc1
    buffer_load_dwordx4 v[52:55], v5, s[12:15], s22 offen offset:3072 sc1
    buffer_load_dwordx2 v[26:27], v31, s[12:15], s25 offen sc1
    s_waitcnt vmcnt(0)
    v_xor_b32 v26, v26, v28
    v_xor_b32 v27, v27, v29
    v_and_or_b32 v26, v27, v30, v26
    v_xor_b32 v36, v42, v34
    v_xor_b32 v37, v43, v35
    v_xor_b32 v38, v46, v34
    v_xor_b32 v39, v47, v35
    v_or3_b32 v36, v36, v37, v38
    v_xor_b32 v37, v50, v34
    v_xor_b32 v38, v51, v35
    v_or3_b32 v36, v36, v39, v37
    v_xor_b32 v37, v54, v34
    v_xor_b32 v39, v55, v35
    v_or3_b32 v36, v36, v38, v37
    v_or3_b32 v36, v36, v39, v26
    v_cmp_ne_u32 vcc, 0, v36
    s_sub_u32 s70, s70, 1
    s_cbranch_scc1 fr_poll1x
    s_cbranch_vccnz fr_poll1
    fr_poll1x:
    v_add_f32 v16, v40, v44
    v_add_f32 v17, v41, v45
    v_add_f32 v24, v48, v52
    v_add_f32 v25, v49, v53
    v_add_f32 v16, v16, v24
    v_add_f32 v17, v17, v25
    v_mov_b32 v18, v16
    v_mov_b32 v21, v17
    s_nop 1
    v_permlane32_swap_b32 v16, v18
    v_permlane32_swap_b32 v17, v21
    s_nop 0
    v_add_f32 v16, v16, v18
    v_add_f32 v17, v17, v21
    v_cvt_pk_bf16_f32 v20, v16, v17
    v_lshlrev_b32 v16, 16, v20
    v_and_b32 v17, 0xffff0000, v20
    v_add_f32 v32, 1.0, v16
    v_add_f32 v33, 1.0, v17
    v_cvt_pk_bf16_f32 v33, v32, v33
    v_lshlrev_b32 v32, 16, v33
    v_and_b32 v33, 0xffff0000, v33
    v_cndmask_b32 v16, v16, v32, s[62:63]
    v_cndmask_b32 v17, v17, v33, s[62:63]
    v_cmp_ne_u32 vcc, 0, v27
    s_cmp_eq_u64 vcc, 0
    s_cselect_b32 s23, 2, 2
    v_mov_b32 v21, s23
    ds_write_b32 v6, v16
    ds_write_b32 v6, v17 offset:16
    s_waitcnt lgkmcnt(0)
    ds_write_b32 v19, v21

    s_mul_i32 s26, s16, 196608
    s_add_u32 s26, s26, 67108864
    s_sleep 4
    fr_poll2:
    buffer_load_dwordx2 v[40:41], v31, s[12:15], s24 offen sc1
    s_waitcnt vmcnt(0)
    v_xor_b32 v40, v40, v34
    v_xor_b32 v41, v41, v35
    v_or_b32 v40, v40, v41
    v_cmp_ne_u32 vcc, 0, v40
    s_cbranch_vccz fr_poll2x
    s_sub_u32 s70, s70, 1
    s_cbranch_scc0 fr_poll2
    fr_poll2x:
    ds_write_b32 v19, v21 offset:4
    s_mov_b32 m0, 98304
    s_add_u32 s27, s26, 4096
    buffer_load_dwordx4 v5, s[12:15], s26 offen sc1 lds
    buffer_load_dwordx4 v5, s[12:15], s26 offen offset:1024 sc1 lds
    buffer_load_dwordx4 v5, s[12:15], s26 offen offset:2048 sc1 lds
    buffer_load_dwordx4 v5, s[12:15], s26 offen offset:3072 sc1 lds
    s_mov_b32 m0, 102400
    s_nop 0
    buffer_load_dwordx4 v5, s[12:15], s27 offen sc1 lds
    buffer_load_dwordx4 v5, s[12:15], s27 offen offset:1024 sc1 lds
    s_branch fr_cons
    fr_bias:
    s_waitcnt lgkmcnt(0)
    s_barrier
    s_waitcnt vmcnt(0)

    s_lshl_b32 s33, s20, 1
    s_add_u32 s33, s33, s34
    s_lshl_b32 s66, s20, 12
    s_lshl_b32 s35, s21, 7
    s_add_u32 s66, s66, s35
    s_add_u32 s66, s66, 2752512
    s_lshl_b32 s67, s33, 10
    s_mul_i32 s35, s21, 49152
    s_add_u32 s67, s67, s35
    s_lshl_b32 s35, s32, 14
    s_add_u32 s67, s67, s35
    s_add_u32 s67, s67, 1048576
    s_mul_i32 s33, s33, 393216
    s_lshr_b32 s35, s21, 1
    s_mul_i32 s35, s35, 12288
    s_add_u32 s33, s33, s35
    s_lshl_b32 s35, s32, 12
    s_add_u32 s33, s33, s35
    s_and_b32 s35, s21, 1
    s_lshl_b32 s35, s35, 11
    s_add_u32 s33, s33, s35
    s_add_u32 s33, s33, 67108864
    v_lshrrev_b32 v62, 2, v61
    s_mov_b32 s35, 196608
    v_mul_lo_u32 v62, v62, s35
    v_lshl_add_u32 v62, v60, 6, v62
    v_and_b32 v63, 3, v61
    v_lshl_add_u32 v62, v63, 4, v62
    v_xor_b32 v63, 32, v62
    v_lshlrev_b32 v59, 7, v61
    v_lshl_add_u32 v59, v60, 4, v59
    v_lshlrev_b32 v58, 4, v60
    v_add_u32 v58, 149504, v58
    v_mov_b32 v57, 0
    v_and_b32 v56, 8, v2
    v_cmp_ne_u32 s[60:61], 0, v56

    v_lshlrev_b32 v80, 16, v64
    v_and_b32 v81, 0xffff0000, v64
    v_lshlrev_b32 v82, 16, v65
    v_and_b32 v83, 0xffff0000, v65
    v_lshlrev_b32 v84, 16, v66
    v_and_b32 v85, 0xffff0000, v66
    v_lshlrev_b32 v86, 16, v67
    v_and_b32 v87, 0xffff0000, v67
    v_lshlrev_b32 v88, 16, v68
    v_and_b32 v89, 0xffff0000, v68
    v_lshlrev_b32 v90, 16, v69
    v_and_b32 v91, 0xffff0000, v69
    v_lshlrev_b32 v92, 16, v70
    v_and_b32 v93, 0xffff0000, v70
    v_lshlrev_b32 v94, 16, v71
    v_and_b32 v95, 0xffff0000, v71
    v_lshlrev_b32 v96, 16, v72
    v_and_b32 v97, 0xffff0000, v72
    v_lshlrev_b32 v98, 16, v73
    v_and_b32 v99, 0xffff0000, v73
    v_lshlrev_b32 v100, 16, v74
    v_and_b32 v101, 0xffff0000, v74
    v_lshlrev_b32 v102, 16, v75
    v_and_b32 v103, 0xffff0000, v75
    v_lshlrev_b32 v104, 16, v76
    v_and_b32 v105, 0xffff0000, v76
    v_lshlrev_b32 v106, 16, v77
    v_and_b32 v107, 0xffff0000, v77
    v_lshlrev_b32 v108, 16, v78
    v_and_b32 v109, 0xffff0000, v78
    v_lshlrev_b32 v110, 16, v79
    v_and_b32 v111, 0xffff0000, v79
fr_c_w1:
    ds_read_b32 v56, v19 offset:0
    s_waitcnt lgkmcnt(0)
    v_readfirstlane_b32 s22, v56
    s_cmp_lg_u32 s22, 0
    s_cbranch_scc1 fr_c_w1_go
    s_sleep 1
    s_branch fr_c_w1

fr_c_w1_go:
    ds_read_b128 v[112:115], v58 offset:128
    ds_read_b128 v[116:119], v58
    ds_read_b64 v[146:147], v19 offset:8
    s_waitcnt lgkmcnt(2)

    s_cmp_eq_u32 s22, 2
    v_mul_f32 v136, v112, v80
    v_mul_f32 v137, v112, v81
    v_mul_f32 v138, v112, v82
    v_mul_f32 v139, v112, v83
    v_mul_f32 v140, v112, v84
    v_mul_f32 v141, v112, v85
    v_mul_f32 v142, v112, v86
    v_mul_f32 v143, v112, v87
    v_cvt_pk_bf16_f32 v64, v136, v137
    v_cvt_pk_bf16_f32 v65, v138, v139
    v_cvt_pk_bf16_f32 v66, v140, v141
    v_cvt_pk_bf16_f32 v67, v142, v143
    s_cbranch_scc1 fr_c_sa0
    buffer_store_dwordx4 v[64:67], v62, s[12:15], s33 offen offset:0
    fr_c_sa0:
    s_cbranch_scc0 fr_c_sb0
    buffer_store_dwordx4 v[64:67], v62, s[12:15], s33 offen offset:0 sc1
    fr_c_sb0:

    v_mul_f32 v136, v113, v88
    v_mul_f32 v137, v113, v89
    v_mul_f32 v138, v113, v90
    v_mul_f32 v139, v113, v91
    v_mul_f32 v140, v113, v92
    v_mul_f32 v141, v113, v93
    v_mul_f32 v142, v113, v94
    v_mul_f32 v143, v113, v95
    v_cvt_pk_bf16_f32 v68, v136, v137
    v_cvt_pk_bf16_f32 v69, v138, v139
    v_cvt_pk_bf16_f32 v70, v140, v141
    v_cvt_pk_bf16_f32 v71, v142, v143
    s_cbranch_scc1 fr_c_sa1
    buffer_store_dwordx4 v[68:71], v63, s[12:15], s33 offen offset:512
    fr_c_sa1:
    s_cbranch_scc0 fr_c_sb1
    buffer_store_dwordx4 v[68:71], v63, s[12:15], s33 offen offset:512 sc1
    fr_c_sb1:

    v_mul_f32 v136, v114, v96
    v_mul_f32 v137, v114, v97
    v_mul_f32 v138, v114, v98
    v_mul_f32 v139, v114, v99
    v_mul_f32 v140, v114, v100
    v_mul_f32 v141, v114, v101
    v_mul_f32 v142, v114, v102
    v_mul_f32 v143, v114, v103
    v_cvt_pk_bf16_f32 v72, v136, v137
    v_cvt_pk_bf16_f32 v73, v138, v139
    v_cvt_pk_bf16_f32 v74, v140, v141
    v_cvt_pk_bf16_f32 v75, v142, v143
    s_cbranch_scc1 fr_c_sa2
    buffer_store_dwordx4 v[72:75], v62, s[12:15], s33 offen offset:1024
    fr_c_sa2:
    s_cbranch_scc0 fr_c_sb2
    buffer_store_dwordx4 v[72:75], v62, s[12:15], s33 offen offset:1024 sc1
    fr_c_sb2:

    v_mul_f32 v136, v115, v104
    v_mul_f32 v137, v115, v105
    v_mul_f32 v138, v115, v106
    v_mul_f32 v139, v115, v107
    v_mul_f32 v140, v115, v108
    v_mul_f32 v141, v115, v109
    v_mul_f32 v142, v115, v110
    v_mul_f32 v143, v115, v111
    v_cvt_pk_bf16_f32 v76, v136, v137
    v_cvt_pk_bf16_f32 v77, v138, v139
    v_cvt_pk_bf16_f32 v78, v140, v141
    v_cvt_pk_bf16_f32 v79, v142, v143
    s_cbranch_scc1 fr_c_sa3
    buffer_store_dwordx4 v[76:79], v63, s[12:15], s33 offen offset:1536
    fr_c_sa3:
    s_cbranch_scc0 fr_c_sb3
    buffer_store_dwordx4 v[76:79], v63, s[12:15], s33 offen offset:1536 sc1
    fr_c_sb3:

    s_waitcnt lgkmcnt(0)

    v_mul_f32 v120, v116, v80
    v_mul_f32 v121, v116, v81
    v_mul_f32 v122, v116, v82
    v_mul_f32 v123, v116, v83
    v_mul_f32 v124, v116, v84
    v_mul_f32 v125, v116, v85
    v_mul_f32 v126, v116, v86
    v_mul_f32 v127, v116, v87
    v_fmac_f32 v120, v117, v88
    v_fmac_f32 v121, v117, v89
    v_fmac_f32 v122, v117, v90
    v_fmac_f32 v123, v117, v91
    v_fmac_f32 v124, v117, v92
    v_fmac_f32 v125, v117, v93
    v_fmac_f32 v126, v117, v94
    v_fmac_f32 v127, v117, v95
    v_fmac_f32 v120, v118, v96
    v_fmac_f32 v121, v118, v97
    v_fmac_f32 v122, v118, v98
    v_fmac_f32 v123, v118, v99
    v_fmac_f32 v124, v118, v100
    v_fmac_f32 v125, v118, v101
    v_fmac_f32 v126, v118, v102
    v_fmac_f32 v127, v118, v103
    v_fmac_f32 v120, v119, v104
    v_fmac_f32 v121, v119, v105
    v_fmac_f32 v122, v119, v106
    v_fmac_f32 v123, v119, v107
    v_fmac_f32 v124, v119, v108
    v_fmac_f32 v125, v119, v109
    v_fmac_f32 v126, v119, v110
    v_fmac_f32 v127, v119, v111
    v_mov_b32 v56, 1
    s_mov_b64 exec, 1
    s_waitcnt vmcnt(0)
    ds_add_rtn_u32 v58, v19, v56 offset:16
    s_waitcnt lgkmcnt(0)
    v_readfirstlane_b32 s23, v58
    s_cmp_lg_u32 s23, 5
    s_cbranch_scc1 fr_c_nf
    s_cmp_eq_u32 s22, 2
    s_cbranch_scc1 fr_c_fs
    buffer_store_dwordx2 v[146:147], v57, s[12:15], s66 offen
    s_branch fr_c_nf
    fr_c_fs:
    buffer_store_dwordx2 v[146:147], v57, s[12:15], s66 offen sc1
    fr_c_nf:
    s_mov_b64 exec, -1

    v_lshlrev_b32 v128, 16, v64
    v_and_b32 v129, 0xffff0000, v64
    v_lshlrev_b32 v130, 16, v65
    v_and_b32 v131, 0xffff0000, v65
    v_lshlrev_b32 v132, 16, v66
    v_and_b32 v133, 0xffff0000, v66
    v_lshlrev_b32 v134, 16, v67
    v_and_b32 v135, 0xffff0000, v67
    v_lshlrev_b32 v136, 16, v68
    v_and_b32 v137, 0xffff0000, v68
    v_lshlrev_b32 v138, 16, v69
    v_and_b32 v139, 0xffff0000, v69
    v_lshlrev_b32 v140, 16, v70
    v_and_b32 v141, 0xffff0000, v70
    v_lshlrev_b32 v142, 16, v71
    v_and_b32 v143, 0xffff0000, v71
    v_add_f32 v128, v128, v136
    v_add_f32 v129, v129, v137
    v_add_f32 v130, v130, v138
    v_add_f32 v131, v131, v139
    v_add_f32 v132, v132, v140
    v_add_f32 v133, v133, v141
    v_add_f32 v134, v134, v142
    v_add_f32 v135, v135, v143
    v_lshlrev_b32 v136, 16, v72
    v_and_b32 v137, 0xffff0000, v72
    v_lshlrev_b32 v138, 16, v73
    v_and_b32 v139, 0xffff0000, v73
    v_lshlrev_b32 v140, 16, v74
    v_and_b32 v141, 0xffff0000, v74
    v_lshlrev_b32 v142, 16, v75
    v_and_b32 v143, 0xffff0000, v75
    v_add_f32 v128, v128, v136
    v_add_f32 v129, v129, v137
    v_add_f32 v130, v130, v138
    v_add_f32 v131, v131, v139
    v_add_f32 v132, v132, v140
    v_add_f32 v133, v133, v141
    v_add_f32 v134, v134, v142
    v_add_f32 v135, v135, v143
    v_lshlrev_b32 v136, 16, v76
    v_and_b32 v137, 0xffff0000, v76
    v_lshlrev_b32 v138, 16, v77
    v_and_b32 v139, 0xffff0000, v77
    v_lshlrev_b32 v140, 16, v78
    v_and_b32 v141, 0xffff0000, v78
    v_lshlrev_b32 v142, 16, v79
    v_and_b32 v143, 0xffff0000, v79
    v_add_f32 v128, v128, v136
    v_add_f32 v129, v129, v137
    v_add_f32 v130, v130, v138
    v_add_f32 v131, v131, v139
    v_add_f32 v132, v132, v140
    v_add_f32 v133, v133, v141
    v_add_f32 v134, v134, v142
    v_add_f32 v135, v135, v143
    s_nop 0
    v_permlane32_swap_b32 v120, v124
    v_permlane32_swap_b32 v121, v125
    v_permlane32_swap_b32 v122, v126
    v_permlane32_swap_b32 v123, v127
    v_permlane32_swap_b32 v128, v132
    v_permlane32_swap_b32 v129, v133
    v_permlane32_swap_b32 v130, v134
    v_permlane32_swap_b32 v131, v135
    v_add_f32 v120, v120, v124
    v_add_f32 v121, v121, v125
    v_add_f32 v122, v122, v126
    v_add_f32 v123, v123, v127
    v_add_f32 v128, v128, v132
    v_add_f32 v129, v129, v133
    v_add_f32 v130, v130, v134
    v_add_f32 v131, v131, v135
    s_nop 0
    v_permlane16_swap_b32 v120, v122
    v_permlane16_swap_b32 v121, v123
    v_permlane16_swap_b32 v128, v130
    v_permlane16_swap_b32 v129, v131
    s_nop 0
    v_add_f32 v120, v120, v122
    v_add_f32 v121, v121, v123
    v_add_f32 v128, v128, v130
    v_add_f32 v129, v129, v131
    s_nop 0
    v_add_f32_dpp v136, v120, v120 row_ror:8 row_mask:0xf bank_mask:0xf
    v_add_f32_dpp v137, v121, v121 row_ror:8 row_mask:0xf bank_mask:0xf
    v_add_f32_dpp v138, v128, v128 row_ror:8 row_mask:0xf bank_mask:0xf
    v_add_f32_dpp v139, v129, v129 row_ror:8 row_mask:0xf bank_mask:0xf
    v_cndmask_b32 v144, v136, v137, s[60:61]
    v_cndmask_b32 v145, v138, v139, s[60:61]
    v_readfirstlane_b32 s72, v146
    v_readfirstlane_b32 s73, v147
    buffer_store_dwordx4 v[144:147], v59, s[12:15], s67 offen sc1

fr_cons:
    s_lshl_b32 s24, s18, 13
    v_and_b32 v3, 15, v2
    v_lshrrev_b32 v4, 4, v2
    v_lshrrev_b32 v6, 1, v3
    v_xor_b32 v6, v6, v4
    v_lshlrev_b32 v6, 4, v6
    v_lshl_add_u32 v6, v3, 7, v6
    v_add_u32 v8, s24, v6
    v_xor_b32 v9, 64, v8
    v_add_u32 v10, 65536, v8
    v_add_u32 v11, 65536, v9
    v_lshrrev_b32 v6, 2, v2
    v_and_b32 v6, 3, v6
    v_lshl_add_u32 v6, v4, 3, v6
    v_lshlrev_b32 v6, 6, v6
    v_and_b32 v7, 1, v4
    v_lshl_add_u32 v6, v7, 5, v6
    v_and_b32 v7, 3, v2
    v_lshl_add_u32 v6, v7, 3, v6
    v_add_u32 v12, 98304, v6
    v_xor_b32 v13, 32, v12

    s_lshl_b32 s24, s18, 10
    v_lshl_add_u32 v14, v3, 4, s24
    v_add_u32 v14, 151552, v14
    s_lshl_b32 s24, s18, 8
    v_lshl_add_u32 v15, v4, 4, s24
    v_add_u32 v15, 147456, v15
    v_lshlrev_b32 v19, 4, v4
    v_add_u32 v19, 150656, v19
    v_lshlrev_b32 v7, 2, v3
    v_add_u32 v7, 150656, v7

    v_mov_b32 v100, 0
    v_mov_b32 v101, 0
    v_mov_b32 v102, 0
    v_mov_b32 v103, 0
    v_mov_b32 v104, 0
    v_mov_b32 v105, 0
    v_mov_b32 v106, 0
    v_mov_b32 v107, 0
    v_mov_b32 v108, 0
    v_mov_b32 v109, 0
    v_mov_b32 v110, 0
    v_mov_b32 v111, 0
    v_mov_b32 v112, 0
    v_mov_b32 v113, 0
    v_mov_b32 v114, 0
    v_mov_b32 v115, 0
    v_mov_b32 v116, 0
    v_mov_b32 v117, 0
    v_mov_b32 v118, 0
    v_mov_b32 v119, 0
    v_mov_b32 v120, 0
    v_mov_b32 v121, 0
    v_mov_b32 v122, 0
    v_mov_b32 v123, 0
    v_mov_b32 v124, 0
    v_mov_b32 v125, 0
    v_mov_b32 v126, 0
    v_mov_b32 v127, 0
    v_mov_b32 v128, 0
    v_mov_b32 v129, 0
    v_mov_b32 v130, 0
    v_mov_b32 v131, 0
    v_mov_b32 v132, 0
    v_mov_b32 v133, 0
    v_mov_b32 v134, 0
    v_mov_b32 v135, 0
    v_mov_b32 v136, 0
    v_mov_b32 v137, 0
    v_mov_b32 v138, 0
    v_mov_b32 v139, 0
    v_mov_b32 v140, 0
    v_mov_b32 v141, 0
    v_mov_b32 v142, 0
    v_mov_b32 v143, 0
    v_mov_b32 v144, 0
    v_mov_b32 v145, 0
    v_mov_b32 v146, 0
    v_mov_b32 v147, 0
    v_mov_b32 v148, 0
    v_mov_b32 v149, 0
    v_mov_b32 v150, 0
    v_mov_b32 v151, 0
    v_mov_b32 v152, 0
    v_mov_b32 v153, 0
    v_mov_b32 v154, 0
    v_mov_b32 v155, 0
    v_mov_b32 v156, 0
    v_mov_b32 v157, 0
    v_mov_b32 v158, 0
    v_mov_b32 v159, 0
    v_mov_b32 v160, 0
    v_mov_b32 v161, 0
    v_mov_b32 v162, 0
    v_mov_b32 v163, 0
    v_mov_b32 v164, 0
    v_mov_b32 v165, 0
    v_mov_b32 v166, 0
    v_mov_b32 v167, 0
    v_mov_b32 v168, 0
    v_mov_b32 v169, 0
    v_mov_b32 v170, 0
    v_mov_b32 v171, 0
    v_mov_b32 v172, 0
    v_mov_b32 v173, 0
    v_mov_b32 v174, 0
    v_mov_b32 v175, 0
    v_mov_b32 v176, 0
    v_mov_b32 v177, 0
    v_mov_b32 v178, 0
    v_mov_b32 v179, 0
    v_mov_b32 v180, 0
    v_mov_b32 v181, 0
    v_mov_b32 v182, 0
    v_mov_b32 v183, 0
    v_mov_b32 v184, 0
    v_mov_b32 v185, 0
    v_mov_b32 v186, 0
    v_mov_b32 v187, 0
    v_mov_b32 v188, 0
    v_mov_b32 v189, 0
    v_mov_b32 v190, 0
    v_mov_b32 v191, 0
    v_mov_b32 v192, 0
    v_mov_b32 v193, 0
    v_mov_b32 v194, 0
    v_mov_b32 v195, 0
    s_cmp_lg_u32 s18, 0
    s_cbranch_scc1 fr_nw0
    s_waitcnt vmcnt(0)
    fr_nw0:
    s_waitcnt lgkmcnt(0)

    s_setprio 3
    s_barrier
    ds_read_b128 v[20:23], v8 offset:0
    ds_read_b64_tr_b16 v[36:37], v12 offset:0
    ds_read_b64_tr_b16 v[38:39], v12 offset:256
    ds_read_b128 v[24:27], v8 offset:2048
    ds_read_b128 v[28:31], v8 offset:4096
    ds_read_b128 v[32:35], v8 offset:6144
    ds_read_b64_tr_b16 v[40:41], v13 offset:0
    ds_read_b64_tr_b16 v[42:43], v13 offset:256
    ds_read_b64_tr_b16 v[44:45], v12 offset:4096
    ds_read_b64_tr_b16 v[46:47], v12 offset:4352
    ds_read_b64_tr_b16 v[48:49], v13 offset:4096
    ds_read_b64_tr_b16 v[50:51], v13 offset:4352
    ds_read_b64_tr_b16 v[52:53], v12 offset:8192
    ds_read_b64_tr_b16 v[54:55], v12 offset:8448
    ds_read_b64_tr_b16 v[56:57], v13 offset:8192
    ds_read_b64_tr_b16 v[58:59], v13 offset:8448
    s_waitcnt lgkmcnt(13)
    v_mfma_f32_16x16x32_bf16 v[100:103], v[36:39], v[20:23], v[100:103]
    ds_read_b128 v[60:63], v9 offset:0
    s_waitcnt lgkmcnt(13)
    v_mfma_f32_16x16x32_bf16 v[104:107], v[36:39], v[24:27], v[104:107]
    ds_read_b64_tr_b16 v[76:77], v12 offset:2048
    s_waitcnt lgkmcnt(13)
    v_mfma_f32_16x16x32_bf16 v[108:111], v[36:39], v[28:31], v[108:111]
    ds_read_b64_tr_b16 v[78:79], v12 offset:2304
    s_waitcnt lgkmcnt(13)
    v_mfma_f32_16x16x32_bf16 v[112:115], v[36:39], v[32:35], v[112:115]
    ds_read_b128 v[64:67], v9 offset:2048
    s_waitcnt lgkmcnt(12)
    v_mfma_f32_16x16x32_bf16 v[128:131], v[40:43], v[32:35], v[128:131]
    ds_read_b128 v[68:71], v9 offset:4096
    v_mfma_f32_16x16x32_bf16 v[124:127], v[40:43], v[28:31], v[124:127]
    ds_read_b128 v[72:75], v9 offset:6144
    v_mfma_f32_16x16x32_bf16 v[120:123], v[40:43], v[24:27], v[120:123]
    ds_read_b64_tr_b16 v[80:81], v13 offset:2048
    v_mfma_f32_16x16x32_bf16 v[116:119], v[40:43], v[20:23], v[116:119]
    ds_read_b64_tr_b16 v[82:83], v13 offset:2304
    s_waitcnt lgkmcnt(14)
    v_mfma_f32_16x16x32_bf16 v[132:135], v[44:47], v[20:23], v[132:135]
    ds_read_b64_tr_b16 v[84:85], v12 offset:6144
    v_mfma_f32_16x16x32_bf16 v[136:139], v[44:47], v[24:27], v[136:139]
    ds_read_b64_tr_b16 v[86:87], v12 offset:6400
    v_mfma_f32_16x16x32_bf16 v[140:143], v[44:47], v[28:31], v[140:143]
    ds_read_b64_tr_b16 v[88:89], v13 offset:6144
    v_mfma_f32_16x16x32_bf16 v[144:147], v[44:47], v[32:35], v[144:147]
    ds_read_b64_tr_b16 v[90:91], v13 offset:6400
    s_waitcnt lgkmcnt(15)
    v_mfma_f32_16x16x32_bf16 v[160:163], v[48:51], v[32:35], v[160:163]
    ds_read_b64_tr_b16 v[92:93], v12 offset:10240
    v_mfma_f32_16x16x32_bf16 v[156:159], v[48:51], v[28:31], v[156:159]
    ds_read_b64_tr_b16 v[94:95], v12 offset:10496
    v_mfma_f32_16x16x32_bf16 v[152:155], v[48:51], v[24:27], v[152:155]
    ds_read_b64_tr_b16 v[96:97], v13 offset:10240
    v_mfma_f32_16x16x32_bf16 v[148:151], v[48:51], v[20:23], v[148:151]
    ds_read_b64_tr_b16 v[98:99], v13 offset:10496
    s_waitcnt lgkmcnt(15)
    v_mfma_f32_16x16x32_bf16 v[164:167], v[20:23], v[52:55], v[164:167]
    v_mfma_f32_16x16x32_bf16 v[168:171], v[24:27], v[52:55], v[168:171]
    v_mfma_f32_16x16x32_bf16 v[172:175], v[28:31], v[52:55], v[172:175]
    v_mfma_f32_16x16x32_bf16 v[176:179], v[32:35], v[52:55], v[176:179]
    v_mfma_f32_16x16x32_bf16 v[192:195], v[32:35], v[56:59], v[192:195]
    v_mfma_f32_16x16x32_bf16 v[188:191], v[28:31], v[56:59], v[188:191]
    v_mfma_f32_16x16x32_bf16 v[184:187], v[24:27], v[56:59], v[184:187]
    v_mfma_f32_16x16x32_bf16 v[180:183], v[20:23], v[56:59], v[180:183]
    s_waitcnt lgkmcnt(13)
    v_mfma_f32_16x16x32_bf16 v[100:103], v[76:79], v[60:63], v[100:103]
    s_waitcnt lgkmcnt(12)
    v_mfma_f32_16x16x32_bf16 v[104:107], v[76:79], v[64:67], v[104:107]
    s_waitcnt lgkmcnt(11)
    v_mfma_f32_16x16x32_bf16 v[108:111], v[76:79], v[68:71], v[108:111]
    s_waitcnt lgkmcnt(0)
    s_barrier
    v_mfma_f32_16x16x32_bf16 v[112:115], v[76:79], v[72:75], v[112:115]
    ds_read_b128 v[20:23], v8 offset:32768
    v_mfma_f32_16x16x32_bf16 v[128:131], v[80:83], v[72:75], v[128:131]
    ds_read_b64_tr_b16 v[36:37], v12 offset:12288
    v_mfma_f32_16x16x32_bf16 v[124:127], v[80:83], v[68:71], v[124:127]
    ds_read_b64_tr_b16 v[38:39], v12 offset:12544
    v_mfma_f32_16x16x32_bf16 v[120:123], v[80:83], v[64:67], v[120:123]
    ds_read_b128 v[24:27], v8 offset:34816
    v_mfma_f32_16x16x32_bf16 v[116:119], v[80:83], v[60:63], v[116:119]
    ds_read_b128 v[28:31], v8 offset:36864
    v_mfma_f32_16x16x32_bf16 v[132:135], v[84:87], v[60:63], v[132:135]
    ds_read_b128 v[32:35], v8 offset:38912
    v_mfma_f32_16x16x32_bf16 v[136:139], v[84:87], v[64:67], v[136:139]
    ds_read_b64_tr_b16 v[40:41], v13 offset:12288
    v_mfma_f32_16x16x32_bf16 v[140:143], v[84:87], v[68:71], v[140:143]
    ds_read_b64_tr_b16 v[42:43], v13 offset:12544
    v_mfma_f32_16x16x32_bf16 v[144:147], v[84:87], v[72:75], v[144:147]
    ds_read_b64_tr_b16 v[44:45], v12 offset:16384
    v_mfma_f32_16x16x32_bf16 v[160:163], v[88:91], v[72:75], v[160:163]
    ds_read_b64_tr_b16 v[46:47], v12 offset:16640
    v_mfma_f32_16x16x32_bf16 v[156:159], v[88:91], v[68:71], v[156:159]
    ds_read_b64_tr_b16 v[48:49], v13 offset:16384
    v_mfma_f32_16x16x32_bf16 v[152:155], v[88:91], v[64:67], v[152:155]
    ds_read_b64_tr_b16 v[50:51], v13 offset:16640
    v_mfma_f32_16x16x32_bf16 v[148:151], v[88:91], v[60:63], v[148:151]
    ds_read_b64_tr_b16 v[52:53], v12 offset:20480
    v_mfma_f32_16x16x32_bf16 v[164:167], v[60:63], v[92:95], v[164:167]
    ds_read_b64_tr_b16 v[54:55], v12 offset:20736
    v_mfma_f32_16x16x32_bf16 v[168:171], v[64:67], v[92:95], v[168:171]
    ds_read_b64_tr_b16 v[56:57], v13 offset:20480
    v_mfma_f32_16x16x32_bf16 v[172:175], v[68:71], v[92:95], v[172:175]
    ds_read_b64_tr_b16 v[58:59], v13 offset:20736
    v_mfma_f32_16x16x32_bf16 v[176:179], v[72:75], v[92:95], v[176:179]
    v_mfma_f32_16x16x32_bf16 v[192:195], v[72:75], v[96:99], v[192:195]
    v_mfma_f32_16x16x32_bf16 v[188:191], v[68:71], v[96:99], v[188:191]
    v_mfma_f32_16x16x32_bf16 v[184:187], v[64:67], v[96:99], v[184:187]
    v_mfma_f32_16x16x32_bf16 v[180:183], v[60:63], v[96:99], v[180:183]
    s_waitcnt lgkmcnt(13)
    v_mfma_f32_16x16x32_bf16 v[100:103], v[36:39], v[20:23], v[100:103]
    ds_read_b128 v[60:63], v9 offset:32768
    s_waitcnt lgkmcnt(13)
    v_mfma_f32_16x16x32_bf16 v[104:107], v[36:39], v[24:27], v[104:107]
    ds_read_b64_tr_b16 v[76:77], v12 offset:14336
    s_waitcnt lgkmcnt(13)
    v_mfma_f32_16x16x32_bf16 v[108:111], v[36:39], v[28:31], v[108:111]
    ds_read_b64_tr_b16 v[78:79], v12 offset:14592
    s_waitcnt lgkmcnt(13)
    v_mfma_f32_16x16x32_bf16 v[112:115], v[36:39], v[32:35], v[112:115]
    ds_read_b128 v[64:67], v9 offset:34816
    s_waitcnt lgkmcnt(12)
    v_mfma_f32_16x16x32_bf16 v[128:131], v[40:43], v[32:35], v[128:131]
    ds_read_b128 v[68:71], v9 offset:36864
    v_mfma_f32_16x16x32_bf16 v[124:127], v[40:43], v[28:31], v[124:127]
    ds_read_b128 v[72:75], v9 offset:38912
    v_mfma_f32_16x16x32_bf16 v[120:123], v[40:43], v[24:27], v[120:123]
    ds_read_b64_tr_b16 v[80:81], v13 offset:14336
    v_mfma_f32_16x16x32_bf16 v[116:119], v[40:43], v[20:23], v[116:119]
    ds_read_b64_tr_b16 v[82:83], v13 offset:14592
    s_waitcnt lgkmcnt(14)
    v_mfma_f32_16x16x32_bf16 v[132:135], v[44:47], v[20:23], v[132:135]
    ds_read_b64_tr_b16 v[84:85], v12 offset:18432
    v_mfma_f32_16x16x32_bf16 v[136:139], v[44:47], v[24:27], v[136:139]
    ds_read_b64_tr_b16 v[86:87], v12 offset:18688
    v_mfma_f32_16x16x32_bf16 v[140:143], v[44:47], v[28:31], v[140:143]
    ds_read_b64_tr_b16 v[88:89], v13 offset:18432
    v_mfma_f32_16x16x32_bf16 v[144:147], v[44:47], v[32:35], v[144:147]
    ds_read_b64_tr_b16 v[90:91], v13 offset:18688
    s_waitcnt lgkmcnt(15)
    v_mfma_f32_16x16x32_bf16 v[160:163], v[48:51], v[32:35], v[160:163]
    ds_read_b64_tr_b16 v[92:93], v12 offset:22528
    v_mfma_f32_16x16x32_bf16 v[156:159], v[48:51], v[28:31], v[156:159]
    ds_read_b64_tr_b16 v[94:95], v12 offset:22784
    v_mfma_f32_16x16x32_bf16 v[152:155], v[48:51], v[24:27], v[152:155]
    ds_read_b64_tr_b16 v[96:97], v13 offset:22528
    v_mfma_f32_16x16x32_bf16 v[148:151], v[48:51], v[20:23], v[148:151]
    ds_read_b64_tr_b16 v[98:99], v13 offset:22784
    s_waitcnt lgkmcnt(15)
    v_mfma_f32_16x16x32_bf16 v[164:167], v[20:23], v[52:55], v[164:167]
    v_mfma_f32_16x16x32_bf16 v[168:171], v[24:27], v[52:55], v[168:171]
    v_mfma_f32_16x16x32_bf16 v[172:175], v[28:31], v[52:55], v[172:175]
    v_mfma_f32_16x16x32_bf16 v[176:179], v[32:35], v[52:55], v[176:179]
    v_mfma_f32_16x16x32_bf16 v[192:195], v[32:35], v[56:59], v[192:195]
    v_mfma_f32_16x16x32_bf16 v[188:191], v[28:31], v[56:59], v[188:191]
    v_mfma_f32_16x16x32_bf16 v[184:187], v[24:27], v[56:59], v[184:187]
    v_mfma_f32_16x16x32_bf16 v[180:183], v[20:23], v[56:59], v[180:183]
    s_waitcnt lgkmcnt(13)
    v_mfma_f32_16x16x32_bf16 v[100:103], v[76:79], v[60:63], v[100:103]
    s_waitcnt lgkmcnt(12)
    v_mfma_f32_16x16x32_bf16 v[104:107], v[76:79], v[64:67], v[104:107]
    s_waitcnt lgkmcnt(11)
    v_mfma_f32_16x16x32_bf16 v[108:111], v[76:79], v[68:71], v[108:111]
    s_waitcnt lgkmcnt(0)
    s_barrier
    v_mfma_f32_16x16x32_bf16 v[112:115], v[76:79], v[72:75], v[112:115]
    ds_read_b128 v[20:23], v10 offset:0
    v_mfma_f32_16x16x32_bf16 v[128:131], v[80:83], v[72:75], v[128:131]
    ds_read_b64_tr_b16 v[36:37], v12 offset:24576
    v_mfma_f32_16x16x32_bf16 v[124:127], v[80:83], v[68:71], v[124:127]
    ds_read_b64_tr_b16 v[38:39], v12 offset:24832
    v_mfma_f32_16x16x32_bf16 v[120:123], v[80:83], v[64:67], v[120:123]
    ds_read_b128 v[24:27], v10 offset:2048
    v_mfma_f32_16x16x32_bf16 v[116:119], v[80:83], v[60:63], v[116:119]
    ds_read_b128 v[28:31], v10 offset:4096
    v_mfma_f32_16x16x32_bf16 v[132:135], v[84:87], v[60:63], v[132:135]
    ds_read_b128 v[32:35], v10 offset:6144
    v_mfma_f32_16x16x32_bf16 v[136:139], v[84:87], v[64:67], v[136:139]
    ds_read_b64_tr_b16 v[40:41], v13 offset:24576
    v_mfma_f32_16x16x32_bf16 v[140:143], v[84:87], v[68:71], v[140:143]
    ds_read_b64_tr_b16 v[42:43], v13 offset:24832
    v_mfma_f32_16x16x32_bf16 v[144:147], v[84:87], v[72:75], v[144:147]
    ds_read_b64_tr_b16 v[44:45], v12 offset:28672
    v_mfma_f32_16x16x32_bf16 v[160:163], v[88:91], v[72:75], v[160:163]
    ds_read_b64_tr_b16 v[46:47], v12 offset:28928
    v_mfma_f32_16x16x32_bf16 v[156:159], v[88:91], v[68:71], v[156:159]
    ds_read_b64_tr_b16 v[48:49], v13 offset:28672
    v_mfma_f32_16x16x32_bf16 v[152:155], v[88:91], v[64:67], v[152:155]
    ds_read_b64_tr_b16 v[50:51], v13 offset:28928
    v_mfma_f32_16x16x32_bf16 v[148:151], v[88:91], v[60:63], v[148:151]
    ds_read_b64_tr_b16 v[52:53], v12 offset:32768
    v_mfma_f32_16x16x32_bf16 v[164:167], v[60:63], v[92:95], v[164:167]
    ds_read_b64_tr_b16 v[54:55], v12 offset:33024
    v_mfma_f32_16x16x32_bf16 v[168:171], v[64:67], v[92:95], v[168:171]
    ds_read_b64_tr_b16 v[56:57], v13 offset:32768
    v_mfma_f32_16x16x32_bf16 v[172:175], v[68:71], v[92:95], v[172:175]
    ds_read_b64_tr_b16 v[58:59], v13 offset:33024
    v_mfma_f32_16x16x32_bf16 v[176:179], v[72:75], v[92:95], v[176:179]
    v_mfma_f32_16x16x32_bf16 v[192:195], v[72:75], v[96:99], v[192:195]
    v_mfma_f32_16x16x32_bf16 v[188:191], v[68:71], v[96:99], v[188:191]
    v_mfma_f32_16x16x32_bf16 v[184:187], v[64:67], v[96:99], v[184:187]
    v_mfma_f32_16x16x32_bf16 v[180:183], v[60:63], v[96:99], v[180:183]
    s_waitcnt lgkmcnt(13)
    v_mfma_f32_16x16x32_bf16 v[100:103], v[36:39], v[20:23], v[100:103]
    ds_read_b128 v[60:63], v11 offset:0
    s_waitcnt lgkmcnt(13)
    v_mfma_f32_16x16x32_bf16 v[104:107], v[36:39], v[24:27], v[104:107]
    ds_read_b64_tr_b16 v[76:77], v12 offset:26624
    s_waitcnt lgkmcnt(13)
    v_mfma_f32_16x16x32_bf16 v[108:111], v[36:39], v[28:31], v[108:111]
    ds_read_b64_tr_b16 v[78:79], v12 offset:26880
    s_waitcnt lgkmcnt(13)
    v_mfma_f32_16x16x32_bf16 v[112:115], v[36:39], v[32:35], v[112:115]
    ds_read_b128 v[64:67], v11 offset:2048
    s_waitcnt lgkmcnt(12)
    v_mfma_f32_16x16x32_bf16 v[128:131], v[40:43], v[32:35], v[128:131]
    ds_read_b128 v[68:71], v11 offset:4096
    v_mfma_f32_16x16x32_bf16 v[124:127], v[40:43], v[28:31], v[124:127]
    ds_read_b128 v[72:75], v11 offset:6144
    v_mfma_f32_16x16x32_bf16 v[120:123], v[40:43], v[24:27], v[120:123]
    ds_read_b64_tr_b16 v[80:81], v13 offset:26624
    v_mfma_f32_16x16x32_bf16 v[116:119], v[40:43], v[20:23], v[116:119]
    ds_read_b64_tr_b16 v[82:83], v13 offset:26880
    s_waitcnt lgkmcnt(14)
    v_mfma_f32_16x16x32_bf16 v[132:135], v[44:47], v[20:23], v[132:135]
    ds_read_b64_tr_b16 v[84:85], v12 offset:30720
    v_mfma_f32_16x16x32_bf16 v[136:139], v[44:47], v[24:27], v[136:139]
    ds_read_b64_tr_b16 v[86:87], v12 offset:30976
    v_mfma_f32_16x16x32_bf16 v[140:143], v[44:47], v[28:31], v[140:143]
    ds_read_b64_tr_b16 v[88:89], v13 offset:30720
    v_mfma_f32_16x16x32_bf16 v[144:147], v[44:47], v[32:35], v[144:147]
    ds_read_b64_tr_b16 v[90:91], v13 offset:30976
    s_waitcnt lgkmcnt(15)
    v_mfma_f32_16x16x32_bf16 v[160:163], v[48:51], v[32:35], v[160:163]
    ds_read_b64_tr_b16 v[92:93], v12 offset:34816
    v_mfma_f32_16x16x32_bf16 v[156:159], v[48:51], v[28:31], v[156:159]
    ds_read_b64_tr_b16 v[94:95], v12 offset:35072
    v_mfma_f32_16x16x32_bf16 v[152:155], v[48:51], v[24:27], v[152:155]
    ds_read_b64_tr_b16 v[96:97], v13 offset:34816
    v_mfma_f32_16x16x32_bf16 v[148:151], v[48:51], v[20:23], v[148:151]
    ds_read_b64_tr_b16 v[98:99], v13 offset:35072
    s_waitcnt lgkmcnt(15)
    v_mfma_f32_16x16x32_bf16 v[164:167], v[20:23], v[52:55], v[164:167]
    v_mfma_f32_16x16x32_bf16 v[168:171], v[24:27], v[52:55], v[168:171]
    v_mfma_f32_16x16x32_bf16 v[172:175], v[28:31], v[52:55], v[172:175]
    v_mfma_f32_16x16x32_bf16 v[176:179], v[32:35], v[52:55], v[176:179]
    v_mfma_f32_16x16x32_bf16 v[192:195], v[32:35], v[56:59], v[192:195]
    v_mfma_f32_16x16x32_bf16 v[188:191], v[28:31], v[56:59], v[188:191]
    v_mfma_f32_16x16x32_bf16 v[184:187], v[24:27], v[56:59], v[184:187]
    v_mfma_f32_16x16x32_bf16 v[180:183], v[20:23], v[56:59], v[180:183]
    s_waitcnt lgkmcnt(13)
    v_mfma_f32_16x16x32_bf16 v[100:103], v[76:79], v[60:63], v[100:103]
    s_waitcnt lgkmcnt(12)
    v_mfma_f32_16x16x32_bf16 v[104:107], v[76:79], v[64:67], v[104:107]
    s_waitcnt lgkmcnt(11)
    v_mfma_f32_16x16x32_bf16 v[108:111], v[76:79], v[68:71], v[108:111]
    s_waitcnt lgkmcnt(0)
    s_barrier
    v_mfma_f32_16x16x32_bf16 v[112:115], v[76:79], v[72:75], v[112:115]
    ds_read_b128 v[20:23], v8 offset:0
    v_mfma_f32_16x16x32_bf16 v[128:131], v[80:83], v[72:75], v[128:131]
    ds_read_b64_tr_b16 v[36:37], v12 offset:36864
    v_mfma_f32_16x16x32_bf16 v[124:127], v[80:83], v[68:71], v[124:127]
    ds_read_b64_tr_b16 v[38:39], v12 offset:37120
    v_mfma_f32_16x16x32_bf16 v[120:123], v[80:83], v[64:67], v[120:123]
    ds_read_b128 v[24:27], v8 offset:2048
    v_mfma_f32_16x16x32_bf16 v[116:119], v[80:83], v[60:63], v[116:119]
    ds_read_b128 v[28:31], v8 offset:4096
    v_mfma_f32_16x16x32_bf16 v[132:135], v[84:87], v[60:63], v[132:135]
    ds_read_b128 v[32:35], v8 offset:6144
    v_mfma_f32_16x16x32_bf16 v[136:139], v[84:87], v[64:67], v[136:139]
    ds_read_b64_tr_b16 v[40:41], v13 offset:36864
    v_mfma_f32_16x16x32_bf16 v[140:143], v[84:87], v[68:71], v[140:143]
    ds_read_b64_tr_b16 v[42:43], v13 offset:37120
    v_mfma_f32_16x16x32_bf16 v[144:147], v[84:87], v[72:75], v[144:147]
    ds_read_b64_tr_b16 v[44:45], v12 offset:40960
    v_mfma_f32_16x16x32_bf16 v[160:163], v[88:91], v[72:75], v[160:163]
    ds_read_b64_tr_b16 v[46:47], v12 offset:41216
    v_mfma_f32_16x16x32_bf16 v[156:159], v[88:91], v[68:71], v[156:159]
    ds_read_b64_tr_b16 v[48:49], v13 offset:40960
    v_mfma_f32_16x16x32_bf16 v[152:155], v[88:91], v[64:67], v[152:155]
    ds_read_b64_tr_b16 v[50:51], v13 offset:41216
    v_mfma_f32_16x16x32_bf16 v[148:151], v[88:91], v[60:63], v[148:151]
    ds_read_b64_tr_b16 v[52:53], v12 offset:45056
    v_mfma_f32_16x16x32_bf16 v[164:167], v[60:63], v[92:95], v[164:167]
    ds_read_b64_tr_b16 v[54:55], v12 offset:45312
    v_mfma_f32_16x16x32_bf16 v[168:171], v[64:67], v[92:95], v[168:171]
    ds_read_b64_tr_b16 v[56:57], v13 offset:45056
    v_mfma_f32_16x16x32_bf16 v[172:175], v[68:71], v[92:95], v[172:175]
    ds_read_b64_tr_b16 v[58:59], v13 offset:45312
    v_mfma_f32_16x16x32_bf16 v[176:179], v[72:75], v[92:95], v[176:179]
    v_mfma_f32_16x16x32_bf16 v[192:195], v[72:75], v[96:99], v[192:195]
    v_mfma_f32_16x16x32_bf16 v[188:191], v[68:71], v[96:99], v[188:191]
    v_mfma_f32_16x16x32_bf16 v[184:187], v[64:67], v[96:99], v[184:187]
    v_mfma_f32_16x16x32_bf16 v[180:183], v[60:63], v[96:99], v[180:183]
    s_waitcnt lgkmcnt(13)
    v_mfma_f32_16x16x32_bf16 v[100:103], v[36:39], v[20:23], v[100:103]
    ds_read_b128 v[60:63], v9 offset:0
    s_waitcnt lgkmcnt(13)
    v_mfma_f32_16x16x32_bf16 v[104:107], v[36:39], v[24:27], v[104:107]
    ds_read_b64_tr_b16 v[76:77], v12 offset:38912
    s_waitcnt lgkmcnt(13)
    v_mfma_f32_16x16x32_bf16 v[108:111], v[36:39], v[28:31], v[108:111]
    ds_read_b64_tr_b16 v[78:79], v12 offset:39168
    s_waitcnt lgkmcnt(13)
    v_mfma_f32_16x16x32_bf16 v[112:115], v[36:39], v[32:35], v[112:115]
    ds_read_b128 v[64:67], v9 offset:2048
    s_waitcnt lgkmcnt(12)
    v_mfma_f32_16x16x32_bf16 v[128:131], v[40:43], v[32:35], v[128:131]
    ds_read_b128 v[68:71], v9 offset:4096
    v_mfma_f32_16x16x32_bf16 v[124:127], v[40:43], v[28:31], v[124:127]
    ds_read_b128 v[72:75], v9 offset:6144
    v_mfma_f32_16x16x32_bf16 v[120:123], v[40:43], v[24:27], v[120:123]
    ds_read_b64_tr_b16 v[80:81], v13 offset:38912
    v_mfma_f32_16x16x32_bf16 v[116:119], v[40:43], v[20:23], v[116:119]
    ds_read_b64_tr_b16 v[82:83], v13 offset:39168
    s_waitcnt lgkmcnt(14)
    v_mfma_f32_16x16x32_bf16 v[132:135], v[44:47], v[20:23], v[132:135]
    ds_read_b64_tr_b16 v[84:85], v12 offset:43008
    v_mfma_f32_16x16x32_bf16 v[136:139], v[44:47], v[24:27], v[136:139]
    ds_read_b64_tr_b16 v[86:87], v12 offset:43264
    v_mfma_f32_16x16x32_bf16 v[140:143], v[44:47], v[28:31], v[140:143]
    ds_read_b64_tr_b16 v[88:89], v13 offset:43008
    v_mfma_f32_16x16x32_bf16 v[144:147], v[44:47], v[32:35], v[144:147]
    ds_read_b64_tr_b16 v[90:91], v13 offset:43264
    s_waitcnt lgkmcnt(15)
    v_mfma_f32_16x16x32_bf16 v[160:163], v[48:51], v[32:35], v[160:163]
    ds_read_b64_tr_b16 v[92:93], v12 offset:47104
    v_mfma_f32_16x16x32_bf16 v[156:159], v[48:51], v[28:31], v[156:159]
    ds_read_b64_tr_b16 v[94:95], v12 offset:47360
    v_mfma_f32_16x16x32_bf16 v[152:155], v[48:51], v[24:27], v[152:155]
    ds_read_b64_tr_b16 v[96:97], v13 offset:47104
    v_mfma_f32_16x16x32_bf16 v[148:151], v[48:51], v[20:23], v[148:151]
    ds_read_b64_tr_b16 v[98:99], v13 offset:47360
    s_waitcnt lgkmcnt(15)
    v_mfma_f32_16x16x32_bf16 v[164:167], v[20:23], v[52:55], v[164:167]
    v_mfma_f32_16x16x32_bf16 v[168:171], v[24:27], v[52:55], v[168:171]
    v_mfma_f32_16x16x32_bf16 v[172:175], v[28:31], v[52:55], v[172:175]
    v_mfma_f32_16x16x32_bf16 v[176:179], v[32:35], v[52:55], v[176:179]
    v_mfma_f32_16x16x32_bf16 v[192:195], v[32:35], v[56:59], v[192:195]
    v_mfma_f32_16x16x32_bf16 v[188:191], v[28:31], v[56:59], v[188:191]
    v_mfma_f32_16x16x32_bf16 v[184:187], v[24:27], v[56:59], v[184:187]
    v_mfma_f32_16x16x32_bf16 v[180:183], v[20:23], v[56:59], v[180:183]
    s_waitcnt lgkmcnt(13)
    v_mfma_f32_16x16x32_bf16 v[100:103], v[76:79], v[60:63], v[100:103]
    s_waitcnt lgkmcnt(12)
    v_mfma_f32_16x16x32_bf16 v[104:107], v[76:79], v[64:67], v[104:107]
    s_waitcnt lgkmcnt(11)
    v_mfma_f32_16x16x32_bf16 v[108:111], v[76:79], v[68:71], v[108:111]
    s_waitcnt lgkmcnt(0)
    s_barrier
    v_mfma_f32_16x16x32_bf16 v[112:115], v[76:79], v[72:75], v[112:115]
    ds_read_b128 v[20:23], v8 offset:32768
    v_mfma_f32_16x16x32_bf16 v[128:131], v[80:83], v[72:75], v[128:131]
    ds_read_b64_tr_b16 v[36:37], v12 offset:0
    v_mfma_f32_16x16x32_bf16 v[124:127], v[80:83], v[68:71], v[124:127]
    ds_read_b64_tr_b16 v[38:39], v12 offset:256
    v_mfma_f32_16x16x32_bf16 v[120:123], v[80:83], v[64:67], v[120:123]
    ds_read_b128 v[24:27], v8 offset:34816
    v_mfma_f32_16x16x32_bf16 v[116:119], v[80:83], v[60:63], v[116:119]
    ds_read_b128 v[28:31], v8 offset:36864
    v_mfma_f32_16x16x32_bf16 v[132:135], v[84:87], v[60:63], v[132:135]
    ds_read_b128 v[32:35], v8 offset:38912
    v_mfma_f32_16x16x32_bf16 v[136:139], v[84:87], v[64:67], v[136:139]
    ds_read_b64_tr_b16 v[40:41], v13 offset:0
    v_mfma_f32_16x16x32_bf16 v[140:143], v[84:87], v[68:71], v[140:143]
    ds_read_b64_tr_b16 v[42:43], v13 offset:256
    v_mfma_f32_16x16x32_bf16 v[144:147], v[84:87], v[72:75], v[144:147]
    ds_read_b64_tr_b16 v[44:45], v12 offset:4096
    v_mfma_f32_16x16x32_bf16 v[160:163], v[88:91], v[72:75], v[160:163]
    ds_read_b64_tr_b16 v[46:47], v12 offset:4352
    v_mfma_f32_16x16x32_bf16 v[156:159], v[88:91], v[68:71], v[156:159]
    ds_read_b64_tr_b16 v[48:49], v13 offset:4096
    v_mfma_f32_16x16x32_bf16 v[152:155], v[88:91], v[64:67], v[152:155]
    ds_read_b64_tr_b16 v[50:51], v13 offset:4352
    v_mfma_f32_16x16x32_bf16 v[148:151], v[88:91], v[60:63], v[148:151]
    ds_read_b64_tr_b16 v[52:53], v12 offset:8192
    v_mfma_f32_16x16x32_bf16 v[164:167], v[60:63], v[92:95], v[164:167]
    ds_read_b64_tr_b16 v[54:55], v12 offset:8448
    v_mfma_f32_16x16x32_bf16 v[168:171], v[64:67], v[92:95], v[168:171]
    ds_read_b64_tr_b16 v[56:57], v13 offset:8192
    v_mfma_f32_16x16x32_bf16 v[172:175], v[68:71], v[92:95], v[172:175]
    ds_read_b64_tr_b16 v[58:59], v13 offset:8448
    v_mfma_f32_16x16x32_bf16 v[176:179], v[72:75], v[92:95], v[176:179]
    v_mfma_f32_16x16x32_bf16 v[192:195], v[72:75], v[96:99], v[192:195]
    v_mfma_f32_16x16x32_bf16 v[188:191], v[68:71], v[96:99], v[188:191]
    v_mfma_f32_16x16x32_bf16 v[184:187], v[64:67], v[96:99], v[184:187]
    v_mfma_f32_16x16x32_bf16 v[180:183], v[60:63], v[96:99], v[180:183]
    s_waitcnt lgkmcnt(13)
    v_mfma_f32_16x16x32_bf16 v[100:103], v[36:39], v[20:23], v[100:103]
    ds_read_b128 v[60:63], v9 offset:32768
    s_waitcnt lgkmcnt(13)
    v_mfma_f32_16x16x32_bf16 v[104:107], v[36:39], v[24:27], v[104:107]
    ds_read_b64_tr_b16 v[76:77], v12 offset:2048
    s_waitcnt lgkmcnt(13)
    v_mfma_f32_16x16x32_bf16 v[108:111], v[36:39], v[28:31], v[108:111]
    ds_read_b64_tr_b16 v[78:79], v12 offset:2304
    s_waitcnt lgkmcnt(13)
    v_mfma_f32_16x16x32_bf16 v[112:115], v[36:39], v[32:35], v[112:115]
    ds_read_b128 v[64:67], v9 offset:34816
    s_waitcnt lgkmcnt(12)
    v_mfma_f32_16x16x32_bf16 v[128:131], v[40:43], v[32:35], v[128:131]
    ds_read_b128 v[68:71], v9 offset:36864
    v_mfma_f32_16x16x32_bf16 v[124:127], v[40:43], v[28:31], v[124:127]
    ds_read_b128 v[72:75], v9 offset:38912
    v_mfma_f32_16x16x32_bf16 v[120:123], v[40:43], v[24:27], v[120:123]
    ds_read_b64_tr_b16 v[80:81], v13 offset:2048
    v_mfma_f32_16x16x32_bf16 v[116:119], v[40:43], v[20:23], v[116:119]
    ds_read_b64_tr_b16 v[82:83], v13 offset:2304
    s_waitcnt lgkmcnt(14)
    v_mfma_f32_16x16x32_bf16 v[132:135], v[44:47], v[20:23], v[132:135]
    ds_read_b64_tr_b16 v[84:85], v12 offset:6144
    v_mfma_f32_16x16x32_bf16 v[136:139], v[44:47], v[24:27], v[136:139]
    ds_read_b64_tr_b16 v[86:87], v12 offset:6400
    v_mfma_f32_16x16x32_bf16 v[140:143], v[44:47], v[28:31], v[140:143]
    ds_read_b64_tr_b16 v[88:89], v13 offset:6144
    v_mfma_f32_16x16x32_bf16 v[144:147], v[44:47], v[32:35], v[144:147]
    ds_read_b64_tr_b16 v[90:91], v13 offset:6400
    s_waitcnt lgkmcnt(15)
    v_mfma_f32_16x16x32_bf16 v[160:163], v[48:51], v[32:35], v[160:163]
    ds_read_b64_tr_b16 v[92:93], v12 offset:10240
    v_mfma_f32_16x16x32_bf16 v[156:159], v[48:51], v[28:31], v[156:159]
    ds_read_b64_tr_b16 v[94:95], v12 offset:10496
    v_mfma_f32_16x16x32_bf16 v[152:155], v[48:51], v[24:27], v[152:155]
    ds_read_b64_tr_b16 v[96:97], v13 offset:10240
    v_mfma_f32_16x16x32_bf16 v[148:151], v[48:51], v[20:23], v[148:151]
    ds_read_b64_tr_b16 v[98:99], v13 offset:10496
    s_waitcnt lgkmcnt(15)
    v_mfma_f32_16x16x32_bf16 v[164:167], v[20:23], v[52:55], v[164:167]
    v_mfma_f32_16x16x32_bf16 v[168:171], v[24:27], v[52:55], v[168:171]
    v_mfma_f32_16x16x32_bf16 v[172:175], v[28:31], v[52:55], v[172:175]
    v_mfma_f32_16x16x32_bf16 v[176:179], v[32:35], v[52:55], v[176:179]
    v_mfma_f32_16x16x32_bf16 v[192:195], v[32:35], v[56:59], v[192:195]
    v_mfma_f32_16x16x32_bf16 v[188:191], v[28:31], v[56:59], v[188:191]
    v_mfma_f32_16x16x32_bf16 v[184:187], v[24:27], v[56:59], v[184:187]
    v_mfma_f32_16x16x32_bf16 v[180:183], v[20:23], v[56:59], v[180:183]
    s_waitcnt lgkmcnt(13)
    v_mfma_f32_16x16x32_bf16 v[100:103], v[76:79], v[60:63], v[100:103]
    s_waitcnt lgkmcnt(12)
    v_mfma_f32_16x16x32_bf16 v[104:107], v[76:79], v[64:67], v[104:107]
    s_waitcnt lgkmcnt(11)
    v_mfma_f32_16x16x32_bf16 v[108:111], v[76:79], v[68:71], v[108:111]
    s_waitcnt lgkmcnt(0)
    s_barrier
    v_mfma_f32_16x16x32_bf16 v[112:115], v[76:79], v[72:75], v[112:115]
    ds_read_b128 v[20:23], v10 offset:0
    v_mfma_f32_16x16x32_bf16 v[128:131], v[80:83], v[72:75], v[128:131]
    ds_read_b64_tr_b16 v[36:37], v12 offset:12288
    v_mfma_f32_16x16x32_bf16 v[124:127], v[80:83], v[68:71], v[124:127]
    ds_read_b64_tr_b16 v[38:39], v12 offset:12544
    v_mfma_f32_16x16x32_bf16 v[120:123], v[80:83], v[64:67], v[120:123]
    ds_read_b128 v[24:27], v10 offset:2048
    v_mfma_f32_16x16x32_bf16 v[116:119], v[80:83], v[60:63], v[116:119]
    ds_read_b128 v[28:31], v10 offset:4096
    v_mfma_f32_16x16x32_bf16 v[132:135], v[84:87], v[60:63], v[132:135]
    ds_read_b128 v[32:35], v10 offset:6144
    v_mfma_f32_16x16x32_bf16 v[136:139], v[84:87], v[64:67], v[136:139]
    ds_read_b64_tr_b16 v[40:41], v13 offset:12288
    v_mfma_f32_16x16x32_bf16 v[140:143], v[84:87], v[68:71], v[140:143]
    ds_read_b64_tr_b16 v[42:43], v13 offset:12544
    v_mfma_f32_16x16x32_bf16 v[144:147], v[84:87], v[72:75], v[144:147]
    ds_read_b64_tr_b16 v[44:45], v12 offset:16384
    v_mfma_f32_16x16x32_bf16 v[160:163], v[88:91], v[72:75], v[160:163]
    ds_read_b64_tr_b16 v[46:47], v12 offset:16640
    v_mfma_f32_16x16x32_bf16 v[156:159], v[88:91], v[68:71], v[156:159]
    ds_read_b64_tr_b16 v[48:49], v13 offset:16384
    v_mfma_f32_16x16x32_bf16 v[152:155], v[88:91], v[64:67], v[152:155]
    ds_read_b64_tr_b16 v[50:51], v13 offset:16640
    v_mfma_f32_16x16x32_bf16 v[148:151], v[88:91], v[60:63], v[148:151]
    ds_read_b64_tr_b16 v[52:53], v12 offset:20480
    v_mfma_f32_16x16x32_bf16 v[164:167], v[60:63], v[92:95], v[164:167]
    ds_read_b64_tr_b16 v[54:55], v12 offset:20736
    v_mfma_f32_16x16x32_bf16 v[168:171], v[64:67], v[92:95], v[168:171]
    ds_read_b64_tr_b16 v[56:57], v13 offset:20480
    v_mfma_f32_16x16x32_bf16 v[172:175], v[68:71], v[92:95], v[172:175]
    ds_read_b64_tr_b16 v[58:59], v13 offset:20736
    v_mfma_f32_16x16x32_bf16 v[176:179], v[72:75], v[92:95], v[176:179]
    v_mfma_f32_16x16x32_bf16 v[192:195], v[72:75], v[96:99], v[192:195]
    v_mfma_f32_16x16x32_bf16 v[188:191], v[68:71], v[96:99], v[188:191]
    v_mfma_f32_16x16x32_bf16 v[184:187], v[64:67], v[96:99], v[184:187]
    v_mfma_f32_16x16x32_bf16 v[180:183], v[60:63], v[96:99], v[180:183]
    s_waitcnt lgkmcnt(13)
    v_mfma_f32_16x16x32_bf16 v[100:103], v[36:39], v[20:23], v[100:103]
    ds_read_b128 v[60:63], v11 offset:0
    s_waitcnt lgkmcnt(13)
    v_mfma_f32_16x16x32_bf16 v[104:107], v[36:39], v[24:27], v[104:107]
    ds_read_b64_tr_b16 v[76:77], v12 offset:14336
    s_waitcnt lgkmcnt(13)
    v_mfma_f32_16x16x32_bf16 v[108:111], v[36:39], v[28:31], v[108:111]
    ds_read_b64_tr_b16 v[78:79], v12 offset:14592
    s_waitcnt lgkmcnt(13)
    v_mfma_f32_16x16x32_bf16 v[112:115], v[36:39], v[32:35], v[112:115]
    ds_read_b128 v[64:67], v11 offset:2048
    s_waitcnt lgkmcnt(12)
    v_mfma_f32_16x16x32_bf16 v[128:131], v[40:43], v[32:35], v[128:131]
    ds_read_b128 v[68:71], v11 offset:4096
    v_mfma_f32_16x16x32_bf16 v[124:127], v[40:43], v[28:31], v[124:127]
    ds_read_b128 v[72:75], v11 offset:6144
    v_mfma_f32_16x16x32_bf16 v[120:123], v[40:43], v[24:27], v[120:123]
    ds_read_b64_tr_b16 v[80:81], v13 offset:14336
    v_mfma_f32_16x16x32_bf16 v[116:119], v[40:43], v[20:23], v[116:119]
    ds_read_b64_tr_b16 v[82:83], v13 offset:14592
    s_waitcnt lgkmcnt(14)
    v_mfma_f32_16x16x32_bf16 v[132:135], v[44:47], v[20:23], v[132:135]
    ds_read_b64_tr_b16 v[84:85], v12 offset:18432
    v_mfma_f32_16x16x32_bf16 v[136:139], v[44:47], v[24:27], v[136:139]
    ds_read_b64_tr_b16 v[86:87], v12 offset:18688
    v_mfma_f32_16x16x32_bf16 v[140:143], v[44:47], v[28:31], v[140:143]
    ds_read_b64_tr_b16 v[88:89], v13 offset:18432
    v_mfma_f32_16x16x32_bf16 v[144:147], v[44:47], v[32:35], v[144:147]
    ds_read_b64_tr_b16 v[90:91], v13 offset:18688
    s_waitcnt lgkmcnt(15)
    v_mfma_f32_16x16x32_bf16 v[160:163], v[48:51], v[32:35], v[160:163]
    ds_read_b64_tr_b16 v[92:93], v12 offset:22528
    v_mfma_f32_16x16x32_bf16 v[156:159], v[48:51], v[28:31], v[156:159]
    ds_read_b64_tr_b16 v[94:95], v12 offset:22784
    v_mfma_f32_16x16x32_bf16 v[152:155], v[48:51], v[24:27], v[152:155]
    ds_read_b64_tr_b16 v[96:97], v13 offset:22528
    v_mfma_f32_16x16x32_bf16 v[148:151], v[48:51], v[20:23], v[148:151]
    ds_read_b64_tr_b16 v[98:99], v13 offset:22784
    s_waitcnt lgkmcnt(15)
    v_mfma_f32_16x16x32_bf16 v[164:167], v[20:23], v[52:55], v[164:167]
    v_mfma_f32_16x16x32_bf16 v[168:171], v[24:27], v[52:55], v[168:171]
    v_mfma_f32_16x16x32_bf16 v[172:175], v[28:31], v[52:55], v[172:175]
    v_mfma_f32_16x16x32_bf16 v[176:179], v[32:35], v[52:55], v[176:179]
    v_mfma_f32_16x16x32_bf16 v[192:195], v[32:35], v[56:59], v[192:195]
    v_mfma_f32_16x16x32_bf16 v[188:191], v[28:31], v[56:59], v[188:191]
    v_mfma_f32_16x16x32_bf16 v[184:187], v[24:27], v[56:59], v[184:187]
    v_mfma_f32_16x16x32_bf16 v[180:183], v[20:23], v[56:59], v[180:183]
    s_waitcnt lgkmcnt(13)
    v_mfma_f32_16x16x32_bf16 v[100:103], v[76:79], v[60:63], v[100:103]
    s_waitcnt lgkmcnt(12)
    v_mfma_f32_16x16x32_bf16 v[104:107], v[76:79], v[64:67], v[104:107]
    s_waitcnt lgkmcnt(11)
    v_mfma_f32_16x16x32_bf16 v[108:111], v[76:79], v[68:71], v[108:111]
    s_waitcnt lgkmcnt(0)
    s_barrier
    v_mfma_f32_16x16x32_bf16 v[112:115], v[76:79], v[72:75], v[112:115]
    ds_read_b128 v[20:23], v8 offset:0
    v_mfma_f32_16x16x32_bf16 v[128:131], v[80:83], v[72:75], v[128:131]
    ds_read_b64_tr_b16 v[36:37], v12 offset:24576
    v_mfma_f32_16x16x32_bf16 v[124:127], v[80:83], v[68:71], v[124:127]
    ds_read_b64_tr_b16 v[38:39], v12 offset:24832
    v_mfma_f32_16x16x32_bf16 v[120:123], v[80:83], v[64:67], v[120:123]
    ds_read_b128 v[24:27], v8 offset:2048
    v_mfma_f32_16x16x32_bf16 v[116:119], v[80:83], v[60:63], v[116:119]
    ds_read_b128 v[28:31], v8 offset:4096
    v_mfma_f32_16x16x32_bf16 v[132:135], v[84:87], v[60:63], v[132:135]
    ds_read_b128 v[32:35], v8 offset:6144
    v_mfma_f32_16x16x32_bf16 v[136:139], v[84:87], v[64:67], v[136:139]
    ds_read_b64_tr_b16 v[40:41], v13 offset:24576
    v_mfma_f32_16x16x32_bf16 v[140:143], v[84:87], v[68:71], v[140:143]
    ds_read_b64_tr_b16 v[42:43], v13 offset:24832
    v_mfma_f32_16x16x32_bf16 v[144:147], v[84:87], v[72:75], v[144:147]
    ds_read_b64_tr_b16 v[44:45], v12 offset:28672
    v_mfma_f32_16x16x32_bf16 v[160:163], v[88:91], v[72:75], v[160:163]
    ds_read_b64_tr_b16 v[46:47], v12 offset:28928
    v_mfma_f32_16x16x32_bf16 v[156:159], v[88:91], v[68:71], v[156:159]
    ds_read_b64_tr_b16 v[48:49], v13 offset:28672
    v_mfma_f32_16x16x32_bf16 v[152:155], v[88:91], v[64:67], v[152:155]
    ds_read_b64_tr_b16 v[50:51], v13 offset:28928
    v_mfma_f32_16x16x32_bf16 v[148:151], v[88:91], v[60:63], v[148:151]
    ds_read_b64_tr_b16 v[52:53], v12 offset:32768
    v_mfma_f32_16x16x32_bf16 v[164:167], v[60:63], v[92:95], v[164:167]
    ds_read_b64_tr_b16 v[54:55], v12 offset:33024
    v_mfma_f32_16x16x32_bf16 v[168:171], v[64:67], v[92:95], v[168:171]
    ds_read_b64_tr_b16 v[56:57], v13 offset:32768
    v_mfma_f32_16x16x32_bf16 v[172:175], v[68:71], v[92:95], v[172:175]
    ds_read_b64_tr_b16 v[58:59], v13 offset:33024
    v_mfma_f32_16x16x32_bf16 v[176:179], v[72:75], v[92:95], v[176:179]
    v_mfma_f32_16x16x32_bf16 v[192:195], v[72:75], v[96:99], v[192:195]
    v_mfma_f32_16x16x32_bf16 v[188:191], v[68:71], v[96:99], v[188:191]
    v_mfma_f32_16x16x32_bf16 v[184:187], v[64:67], v[96:99], v[184:187]
    v_mfma_f32_16x16x32_bf16 v[180:183], v[60:63], v[96:99], v[180:183]
    s_waitcnt lgkmcnt(13)
    v_mfma_f32_16x16x32_bf16 v[100:103], v[36:39], v[20:23], v[100:103]
    ds_read_b128 v[60:63], v9 offset:0
    s_waitcnt lgkmcnt(13)
    v_mfma_f32_16x16x32_bf16 v[104:107], v[36:39], v[24:27], v[104:107]
    ds_read_b64_tr_b16 v[76:77], v12 offset:26624
    s_waitcnt lgkmcnt(13)
    v_mfma_f32_16x16x32_bf16 v[108:111], v[36:39], v[28:31], v[108:111]
    ds_read_b64_tr_b16 v[78:79], v12 offset:26880
    s_waitcnt lgkmcnt(13)
    v_mfma_f32_16x16x32_bf16 v[112:115], v[36:39], v[32:35], v[112:115]
    ds_read_b128 v[64:67], v9 offset:2048
    s_waitcnt lgkmcnt(12)
    v_mfma_f32_16x16x32_bf16 v[128:131], v[40:43], v[32:35], v[128:131]
    ds_read_b128 v[68:71], v9 offset:4096
    v_mfma_f32_16x16x32_bf16 v[124:127], v[40:43], v[28:31], v[124:127]
    ds_read_b128 v[72:75], v9 offset:6144
    v_mfma_f32_16x16x32_bf16 v[120:123], v[40:43], v[24:27], v[120:123]
    ds_read_b64_tr_b16 v[80:81], v13 offset:26624
    v_mfma_f32_16x16x32_bf16 v[116:119], v[40:43], v[20:23], v[116:119]
    ds_read_b64_tr_b16 v[82:83], v13 offset:26880
    s_waitcnt lgkmcnt(14)
    v_mfma_f32_16x16x32_bf16 v[132:135], v[44:47], v[20:23], v[132:135]
    ds_read_b64_tr_b16 v[84:85], v12 offset:30720
    v_mfma_f32_16x16x32_bf16 v[136:139], v[44:47], v[24:27], v[136:139]
    ds_read_b64_tr_b16 v[86:87], v12 offset:30976
    v_mfma_f32_16x16x32_bf16 v[140:143], v[44:47], v[28:31], v[140:143]
    ds_read_b64_tr_b16 v[88:89], v13 offset:30720
    v_mfma_f32_16x16x32_bf16 v[144:147], v[44:47], v[32:35], v[144:147]
    ds_read_b64_tr_b16 v[90:91], v13 offset:30976
    s_waitcnt lgkmcnt(15)
    v_mfma_f32_16x16x32_bf16 v[160:163], v[48:51], v[32:35], v[160:163]
    ds_read_b64_tr_b16 v[92:93], v12 offset:34816
    v_mfma_f32_16x16x32_bf16 v[156:159], v[48:51], v[28:31], v[156:159]
    ds_read_b64_tr_b16 v[94:95], v12 offset:35072
    v_mfma_f32_16x16x32_bf16 v[152:155], v[48:51], v[24:27], v[152:155]
    ds_read_b64_tr_b16 v[96:97], v13 offset:34816
    v_mfma_f32_16x16x32_bf16 v[148:151], v[48:51], v[20:23], v[148:151]
    ds_read_b64_tr_b16 v[98:99], v13 offset:35072
    s_waitcnt lgkmcnt(15)
    v_mfma_f32_16x16x32_bf16 v[164:167], v[20:23], v[52:55], v[164:167]
    v_mfma_f32_16x16x32_bf16 v[168:171], v[24:27], v[52:55], v[168:171]
    v_mfma_f32_16x16x32_bf16 v[172:175], v[28:31], v[52:55], v[172:175]
    v_mfma_f32_16x16x32_bf16 v[176:179], v[32:35], v[52:55], v[176:179]
    v_mfma_f32_16x16x32_bf16 v[192:195], v[32:35], v[56:59], v[192:195]
    v_mfma_f32_16x16x32_bf16 v[188:191], v[28:31], v[56:59], v[188:191]
    v_mfma_f32_16x16x32_bf16 v[184:187], v[24:27], v[56:59], v[184:187]
    v_mfma_f32_16x16x32_bf16 v[180:183], v[20:23], v[56:59], v[180:183]
    s_waitcnt lgkmcnt(13)
    v_mfma_f32_16x16x32_bf16 v[100:103], v[76:79], v[60:63], v[100:103]
    s_waitcnt lgkmcnt(12)
    v_mfma_f32_16x16x32_bf16 v[104:107], v[76:79], v[64:67], v[104:107]
    s_waitcnt lgkmcnt(11)
    v_mfma_f32_16x16x32_bf16 v[108:111], v[76:79], v[68:71], v[108:111]
    s_waitcnt lgkmcnt(0)
    s_barrier
    v_mfma_f32_16x16x32_bf16 v[112:115], v[76:79], v[72:75], v[112:115]
    ds_read_b128 v[20:23], v8 offset:32768
    v_mfma_f32_16x16x32_bf16 v[128:131], v[80:83], v[72:75], v[128:131]
    ds_read_b64_tr_b16 v[36:37], v12 offset:36864
    v_mfma_f32_16x16x32_bf16 v[124:127], v[80:83], v[68:71], v[124:127]
    ds_read_b64_tr_b16 v[38:39], v12 offset:37120
    v_mfma_f32_16x16x32_bf16 v[120:123], v[80:83], v[64:67], v[120:123]
    ds_read_b128 v[24:27], v8 offset:34816
    v_mfma_f32_16x16x32_bf16 v[116:119], v[80:83], v[60:63], v[116:119]
    ds_read_b128 v[28:31], v8 offset:36864
    v_mfma_f32_16x16x32_bf16 v[132:135], v[84:87], v[60:63], v[132:135]
    ds_read_b128 v[32:35], v8 offset:38912
    v_mfma_f32_16x16x32_bf16 v[136:139], v[84:87], v[64:67], v[136:139]
    ds_read_b64_tr_b16 v[40:41], v13 offset:36864
    v_mfma_f32_16x16x32_bf16 v[140:143], v[84:87], v[68:71], v[140:143]
    ds_read_b64_tr_b16 v[42:43], v13 offset:37120
    v_mfma_f32_16x16x32_bf16 v[144:147], v[84:87], v[72:75], v[144:147]
    ds_read_b64_tr_b16 v[44:45], v12 offset:40960
    v_mfma_f32_16x16x32_bf16 v[160:163], v[88:91], v[72:75], v[160:163]
    ds_read_b64_tr_b16 v[46:47], v12 offset:41216
    v_mfma_f32_16x16x32_bf16 v[156:159], v[88:91], v[68:71], v[156:159]
    ds_read_b64_tr_b16 v[48:49], v13 offset:40960
    v_mfma_f32_16x16x32_bf16 v[152:155], v[88:91], v[64:67], v[152:155]
    ds_read_b64_tr_b16 v[50:51], v13 offset:41216
    v_mfma_f32_16x16x32_bf16 v[148:151], v[88:91], v[60:63], v[148:151]
    ds_read_b64_tr_b16 v[52:53], v12 offset:45056
    v_mfma_f32_16x16x32_bf16 v[164:167], v[60:63], v[92:95], v[164:167]
    ds_read_b64_tr_b16 v[54:55], v12 offset:45312
    v_mfma_f32_16x16x32_bf16 v[168:171], v[64:67], v[92:95], v[168:171]
    ds_read_b64_tr_b16 v[56:57], v13 offset:45056
    v_mfma_f32_16x16x32_bf16 v[172:175], v[68:71], v[92:95], v[172:175]
    ds_read_b64_tr_b16 v[58:59], v13 offset:45312
    v_mfma_f32_16x16x32_bf16 v[176:179], v[72:75], v[92:95], v[176:179]
    v_mfma_f32_16x16x32_bf16 v[192:195], v[72:75], v[96:99], v[192:195]
    v_mfma_f32_16x16x32_bf16 v[188:191], v[68:71], v[96:99], v[188:191]
    v_mfma_f32_16x16x32_bf16 v[184:187], v[64:67], v[96:99], v[184:187]
    v_mfma_f32_16x16x32_bf16 v[180:183], v[60:63], v[96:99], v[180:183]
    s_waitcnt lgkmcnt(13)
    v_mfma_f32_16x16x32_bf16 v[100:103], v[36:39], v[20:23], v[100:103]
    ds_read_b128 v[60:63], v9 offset:32768
    s_waitcnt lgkmcnt(13)
    v_mfma_f32_16x16x32_bf16 v[104:107], v[36:39], v[24:27], v[104:107]
    ds_read_b64_tr_b16 v[76:77], v12 offset:38912
    s_waitcnt lgkmcnt(13)
    v_mfma_f32_16x16x32_bf16 v[108:111], v[36:39], v[28:31], v[108:111]
    ds_read_b64_tr_b16 v[78:79], v12 offset:39168
    s_waitcnt lgkmcnt(13)
    v_mfma_f32_16x16x32_bf16 v[112:115], v[36:39], v[32:35], v[112:115]
    ds_read_b128 v[64:67], v9 offset:34816
    s_waitcnt lgkmcnt(12)
    v_mfma_f32_16x16x32_bf16 v[128:131], v[40:43], v[32:35], v[128:131]
    ds_read_b128 v[68:71], v9 offset:36864
    v_mfma_f32_16x16x32_bf16 v[124:127], v[40:43], v[28:31], v[124:127]
    ds_read_b128 v[72:75], v9 offset:38912
    v_mfma_f32_16x16x32_bf16 v[120:123], v[40:43], v[24:27], v[120:123]
    ds_read_b64_tr_b16 v[80:81], v13 offset:38912
    v_mfma_f32_16x16x32_bf16 v[116:119], v[40:43], v[20:23], v[116:119]
    ds_read_b64_tr_b16 v[82:83], v13 offset:39168
    s_waitcnt lgkmcnt(14)
    v_mfma_f32_16x16x32_bf16 v[132:135], v[44:47], v[20:23], v[132:135]
    ds_read_b64_tr_b16 v[84:85], v12 offset:43008
    v_mfma_f32_16x16x32_bf16 v[136:139], v[44:47], v[24:27], v[136:139]
    ds_read_b64_tr_b16 v[86:87], v12 offset:43264
    v_mfma_f32_16x16x32_bf16 v[140:143], v[44:47], v[28:31], v[140:143]
    ds_read_b64_tr_b16 v[88:89], v13 offset:43008
    v_mfma_f32_16x16x32_bf16 v[144:147], v[44:47], v[32:35], v[144:147]
    ds_read_b64_tr_b16 v[90:91], v13 offset:43264
    s_waitcnt lgkmcnt(15)
    v_mfma_f32_16x16x32_bf16 v[160:163], v[48:51], v[32:35], v[160:163]
    ds_read_b64_tr_b16 v[92:93], v12 offset:47104
    v_mfma_f32_16x16x32_bf16 v[156:159], v[48:51], v[28:31], v[156:159]
    ds_read_b64_tr_b16 v[94:95], v12 offset:47360
    v_mfma_f32_16x16x32_bf16 v[152:155], v[48:51], v[24:27], v[152:155]
    ds_read_b64_tr_b16 v[96:97], v13 offset:47104
    v_mfma_f32_16x16x32_bf16 v[148:151], v[48:51], v[20:23], v[148:151]
    ds_read_b64_tr_b16 v[98:99], v13 offset:47360
    s_waitcnt lgkmcnt(15)
    v_mfma_f32_16x16x32_bf16 v[164:167], v[20:23], v[52:55], v[164:167]
    v_mfma_f32_16x16x32_bf16 v[168:171], v[24:27], v[52:55], v[168:171]
    v_mfma_f32_16x16x32_bf16 v[172:175], v[28:31], v[52:55], v[172:175]
    v_mfma_f32_16x16x32_bf16 v[176:179], v[32:35], v[52:55], v[176:179]
    v_mfma_f32_16x16x32_bf16 v[192:195], v[32:35], v[56:59], v[192:195]
    v_mfma_f32_16x16x32_bf16 v[188:191], v[28:31], v[56:59], v[188:191]
    v_mfma_f32_16x16x32_bf16 v[184:187], v[24:27], v[56:59], v[184:187]
    v_mfma_f32_16x16x32_bf16 v[180:183], v[20:23], v[56:59], v[180:183]
    s_waitcnt lgkmcnt(13)
    v_mfma_f32_16x16x32_bf16 v[100:103], v[76:79], v[60:63], v[100:103]
    s_waitcnt lgkmcnt(12)
    v_mfma_f32_16x16x32_bf16 v[104:107], v[76:79], v[64:67], v[104:107]
    s_waitcnt lgkmcnt(11)
    v_mfma_f32_16x16x32_bf16 v[108:111], v[76:79], v[68:71], v[108:111]
    s_waitcnt lgkmcnt(0)
    s_barrier
    v_mfma_f32_16x16x32_bf16 v[112:115], v[76:79], v[72:75], v[112:115]
    ds_read_b128 v[20:23], v10 offset:0
    v_mfma_f32_16x16x32_bf16 v[128:131], v[80:83], v[72:75], v[128:131]
    ds_read_b64_tr_b16 v[36:37], v12 offset:0
    v_mfma_f32_16x16x32_bf16 v[124:127], v[80:83], v[68:71], v[124:127]
    ds_read_b64_tr_b16 v[38:39], v12 offset:256
    v_mfma_f32_16x16x32_bf16 v[120:123], v[80:83], v[64:67], v[120:123]
    ds_read_b128 v[24:27], v10 offset:2048
    v_mfma_f32_16x16x32_bf16 v[116:119], v[80:83], v[60:63], v[116:119]
    ds_read_b128 v[28:31], v10 offset:4096
    v_mfma_f32_16x16x32_bf16 v[132:135], v[84:87], v[60:63], v[132:135]
    ds_read_b128 v[32:35], v10 offset:6144
    v_mfma_f32_16x16x32_bf16 v[136:139], v[84:87], v[64:67], v[136:139]
    ds_read_b64_tr_b16 v[40:41], v13 offset:0
    v_mfma_f32_16x16x32_bf16 v[140:143], v[84:87], v[68:71], v[140:143]
    ds_read_b64_tr_b16 v[42:43], v13 offset:256
    v_mfma_f32_16x16x32_bf16 v[144:147], v[84:87], v[72:75], v[144:147]
    ds_read_b64_tr_b16 v[44:45], v12 offset:4096
    v_mfma_f32_16x16x32_bf16 v[160:163], v[88:91], v[72:75], v[160:163]
    ds_read_b64_tr_b16 v[46:47], v12 offset:4352
    v_mfma_f32_16x16x32_bf16 v[156:159], v[88:91], v[68:71], v[156:159]
    ds_read_b64_tr_b16 v[48:49], v13 offset:4096
    v_mfma_f32_16x16x32_bf16 v[152:155], v[88:91], v[64:67], v[152:155]
    ds_read_b64_tr_b16 v[50:51], v13 offset:4352
    v_mfma_f32_16x16x32_bf16 v[148:151], v[88:91], v[60:63], v[148:151]
    ds_read_b64_tr_b16 v[52:53], v12 offset:8192
    v_mfma_f32_16x16x32_bf16 v[164:167], v[60:63], v[92:95], v[164:167]
    ds_read_b64_tr_b16 v[54:55], v12 offset:8448
    v_mfma_f32_16x16x32_bf16 v[168:171], v[64:67], v[92:95], v[168:171]
    ds_read_b64_tr_b16 v[56:57], v13 offset:8192
    v_mfma_f32_16x16x32_bf16 v[172:175], v[68:71], v[92:95], v[172:175]
    ds_read_b64_tr_b16 v[58:59], v13 offset:8448
    v_mfma_f32_16x16x32_bf16 v[176:179], v[72:75], v[92:95], v[176:179]
    v_mfma_f32_16x16x32_bf16 v[192:195], v[72:75], v[96:99], v[192:195]
    v_mfma_f32_16x16x32_bf16 v[188:191], v[68:71], v[96:99], v[188:191]
    v_mfma_f32_16x16x32_bf16 v[184:187], v[64:67], v[96:99], v[184:187]
    v_mfma_f32_16x16x32_bf16 v[180:183], v[60:63], v[96:99], v[180:183]
    s_waitcnt lgkmcnt(13)
    v_mfma_f32_16x16x32_bf16 v[100:103], v[36:39], v[20:23], v[100:103]
    ds_read_b128 v[60:63], v11 offset:0
    s_waitcnt lgkmcnt(13)
    v_mfma_f32_16x16x32_bf16 v[104:107], v[36:39], v[24:27], v[104:107]
    ds_read_b64_tr_b16 v[76:77], v12 offset:2048
    s_waitcnt lgkmcnt(13)
    v_mfma_f32_16x16x32_bf16 v[108:111], v[36:39], v[28:31], v[108:111]
    ds_read_b64_tr_b16 v[78:79], v12 offset:2304
    s_waitcnt lgkmcnt(13)
    v_mfma_f32_16x16x32_bf16 v[112:115], v[36:39], v[32:35], v[112:115]
    ds_read_b128 v[64:67], v11 offset:2048
    s_waitcnt lgkmcnt(12)
    v_mfma_f32_16x16x32_bf16 v[128:131], v[40:43], v[32:35], v[128:131]
    ds_read_b128 v[68:71], v11 offset:4096
    v_mfma_f32_16x16x32_bf16 v[124:127], v[40:43], v[28:31], v[124:127]
    ds_read_b128 v[72:75], v11 offset:6144
    v_mfma_f32_16x16x32_bf16 v[120:123], v[40:43], v[24:27], v[120:123]
    ds_read_b64_tr_b16 v[80:81], v13 offset:2048
    v_mfma_f32_16x16x32_bf16 v[116:119], v[40:43], v[20:23], v[116:119]
    ds_read_b64_tr_b16 v[82:83], v13 offset:2304
    s_waitcnt lgkmcnt(14)
    v_mfma_f32_16x16x32_bf16 v[132:135], v[44:47], v[20:23], v[132:135]
    ds_read_b64_tr_b16 v[84:85], v12 offset:6144
    v_mfma_f32_16x16x32_bf16 v[136:139], v[44:47], v[24:27], v[136:139]
    ds_read_b64_tr_b16 v[86:87], v12 offset:6400
    v_mfma_f32_16x16x32_bf16 v[140:143], v[44:47], v[28:31], v[140:143]
    ds_read_b64_tr_b16 v[88:89], v13 offset:6144
    v_mfma_f32_16x16x32_bf16 v[144:147], v[44:47], v[32:35], v[144:147]
    ds_read_b64_tr_b16 v[90:91], v13 offset:6400
    s_waitcnt lgkmcnt(15)
    v_mfma_f32_16x16x32_bf16 v[160:163], v[48:51], v[32:35], v[160:163]
    ds_read_b64_tr_b16 v[92:93], v12 offset:10240
    v_mfma_f32_16x16x32_bf16 v[156:159], v[48:51], v[28:31], v[156:159]
    ds_read_b64_tr_b16 v[94:95], v12 offset:10496
    v_mfma_f32_16x16x32_bf16 v[152:155], v[48:51], v[24:27], v[152:155]
    ds_read_b64_tr_b16 v[96:97], v13 offset:10240
    v_mfma_f32_16x16x32_bf16 v[148:151], v[48:51], v[20:23], v[148:151]
    ds_read_b64_tr_b16 v[98:99], v13 offset:10496
    s_waitcnt lgkmcnt(15)
    v_mfma_f32_16x16x32_bf16 v[164:167], v[20:23], v[52:55], v[164:167]
    v_mfma_f32_16x16x32_bf16 v[168:171], v[24:27], v[52:55], v[168:171]
    v_mfma_f32_16x16x32_bf16 v[172:175], v[28:31], v[52:55], v[172:175]
    v_mfma_f32_16x16x32_bf16 v[176:179], v[32:35], v[52:55], v[176:179]
    v_mfma_f32_16x16x32_bf16 v[192:195], v[32:35], v[56:59], v[192:195]
    v_mfma_f32_16x16x32_bf16 v[188:191], v[28:31], v[56:59], v[188:191]
    v_mfma_f32_16x16x32_bf16 v[184:187], v[24:27], v[56:59], v[184:187]
    v_mfma_f32_16x16x32_bf16 v[180:183], v[20:23], v[56:59], v[180:183]
    s_waitcnt lgkmcnt(13)
    v_mfma_f32_16x16x32_bf16 v[100:103], v[76:79], v[60:63], v[100:103]
    s_waitcnt lgkmcnt(12)
    v_mfma_f32_16x16x32_bf16 v[104:107], v[76:79], v[64:67], v[104:107]
    s_waitcnt lgkmcnt(11)
    v_mfma_f32_16x16x32_bf16 v[108:111], v[76:79], v[68:71], v[108:111]
    s_waitcnt lgkmcnt(0)
    s_barrier
    v_mfma_f32_16x16x32_bf16 v[112:115], v[76:79], v[72:75], v[112:115]
    ds_read_b128 v[20:23], v8 offset:0
    v_mfma_f32_16x16x32_bf16 v[128:131], v[80:83], v[72:75], v[128:131]
    ds_read_b64_tr_b16 v[36:37], v12 offset:12288
    v_mfma_f32_16x16x32_bf16 v[124:127], v[80:83], v[68:71], v[124:127]
    ds_read_b64_tr_b16 v[38:39], v12 offset:12544
    v_mfma_f32_16x16x32_bf16 v[120:123], v[80:83], v[64:67], v[120:123]
    ds_read_b128 v[24:27], v8 offset:2048
    v_mfma_f32_16x16x32_bf16 v[116:119], v[80:83], v[60:63], v[116:119]
    ds_read_b128 v[28:31], v8 offset:4096
    v_mfma_f32_16x16x32_bf16 v[132:135], v[84:87], v[60:63], v[132:135]
    ds_read_b128 v[32:35], v8 offset:6144
    v_mfma_f32_16x16x32_bf16 v[136:139], v[84:87], v[64:67], v[136:139]
    ds_read_b64_tr_b16 v[40:41], v13 offset:12288
    v_mfma_f32_16x16x32_bf16 v[140:143], v[84:87], v[68:71], v[140:143]
    ds_read_b64_tr_b16 v[42:43], v13 offset:12544
    v_mfma_f32_16x16x32_bf16 v[144:147], v[84:87], v[72:75], v[144:147]
    ds_read_b64_tr_b16 v[44:45], v12 offset:16384
    v_mfma_f32_16x16x32_bf16 v[160:163], v[88:91], v[72:75], v[160:163]
    ds_read_b64_tr_b16 v[46:47], v12 offset:16640
    v_mfma_f32_16x16x32_bf16 v[156:159], v[88:91], v[68:71], v[156:159]
    ds_read_b64_tr_b16 v[48:49], v13 offset:16384
    v_mfma_f32_16x16x32_bf16 v[152:155], v[88:91], v[64:67], v[152:155]
    ds_read_b64_tr_b16 v[50:51], v13 offset:16640
    v_mfma_f32_16x16x32_bf16 v[148:151], v[88:91], v[60:63], v[148:151]
    ds_read_b64_tr_b16 v[52:53], v12 offset:20480
    v_mfma_f32_16x16x32_bf16 v[164:167], v[60:63], v[92:95], v[164:167]
    ds_read_b64_tr_b16 v[54:55], v12 offset:20736
    v_mfma_f32_16x16x32_bf16 v[168:171], v[64:67], v[92:95], v[168:171]
    ds_read_b64_tr_b16 v[56:57], v13 offset:20480
    v_mfma_f32_16x16x32_bf16 v[172:175], v[68:71], v[92:95], v[172:175]
    ds_read_b64_tr_b16 v[58:59], v13 offset:20736
    v_mfma_f32_16x16x32_bf16 v[176:179], v[72:75], v[92:95], v[176:179]
    v_mfma_f32_16x16x32_bf16 v[192:195], v[72:75], v[96:99], v[192:195]
    v_mfma_f32_16x16x32_bf16 v[188:191], v[68:71], v[96:99], v[188:191]
    v_mfma_f32_16x16x32_bf16 v[184:187], v[64:67], v[96:99], v[184:187]
    v_mfma_f32_16x16x32_bf16 v[180:183], v[60:63], v[96:99], v[180:183]
    s_waitcnt lgkmcnt(13)
    v_mfma_f32_16x16x32_bf16 v[100:103], v[36:39], v[20:23], v[100:103]
    ds_read_b128 v[60:63], v9 offset:0
    s_waitcnt lgkmcnt(13)
    v_mfma_f32_16x16x32_bf16 v[104:107], v[36:39], v[24:27], v[104:107]
    ds_read_b64_tr_b16 v[76:77], v12 offset:14336
    s_waitcnt lgkmcnt(13)
    v_mfma_f32_16x16x32_bf16 v[108:111], v[36:39], v[28:31], v[108:111]
    ds_read_b64_tr_b16 v[78:79], v12 offset:14592
    s_waitcnt lgkmcnt(13)
    v_mfma_f32_16x16x32_bf16 v[112:115], v[36:39], v[32:35], v[112:115]
    ds_read_b128 v[64:67], v9 offset:2048
    s_waitcnt lgkmcnt(12)
    v_mfma_f32_16x16x32_bf16 v[128:131], v[40:43], v[32:35], v[128:131]
    ds_read_b128 v[68:71], v9 offset:4096
    v_mfma_f32_16x16x32_bf16 v[124:127], v[40:43], v[28:31], v[124:127]
    ds_read_b128 v[72:75], v9 offset:6144
    v_mfma_f32_16x16x32_bf16 v[120:123], v[40:43], v[24:27], v[120:123]
    ds_read_b64_tr_b16 v[80:81], v13 offset:14336
    v_mfma_f32_16x16x32_bf16 v[116:119], v[40:43], v[20:23], v[116:119]
    ds_read_b64_tr_b16 v[82:83], v13 offset:14592
    s_waitcnt lgkmcnt(14)
    v_mfma_f32_16x16x32_bf16 v[132:135], v[44:47], v[20:23], v[132:135]
    ds_read_b64_tr_b16 v[84:85], v12 offset:18432
    v_mfma_f32_16x16x32_bf16 v[136:139], v[44:47], v[24:27], v[136:139]
    ds_read_b64_tr_b16 v[86:87], v12 offset:18688
    v_mfma_f32_16x16x32_bf16 v[140:143], v[44:47], v[28:31], v[140:143]
    ds_read_b64_tr_b16 v[88:89], v13 offset:18432
    v_mfma_f32_16x16x32_bf16 v[144:147], v[44:47], v[32:35], v[144:147]
    ds_read_b64_tr_b16 v[90:91], v13 offset:18688
    s_waitcnt lgkmcnt(15)
    v_mfma_f32_16x16x32_bf16 v[160:163], v[48:51], v[32:35], v[160:163]
    ds_read_b64_tr_b16 v[92:93], v12 offset:22528
    v_mfma_f32_16x16x32_bf16 v[156:159], v[48:51], v[28:31], v[156:159]
    ds_read_b64_tr_b16 v[94:95], v12 offset:22784
    v_mfma_f32_16x16x32_bf16 v[152:155], v[48:51], v[24:27], v[152:155]
    ds_read_b64_tr_b16 v[96:97], v13 offset:22528
    v_mfma_f32_16x16x32_bf16 v[148:151], v[48:51], v[20:23], v[148:151]
    ds_read_b64_tr_b16 v[98:99], v13 offset:22784
    s_waitcnt lgkmcnt(15)
    v_mfma_f32_16x16x32_bf16 v[164:167], v[20:23], v[52:55], v[164:167]
    v_mfma_f32_16x16x32_bf16 v[168:171], v[24:27], v[52:55], v[168:171]
    v_mfma_f32_16x16x32_bf16 v[172:175], v[28:31], v[52:55], v[172:175]
    v_mfma_f32_16x16x32_bf16 v[176:179], v[32:35], v[52:55], v[176:179]
    v_mfma_f32_16x16x32_bf16 v[192:195], v[32:35], v[56:59], v[192:195]
    v_mfma_f32_16x16x32_bf16 v[188:191], v[28:31], v[56:59], v[188:191]
    v_mfma_f32_16x16x32_bf16 v[184:187], v[24:27], v[56:59], v[184:187]
    v_mfma_f32_16x16x32_bf16 v[180:183], v[20:23], v[56:59], v[180:183]
    s_waitcnt lgkmcnt(13)
    v_mfma_f32_16x16x32_bf16 v[100:103], v[76:79], v[60:63], v[100:103]
    s_waitcnt lgkmcnt(12)
    v_mfma_f32_16x16x32_bf16 v[104:107], v[76:79], v[64:67], v[104:107]
    s_waitcnt lgkmcnt(11)
    v_mfma_f32_16x16x32_bf16 v[108:111], v[76:79], v[68:71], v[108:111]
    s_waitcnt lgkmcnt(0)
    s_barrier
    v_mfma_f32_16x16x32_bf16 v[112:115], v[76:79], v[72:75], v[112:115]
    ds_read_b128 v[20:23], v8 offset:32768
    v_mfma_f32_16x16x32_bf16 v[128:131], v[80:83], v[72:75], v[128:131]
    ds_read_b64_tr_b16 v[36:37], v12 offset:24576
    v_mfma_f32_16x16x32_bf16 v[124:127], v[80:83], v[68:71], v[124:127]
    ds_read_b64_tr_b16 v[38:39], v12 offset:24832
    v_mfma_f32_16x16x32_bf16 v[120:123], v[80:83], v[64:67], v[120:123]
    ds_read_b128 v[24:27], v8 offset:34816
    v_mfma_f32_16x16x32_bf16 v[116:119], v[80:83], v[60:63], v[116:119]
    ds_read_b128 v[28:31], v8 offset:36864
    v_mfma_f32_16x16x32_bf16 v[132:135], v[84:87], v[60:63], v[132:135]
    ds_read_b128 v[32:35], v8 offset:38912
    v_mfma_f32_16x16x32_bf16 v[136:139], v[84:87], v[64:67], v[136:139]
    ds_read_b64_tr_b16 v[40:41], v13 offset:24576
    v_mfma_f32_16x16x32_bf16 v[140:143], v[84:87], v[68:71], v[140:143]
    ds_read_b64_tr_b16 v[42:43], v13 offset:24832
    v_mfma_f32_16x16x32_bf16 v[144:147], v[84:87], v[72:75], v[144:147]
    ds_read_b64_tr_b16 v[44:45], v12 offset:28672
    v_mfma_f32_16x16x32_bf16 v[160:163], v[88:91], v[72:75], v[160:163]
    ds_read_b64_tr_b16 v[46:47], v12 offset:28928
    v_mfma_f32_16x16x32_bf16 v[156:159], v[88:91], v[68:71], v[156:159]
    ds_read_b64_tr_b16 v[48:49], v13 offset:28672
    v_mfma_f32_16x16x32_bf16 v[152:155], v[88:91], v[64:67], v[152:155]
    ds_read_b64_tr_b16 v[50:51], v13 offset:28928
    v_mfma_f32_16x16x32_bf16 v[148:151], v[88:91], v[60:63], v[148:151]
    ds_read_b64_tr_b16 v[52:53], v12 offset:32768
    v_mfma_f32_16x16x32_bf16 v[164:167], v[60:63], v[92:95], v[164:167]
    ds_read_b64_tr_b16 v[54:55], v12 offset:33024
    v_mfma_f32_16x16x32_bf16 v[168:171], v[64:67], v[92:95], v[168:171]
    ds_read_b64_tr_b16 v[56:57], v13 offset:32768
    v_mfma_f32_16x16x32_bf16 v[172:175], v[68:71], v[92:95], v[172:175]
    ds_read_b64_tr_b16 v[58:59], v13 offset:33024
    v_mfma_f32_16x16x32_bf16 v[176:179], v[72:75], v[92:95], v[176:179]
    v_mfma_f32_16x16x32_bf16 v[192:195], v[72:75], v[96:99], v[192:195]
    v_mfma_f32_16x16x32_bf16 v[188:191], v[68:71], v[96:99], v[188:191]
    v_mfma_f32_16x16x32_bf16 v[184:187], v[64:67], v[96:99], v[184:187]
    v_mfma_f32_16x16x32_bf16 v[180:183], v[60:63], v[96:99], v[180:183]
    s_waitcnt lgkmcnt(13)
    v_mfma_f32_16x16x32_bf16 v[100:103], v[36:39], v[20:23], v[100:103]
    ds_read_b128 v[60:63], v9 offset:32768
    s_waitcnt lgkmcnt(13)
    v_mfma_f32_16x16x32_bf16 v[104:107], v[36:39], v[24:27], v[104:107]
    ds_read_b64_tr_b16 v[76:77], v12 offset:26624
    s_waitcnt lgkmcnt(13)
    v_mfma_f32_16x16x32_bf16 v[108:111], v[36:39], v[28:31], v[108:111]
    ds_read_b64_tr_b16 v[78:79], v12 offset:26880
    s_waitcnt lgkmcnt(13)
    v_mfma_f32_16x16x32_bf16 v[112:115], v[36:39], v[32:35], v[112:115]
    ds_read_b128 v[64:67], v9 offset:34816
    s_waitcnt lgkmcnt(12)
    v_mfma_f32_16x16x32_bf16 v[128:131], v[40:43], v[32:35], v[128:131]
    ds_read_b128 v[68:71], v9 offset:36864
    v_mfma_f32_16x16x32_bf16 v[124:127], v[40:43], v[28:31], v[124:127]
    ds_read_b128 v[72:75], v9 offset:38912
    v_mfma_f32_16x16x32_bf16 v[120:123], v[40:43], v[24:27], v[120:123]
    ds_read_b64_tr_b16 v[80:81], v13 offset:26624
    v_mfma_f32_16x16x32_bf16 v[116:119], v[40:43], v[20:23], v[116:119]
    ds_read_b64_tr_b16 v[82:83], v13 offset:26880
    s_waitcnt lgkmcnt(14)
    v_mfma_f32_16x16x32_bf16 v[132:135], v[44:47], v[20:23], v[132:135]
    ds_read_b64_tr_b16 v[84:85], v12 offset:30720
    v_mfma_f32_16x16x32_bf16 v[136:139], v[44:47], v[24:27], v[136:139]
    ds_read_b64_tr_b16 v[86:87], v12 offset:30976
    v_mfma_f32_16x16x32_bf16 v[140:143], v[44:47], v[28:31], v[140:143]
    ds_read_b64_tr_b16 v[88:89], v13 offset:30720
    v_mfma_f32_16x16x32_bf16 v[144:147], v[44:47], v[32:35], v[144:147]
    ds_read_b64_tr_b16 v[90:91], v13 offset:30976
    s_waitcnt lgkmcnt(15)
    v_mfma_f32_16x16x32_bf16 v[160:163], v[48:51], v[32:35], v[160:163]
    ds_read_b64_tr_b16 v[92:93], v12 offset:34816
    v_mfma_f32_16x16x32_bf16 v[156:159], v[48:51], v[28:31], v[156:159]
    ds_read_b64_tr_b16 v[94:95], v12 offset:35072
    v_mfma_f32_16x16x32_bf16 v[152:155], v[48:51], v[24:27], v[152:155]
    ds_read_b64_tr_b16 v[96:97], v13 offset:34816
    v_mfma_f32_16x16x32_bf16 v[148:151], v[48:51], v[20:23], v[148:151]
    ds_read_b64_tr_b16 v[98:99], v13 offset:35072
    s_waitcnt lgkmcnt(15)
    v_mfma_f32_16x16x32_bf16 v[164:167], v[20:23], v[52:55], v[164:167]
    v_mfma_f32_16x16x32_bf16 v[168:171], v[24:27], v[52:55], v[168:171]
    v_mfma_f32_16x16x32_bf16 v[172:175], v[28:31], v[52:55], v[172:175]
    v_mfma_f32_16x16x32_bf16 v[176:179], v[32:35], v[52:55], v[176:179]
    v_mfma_f32_16x16x32_bf16 v[192:195], v[32:35], v[56:59], v[192:195]
    v_mfma_f32_16x16x32_bf16 v[188:191], v[28:31], v[56:59], v[188:191]
    v_mfma_f32_16x16x32_bf16 v[184:187], v[24:27], v[56:59], v[184:187]
    v_mfma_f32_16x16x32_bf16 v[180:183], v[20:23], v[56:59], v[180:183]
    s_waitcnt lgkmcnt(13)
    v_mfma_f32_16x16x32_bf16 v[100:103], v[76:79], v[60:63], v[100:103]
    s_waitcnt lgkmcnt(12)
    v_mfma_f32_16x16x32_bf16 v[104:107], v[76:79], v[64:67], v[104:107]
    s_waitcnt lgkmcnt(11)
    v_mfma_f32_16x16x32_bf16 v[108:111], v[76:79], v[68:71], v[108:111]
    s_waitcnt lgkmcnt(0)
    s_barrier
    v_mfma_f32_16x16x32_bf16 v[112:115], v[76:79], v[72:75], v[112:115]
    ds_read_b128 v[20:23], v10 offset:0
    v_mfma_f32_16x16x32_bf16 v[128:131], v[80:83], v[72:75], v[128:131]
    ds_read_b64_tr_b16 v[36:37], v12 offset:36864
    v_mfma_f32_16x16x32_bf16 v[124:127], v[80:83], v[68:71], v[124:127]
    ds_read_b64_tr_b16 v[38:39], v12 offset:37120
    v_mfma_f32_16x16x32_bf16 v[120:123], v[80:83], v[64:67], v[120:123]
    ds_read_b128 v[24:27], v10 offset:2048
    v_mfma_f32_16x16x32_bf16 v[116:119], v[80:83], v[60:63], v[116:119]
    ds_read_b128 v[28:31], v10 offset:4096
    v_mfma_f32_16x16x32_bf16 v[132:135], v[84:87], v[60:63], v[132:135]
    ds_read_b128 v[32:35], v10 offset:6144
    v_mfma_f32_16x16x32_bf16 v[136:139], v[84:87], v[64:67], v[136:139]
    ds_read_b64_tr_b16 v[40:41], v13 offset:36864
    v_mfma_f32_16x16x32_bf16 v[140:143], v[84:87], v[68:71], v[140:143]
    ds_read_b64_tr_b16 v[42:43], v13 offset:37120
    v_mfma_f32_16x16x32_bf16 v[144:147], v[84:87], v[72:75], v[144:147]
    ds_read_b64_tr_b16 v[44:45], v12 offset:40960
    v_mfma_f32_16x16x32_bf16 v[160:163], v[88:91], v[72:75], v[160:163]
    ds_read_b64_tr_b16 v[46:47], v12 offset:41216
    v_mfma_f32_16x16x32_bf16 v[156:159], v[88:91], v[68:71], v[156:159]
    ds_read_b64_tr_b16 v[48:49], v13 offset:40960
    v_mfma_f32_16x16x32_bf16 v[152:155], v[88:91], v[64:67], v[152:155]
    ds_read_b64_tr_b16 v[50:51], v13 offset:41216
    v_mfma_f32_16x16x32_bf16 v[148:151], v[88:91], v[60:63], v[148:151]
    ds_read_b64_tr_b16 v[52:53], v12 offset:45056
    v_mfma_f32_16x16x32_bf16 v[164:167], v[60:63], v[92:95], v[164:167]
    ds_read_b64_tr_b16 v[54:55], v12 offset:45312
    v_mfma_f32_16x16x32_bf16 v[168:171], v[64:67], v[92:95], v[168:171]
    ds_read_b64_tr_b16 v[56:57], v13 offset:45056
    v_mfma_f32_16x16x32_bf16 v[172:175], v[68:71], v[92:95], v[172:175]
    ds_read_b64_tr_b16 v[58:59], v13 offset:45312
    v_mfma_f32_16x16x32_bf16 v[176:179], v[72:75], v[92:95], v[176:179]
    v_mfma_f32_16x16x32_bf16 v[192:195], v[72:75], v[96:99], v[192:195]
    v_mfma_f32_16x16x32_bf16 v[188:191], v[68:71], v[96:99], v[188:191]
    v_mfma_f32_16x16x32_bf16 v[184:187], v[64:67], v[96:99], v[184:187]
    v_mfma_f32_16x16x32_bf16 v[180:183], v[60:63], v[96:99], v[180:183]
    s_waitcnt lgkmcnt(13)
    v_mfma_f32_16x16x32_bf16 v[100:103], v[36:39], v[20:23], v[100:103]
    ds_read_b128 v[60:63], v11 offset:0
    s_waitcnt lgkmcnt(13)
    v_mfma_f32_16x16x32_bf16 v[104:107], v[36:39], v[24:27], v[104:107]
    ds_read_b64_tr_b16 v[76:77], v12 offset:38912
    s_waitcnt lgkmcnt(13)
    v_mfma_f32_16x16x32_bf16 v[108:111], v[36:39], v[28:31], v[108:111]
    ds_read_b64_tr_b16 v[78:79], v12 offset:39168
    s_waitcnt lgkmcnt(13)
    v_mfma_f32_16x16x32_bf16 v[112:115], v[36:39], v[32:35], v[112:115]
    ds_read_b128 v[64:67], v11 offset:2048
    s_waitcnt lgkmcnt(12)
    v_mfma_f32_16x16x32_bf16 v[128:131], v[40:43], v[32:35], v[128:131]
    ds_read_b128 v[68:71], v11 offset:4096
    v_mfma_f32_16x16x32_bf16 v[124:127], v[40:43], v[28:31], v[124:127]
    ds_read_b128 v[72:75], v11 offset:6144
    v_mfma_f32_16x16x32_bf16 v[120:123], v[40:43], v[24:27], v[120:123]
    ds_read_b64_tr_b16 v[80:81], v13 offset:38912
    v_mfma_f32_16x16x32_bf16 v[116:119], v[40:43], v[20:23], v[116:119]
    ds_read_b64_tr_b16 v[82:83], v13 offset:39168
    s_waitcnt lgkmcnt(14)
    v_mfma_f32_16x16x32_bf16 v[132:135], v[44:47], v[20:23], v[132:135]
    ds_read_b64_tr_b16 v[84:85], v12 offset:43008
    v_mfma_f32_16x16x32_bf16 v[136:139], v[44:47], v[24:27], v[136:139]
    ds_read_b64_tr_b16 v[86:87], v12 offset:43264
    v_mfma_f32_16x16x32_bf16 v[140:143], v[44:47], v[28:31], v[140:143]
    ds_read_b64_tr_b16 v[88:89], v13 offset:43008
    v_mfma_f32_16x16x32_bf16 v[144:147], v[44:47], v[32:35], v[144:147]
    ds_read_b64_tr_b16 v[90:91], v13 offset:43264
    s_waitcnt lgkmcnt(15)
    v_mfma_f32_16x16x32_bf16 v[160:163], v[48:51], v[32:35], v[160:163]
    ds_read_b64_tr_b16 v[92:93], v12 offset:47104
    v_mfma_f32_16x16x32_bf16 v[156:159], v[48:51], v[28:31], v[156:159]
    ds_read_b64_tr_b16 v[94:95], v12 offset:47360
    v_mfma_f32_16x16x32_bf16 v[152:155], v[48:51], v[24:27], v[152:155]
    ds_read_b64_tr_b16 v[96:97], v13 offset:47104
    v_mfma_f32_16x16x32_bf16 v[148:151], v[48:51], v[20:23], v[148:151]
    ds_read_b64_tr_b16 v[98:99], v13 offset:47360
    s_waitcnt lgkmcnt(15)
    v_mfma_f32_16x16x32_bf16 v[164:167], v[20:23], v[52:55], v[164:167]
    v_mfma_f32_16x16x32_bf16 v[168:171], v[24:27], v[52:55], v[168:171]
    v_mfma_f32_16x16x32_bf16 v[172:175], v[28:31], v[52:55], v[172:175]
    v_mfma_f32_16x16x32_bf16 v[176:179], v[32:35], v[52:55], v[176:179]
    v_mfma_f32_16x16x32_bf16 v[192:195], v[32:35], v[56:59], v[192:195]
    v_mfma_f32_16x16x32_bf16 v[188:191], v[28:31], v[56:59], v[188:191]
    v_mfma_f32_16x16x32_bf16 v[184:187], v[24:27], v[56:59], v[184:187]
    v_mfma_f32_16x16x32_bf16 v[180:183], v[20:23], v[56:59], v[180:183]
    s_waitcnt lgkmcnt(13)
    v_mfma_f32_16x16x32_bf16 v[100:103], v[76:79], v[60:63], v[100:103]
    s_waitcnt lgkmcnt(12)
    v_mfma_f32_16x16x32_bf16 v[104:107], v[76:79], v[64:67], v[104:107]
    s_waitcnt lgkmcnt(11)
    v_mfma_f32_16x16x32_bf16 v[108:111], v[76:79], v[68:71], v[108:111]
    s_waitcnt lgkmcnt(0)
    s_barrier
    v_mfma_f32_16x16x32_bf16 v[112:115], v[76:79], v[72:75], v[112:115]
    ds_read_b128 v[20:23], v8 offset:0
    v_mfma_f32_16x16x32_bf16 v[128:131], v[80:83], v[72:75], v[128:131]
    ds_read_b64_tr_b16 v[36:37], v12 offset:0
    v_mfma_f32_16x16x32_bf16 v[124:127], v[80:83], v[68:71], v[124:127]
    ds_read_b64_tr_b16 v[38:39], v12 offset:256
    v_mfma_f32_16x16x32_bf16 v[120:123], v[80:83], v[64:67], v[120:123]
    ds_read_b128 v[24:27], v8 offset:2048
    v_mfma_f32_16x16x32_bf16 v[116:119], v[80:83], v[60:63], v[116:119]
    ds_read_b128 v[28:31], v8 offset:4096
    v_mfma_f32_16x16x32_bf16 v[132:135], v[84:87], v[60:63], v[132:135]
    ds_read_b128 v[32:35], v8 offset:6144
    v_mfma_f32_16x16x32_bf16 v[136:139], v[84:87], v[64:67], v[136:139]
    ds_read_b64_tr_b16 v[40:41], v13 offset:0
    v_mfma_f32_16x16x32_bf16 v[140:143], v[84:87], v[68:71], v[140:143]
    ds_read_b64_tr_b16 v[42:43], v13 offset:256
    v_mfma_f32_16x16x32_bf16 v[144:147], v[84:87], v[72:75], v[144:147]
    ds_read_b64_tr_b16 v[44:45], v12 offset:4096
    v_mfma_f32_16x16x32_bf16 v[160:163], v[88:91], v[72:75], v[160:163]
    ds_read_b64_tr_b16 v[46:47], v12 offset:4352
    v_mfma_f32_16x16x32_bf16 v[156:159], v[88:91], v[68:71], v[156:159]
    ds_read_b64_tr_b16 v[48:49], v13 offset:4096
    v_mfma_f32_16x16x32_bf16 v[152:155], v[88:91], v[64:67], v[152:155]
    ds_read_b64_tr_b16 v[50:51], v13 offset:4352
    v_mfma_f32_16x16x32_bf16 v[148:151], v[88:91], v[60:63], v[148:151]
    ds_read_b64_tr_b16 v[52:53], v12 offset:8192
    v_mfma_f32_16x16x32_bf16 v[164:167], v[60:63], v[92:95], v[164:167]
    ds_read_b64_tr_b16 v[54:55], v12 offset:8448
    v_mfma_f32_16x16x32_bf16 v[168:171], v[64:67], v[92:95], v[168:171]
    ds_read_b64_tr_b16 v[56:57], v13 offset:8192
    v_mfma_f32_16x16x32_bf16 v[172:175], v[68:71], v[92:95], v[172:175]
    ds_read_b64_tr_b16 v[58:59], v13 offset:8448
    v_mfma_f32_16x16x32_bf16 v[176:179], v[72:75], v[92:95], v[176:179]
    v_mfma_f32_16x16x32_bf16 v[192:195], v[72:75], v[96:99], v[192:195]
    v_mfma_f32_16x16x32_bf16 v[188:191], v[68:71], v[96:99], v[188:191]
    v_mfma_f32_16x16x32_bf16 v[184:187], v[64:67], v[96:99], v[184:187]
    v_mfma_f32_16x16x32_bf16 v[180:183], v[60:63], v[96:99], v[180:183]
    s_waitcnt lgkmcnt(13)
    v_mfma_f32_16x16x32_bf16 v[100:103], v[36:39], v[20:23], v[100:103]
    ds_read_b128 v[60:63], v9 offset:0
    s_waitcnt lgkmcnt(13)
    v_mfma_f32_16x16x32_bf16 v[104:107], v[36:39], v[24:27], v[104:107]
    ds_read_b64_tr_b16 v[76:77], v12 offset:2048
    s_waitcnt lgkmcnt(13)
    v_mfma_f32_16x16x32_bf16 v[108:111], v[36:39], v[28:31], v[108:111]
    ds_read_b64_tr_b16 v[78:79], v12 offset:2304
    s_waitcnt lgkmcnt(13)
    v_mfma_f32_16x16x32_bf16 v[112:115], v[36:39], v[32:35], v[112:115]
    ds_read_b128 v[64:67], v9 offset:2048
    s_waitcnt lgkmcnt(12)
    v_mfma_f32_16x16x32_bf16 v[128:131], v[40:43], v[32:35], v[128:131]
    ds_read_b128 v[68:71], v9 offset:4096
    v_mfma_f32_16x16x32_bf16 v[124:127], v[40:43], v[28:31], v[124:127]
    ds_read_b128 v[72:75], v9 offset:6144
    v_mfma_f32_16x16x32_bf16 v[120:123], v[40:43], v[24:27], v[120:123]
    ds_read_b64_tr_b16 v[80:81], v13 offset:2048
    v_mfma_f32_16x16x32_bf16 v[116:119], v[40:43], v[20:23], v[116:119]
    ds_read_b64_tr_b16 v[82:83], v13 offset:2304
    s_waitcnt lgkmcnt(14)
    v_mfma_f32_16x16x32_bf16 v[132:135], v[44:47], v[20:23], v[132:135]
    ds_read_b64_tr_b16 v[84:85], v12 offset:6144
    v_mfma_f32_16x16x32_bf16 v[136:139], v[44:47], v[24:27], v[136:139]
    ds_read_b64_tr_b16 v[86:87], v12 offset:6400
    v_mfma_f32_16x16x32_bf16 v[140:143], v[44:47], v[28:31], v[140:143]
    ds_read_b64_tr_b16 v[88:89], v13 offset:6144
    v_mfma_f32_16x16x32_bf16 v[144:147], v[44:47], v[32:35], v[144:147]
    ds_read_b64_tr_b16 v[90:91], v13 offset:6400
    s_waitcnt lgkmcnt(15)
    v_mfma_f32_16x16x32_bf16 v[160:163], v[48:51], v[32:35], v[160:163]
    ds_read_b64_tr_b16 v[92:93], v12 offset:10240
    v_mfma_f32_16x16x32_bf16 v[156:159], v[48:51], v[28:31], v[156:159]
    ds_read_b64_tr_b16 v[94:95], v12 offset:10496
    v_mfma_f32_16x16x32_bf16 v[152:155], v[48:51], v[24:27], v[152:155]
    ds_read_b64_tr_b16 v[96:97], v13 offset:10240
    v_mfma_f32_16x16x32_bf16 v[148:151], v[48:51], v[20:23], v[148:151]
    ds_read_b64_tr_b16 v[98:99], v13 offset:10496
    s_waitcnt lgkmcnt(15)
    v_mfma_f32_16x16x32_bf16 v[164:167], v[20:23], v[52:55], v[164:167]
    v_mfma_f32_16x16x32_bf16 v[168:171], v[24:27], v[52:55], v[168:171]
    v_mfma_f32_16x16x32_bf16 v[172:175], v[28:31], v[52:55], v[172:175]
    v_mfma_f32_16x16x32_bf16 v[176:179], v[32:35], v[52:55], v[176:179]
    v_mfma_f32_16x16x32_bf16 v[192:195], v[32:35], v[56:59], v[192:195]
    v_mfma_f32_16x16x32_bf16 v[188:191], v[28:31], v[56:59], v[188:191]
    v_mfma_f32_16x16x32_bf16 v[184:187], v[24:27], v[56:59], v[184:187]
    v_mfma_f32_16x16x32_bf16 v[180:183], v[20:23], v[56:59], v[180:183]
    s_waitcnt lgkmcnt(13)
    v_mfma_f32_16x16x32_bf16 v[100:103], v[76:79], v[60:63], v[100:103]
    s_waitcnt lgkmcnt(12)
    v_mfma_f32_16x16x32_bf16 v[104:107], v[76:79], v[64:67], v[104:107]
    s_waitcnt lgkmcnt(11)
    v_mfma_f32_16x16x32_bf16 v[108:111], v[76:79], v[68:71], v[108:111]
    s_waitcnt lgkmcnt(0)
    s_barrier
    v_mfma_f32_16x16x32_bf16 v[112:115], v[76:79], v[72:75], v[112:115]
    ds_read_b128 v[20:23], v8 offset:32768
    v_mfma_f32_16x16x32_bf16 v[128:131], v[80:83], v[72:75], v[128:131]
    ds_read_b64_tr_b16 v[36:37], v12 offset:12288
    v_mfma_f32_16x16x32_bf16 v[124:127], v[80:83], v[68:71], v[124:127]
    ds_read_b64_tr_b16 v[38:39], v12 offset:12544
    v_mfma_f32_16x16x32_bf16 v[120:123], v[80:83], v[64:67], v[120:123]
    ds_read_b128 v[24:27], v8 offset:34816
    v_mfma_f32_16x16x32_bf16 v[116:119], v[80:83], v[60:63], v[116:119]
    ds_read_b128 v[28:31], v8 offset:36864
    v_mfma_f32_16x16x32_bf16 v[132:135], v[84:87], v[60:63], v[132:135]
    ds_read_b128 v[32:35], v8 offset:38912
    v_mfma_f32_16x16x32_bf16 v[136:139], v[84:87], v[64:67], v[136:139]
    ds_read_b64_tr_b16 v[40:41], v13 offset:12288
    v_mfma_f32_16x16x32_bf16 v[140:143], v[84:87], v[68:71], v[140:143]
    ds_read_b64_tr_b16 v[42:43], v13 offset:12544
    v_mfma_f32_16x16x32_bf16 v[144:147], v[84:87], v[72:75], v[144:147]
    ds_read_b64_tr_b16 v[44:45], v12 offset:16384
    v_mfma_f32_16x16x32_bf16 v[160:163], v[88:91], v[72:75], v[160:163]
    ds_read_b64_tr_b16 v[46:47], v12 offset:16640
    v_mfma_f32_16x16x32_bf16 v[156:159], v[88:91], v[68:71], v[156:159]
    ds_read_b64_tr_b16 v[48:49], v13 offset:16384
    v_mfma_f32_16x16x32_bf16 v[152:155], v[88:91], v[64:67], v[152:155]
    ds_read_b64_tr_b16 v[50:51], v13 offset:16640
    v_mfma_f32_16x16x32_bf16 v[148:151], v[88:91], v[60:63], v[148:151]
    ds_read_b64_tr_b16 v[52:53], v12 offset:20480
    v_mfma_f32_16x16x32_bf16 v[164:167], v[60:63], v[92:95], v[164:167]
    ds_read_b64_tr_b16 v[54:55], v12 offset:20736
    v_mfma_f32_16x16x32_bf16 v[168:171], v[64:67], v[92:95], v[168:171]
    ds_read_b64_tr_b16 v[56:57], v13 offset:20480
    v_mfma_f32_16x16x32_bf16 v[172:175], v[68:71], v[92:95], v[172:175]
    ds_read_b64_tr_b16 v[58:59], v13 offset:20736
    v_mfma_f32_16x16x32_bf16 v[176:179], v[72:75], v[92:95], v[176:179]
    ds_read_b128 v[196:199], v14 offset:0
    v_mfma_f32_16x16x32_bf16 v[192:195], v[72:75], v[96:99], v[192:195]
    ds_read_b128 v[200:203], v14 offset:256
    v_mfma_f32_16x16x32_bf16 v[188:191], v[68:71], v[96:99], v[188:191]
    ds_read_b128 v[204:207], v14 offset:512
    v_mfma_f32_16x16x32_bf16 v[184:187], v[64:67], v[96:99], v[184:187]
    ds_read_b128 v[208:211], v14 offset:768
    v_mfma_f32_16x16x32_bf16 v[180:183], v[60:63], v[96:99], v[180:183]
    s_waitcnt lgkmcnt(15)
    v_mfma_f32_16x16x32_bf16 v[100:103], v[36:39], v[20:23], v[100:103]
    ds_read_b128 v[60:63], v9 offset:32768
    v_mfma_f32_16x16x32_bf16 v[104:107], v[36:39], v[24:27], v[104:107]
    ds_read_b64_tr_b16 v[76:77], v12 offset:14336
    v_mfma_f32_16x16x32_bf16 v[108:111], v[36:39], v[28:31], v[108:111]
    ds_read_b64_tr_b16 v[78:79], v12 offset:14592
    s_waitcnt lgkmcnt(15)
    v_mfma_f32_16x16x32_bf16 v[112:115], v[36:39], v[32:35], v[112:115]
    ds_read_b128 v[64:67], v9 offset:34816
    v_mfma_f32_16x16x32_bf16 v[128:131], v[40:43], v[32:35], v[128:131]
    ds_read_b128 v[68:71], v9 offset:36864
    v_mfma_f32_16x16x32_bf16 v[124:127], v[40:43], v[28:31], v[124:127]
    ds_read_b128 v[72:75], v9 offset:38912
    v_mfma_f32_16x16x32_bf16 v[120:123], v[40:43], v[24:27], v[120:123]
    ds_read_b64_tr_b16 v[80:81], v13 offset:14336
    v_mfma_f32_16x16x32_bf16 v[116:119], v[40:43], v[20:23], v[116:119]
    ds_read_b64_tr_b16 v[82:83], v13 offset:14592
    s_waitcnt lgkmcnt(15)
    v_mfma_f32_16x16x32_bf16 v[132:135], v[44:47], v[20:23], v[132:135]
    ds_read_b64_tr_b16 v[84:85], v12 offset:18432
    v_mfma_f32_16x16x32_bf16 v[136:139], v[44:47], v[24:27], v[136:139]
    ds_read_b64_tr_b16 v[86:87], v12 offset:18688
    v_mfma_f32_16x16x32_bf16 v[140:143], v[44:47], v[28:31], v[140:143]
    ds_read_b64_tr_b16 v[88:89], v13 offset:18432
    v_mfma_f32_16x16x32_bf16 v[144:147], v[44:47], v[32:35], v[144:147]
    ds_read_b64_tr_b16 v[90:91], v13 offset:18688
    v_mfma_f32_16x16x32_bf16 v[160:163], v[48:51], v[32:35], v[160:163]
    ds_read_b64_tr_b16 v[92:93], v12 offset:22528
    v_mfma_f32_16x16x32_bf16 v[156:159], v[48:51], v[28:31], v[156:159]
    ds_read_b64_tr_b16 v[94:95], v12 offset:22784
    v_mfma_f32_16x16x32_bf16 v[152:155], v[48:51], v[24:27], v[152:155]
    ds_read_b64_tr_b16 v[96:97], v13 offset:22528
    v_mfma_f32_16x16x32_bf16 v[148:151], v[48:51], v[20:23], v[148:151]
    ds_read_b64_tr_b16 v[98:99], v13 offset:22784
    s_waitcnt lgkmcnt(15)
    v_mfma_f32_16x16x32_bf16 v[164:167], v[20:23], v[52:55], v[164:167]
    ds_read_b128 v[212:215], v19 offset:0
    v_mfma_f32_16x16x32_bf16 v[168:171], v[24:27], v[52:55], v[168:171]
    ds_read_b128 v[216:219], v19 offset:64
    v_mfma_f32_16x16x32_bf16 v[172:175], v[28:31], v[52:55], v[172:175]
    ds_read_b128 v[220:223], v19 offset:128
    v_mfma_f32_16x16x32_bf16 v[176:179], v[32:35], v[52:55], v[176:179]
    ds_read_b128 v[224:227], v19 offset:192
    v_mfma_f32_16x16x32_bf16 v[192:195], v[32:35], v[56:59], v[192:195]
    ds_read_b128 v[228:231], v19 offset:384
    v_mfma_f32_16x16x32_bf16 v[188:191], v[28:31], v[56:59], v[188:191]
    ds_read_b128 v[232:235], v19 offset:448
    v_mfma_f32_16x16x32_bf16 v[184:187], v[24:27], v[56:59], v[184:187]
    ds_read_b128 v[236:239], v19 offset:512
    v_mfma_f32_16x16x32_bf16 v[180:183], v[20:23], v[56:59], v[180:183]
    ds_read_b128 v[240:243], v19 offset:576
    s_waitcnt lgkmcnt(15)
    v_mfma_f32_16x16x32_bf16 v[100:103], v[76:79], v[60:63], v[100:103]
    s_waitcnt lgkmcnt(0)
    v_fmac_f32 v152, v224, v201
    v_fmac_f32 v152, v240, v200
    v_fmac_f32 v153, v225, v201
    v_fmac_f32 v153, v241, v200
    v_mfma_f32_16x16x32_bf16 v[104:107], v[76:79], v[64:67], v[104:107]
    v_fmac_f32 v148, v224, v197
    v_fmac_f32 v148, v240, v196
    v_fmac_f32 v149, v225, v197
    v_fmac_f32 v149, v241, v196
    v_mfma_f32_16x16x32_bf16 v[108:111], v[76:79], v[68:71], v[108:111]
    s_barrier
    v_mfma_f32_16x16x32_bf16 v[112:115], v[76:79], v[72:75], v[112:115]
    ds_read_b128 v[20:23], v10 offset:0
    v_mfma_f32_16x16x32_bf16 v[128:131], v[80:83], v[72:75], v[128:131]
    ds_read_b64_tr_b16 v[36:37], v12 offset:24576
    v_mfma_f32_16x16x32_bf16 v[124:127], v[80:83], v[68:71], v[124:127]
    ds_read_b64_tr_b16 v[38:39], v12 offset:24832
    v_mfma_f32_16x16x32_bf16 v[120:123], v[80:83], v[64:67], v[120:123]
    ds_read_b128 v[24:27], v10 offset:2048
    v_mfma_f32_16x16x32_bf16 v[116:119], v[80:83], v[60:63], v[116:119]
    ds_read_b128 v[28:31], v10 offset:4096
    v_mfma_f32_16x16x32_bf16 v[132:135], v[84:87], v[60:63], v[132:135]
    ds_read_b128 v[32:35], v10 offset:6144
    v_mfma_f32_16x16x32_bf16 v[136:139], v[84:87], v[64:67], v[136:139]
    ds_read_b64_tr_b16 v[40:41], v13 offset:24576
    v_mfma_f32_16x16x32_bf16 v[140:143], v[84:87], v[68:71], v[140:143]
    ds_read_b64_tr_b16 v[42:43], v13 offset:24832
    v_fmac_f32 v100, v212, v197
    v_fmac_f32 v100, v228, v196
    v_fmac_f32 v101, v213, v197
    v_fmac_f32 v101, v229, v196
    v_mfma_f32_16x16x32_bf16 v[144:147], v[84:87], v[72:75], v[144:147]
    ds_read_b64_tr_b16 v[44:45], v12 offset:28672
    v_fmac_f32 v104, v212, v201
    v_fmac_f32 v104, v228, v200
    v_fmac_f32 v105, v213, v201
    v_fmac_f32 v105, v229, v200
    v_mfma_f32_16x16x32_bf16 v[160:163], v[88:91], v[72:75], v[160:163]
    ds_read_b64_tr_b16 v[46:47], v12 offset:28928
    v_fmac_f32 v108, v212, v205
    v_fmac_f32 v108, v228, v204
    v_fmac_f32 v109, v213, v205
    v_fmac_f32 v109, v229, v204
    v_mfma_f32_16x16x32_bf16 v[156:159], v[88:91], v[68:71], v[156:159]
    ds_read_b64_tr_b16 v[48:49], v13 offset:28672
    v_fmac_f32 v112, v212, v209
    v_fmac_f32 v112, v228, v208
    v_fmac_f32 v113, v213, v209
    v_fmac_f32 v113, v229, v208
    v_mfma_f32_16x16x32_bf16 v[152:155], v[88:91], v[64:67], v[152:155]
    ds_read_b64_tr_b16 v[50:51], v13 offset:28928
    v_fmac_f32 v128, v216, v209
    v_fmac_f32 v128, v232, v208
    v_fmac_f32 v129, v217, v209
    v_fmac_f32 v129, v233, v208
    v_mfma_f32_16x16x32_bf16 v[148:151], v[88:91], v[60:63], v[148:151]
    ds_read_b64_tr_b16 v[52:53], v12 offset:32768
    v_fmac_f32 v124, v216, v205
    v_fmac_f32 v124, v232, v204
    v_fmac_f32 v125, v217, v205
    v_fmac_f32 v125, v233, v204
    v_mfma_f32_16x16x32_bf16 v[164:167], v[60:63], v[92:95], v[164:167]
    ds_read_b64_tr_b16 v[54:55], v12 offset:33024
    v_fmac_f32 v120, v216, v201
    v_fmac_f32 v120, v232, v200
    v_fmac_f32 v121, v217, v201
    v_fmac_f32 v121, v233, v200
    v_mfma_f32_16x16x32_bf16 v[168:171], v[64:67], v[92:95], v[168:171]
    ds_read_b64_tr_b16 v[56:57], v13 offset:32768
    v_fmac_f32 v116, v216, v197
    v_fmac_f32 v116, v232, v196
    v_fmac_f32 v117, v217, v197
    v_fmac_f32 v117, v233, v196
    v_mfma_f32_16x16x32_bf16 v[172:175], v[68:71], v[92:95], v[172:175]
    ds_read_b64_tr_b16 v[58:59], v13 offset:33024
    v_fmac_f32 v132, v220, v197
    v_fmac_f32 v132, v236, v196
    v_fmac_f32 v133, v221, v197
    v_fmac_f32 v133, v237, v196
    v_mfma_f32_16x16x32_bf16 v[176:179], v[72:75], v[92:95], v[176:179]
    v_fmac_f32 v136, v220, v201
    v_fmac_f32 v136, v236, v200
    v_fmac_f32 v137, v221, v201
    v_fmac_f32 v137, v237, v200
    v_mfma_f32_16x16x32_bf16 v[192:195], v[72:75], v[96:99], v[192:195]
    v_fmac_f32 v140, v220, v205
    v_fmac_f32 v140, v236, v204
    v_fmac_f32 v141, v221, v205
    v_fmac_f32 v141, v237, v204
    v_mfma_f32_16x16x32_bf16 v[188:191], v[68:71], v[96:99], v[188:191]
    v_fmac_f32 v144, v220, v209
    v_fmac_f32 v144, v236, v208
    v_fmac_f32 v145, v221, v209
    v_fmac_f32 v145, v237, v208
    v_mfma_f32_16x16x32_bf16 v[184:187], v[64:67], v[96:99], v[184:187]
    v_fmac_f32 v160, v224, v209
    v_fmac_f32 v160, v240, v208
    v_fmac_f32 v161, v225, v209
    v_fmac_f32 v161, v241, v208
    v_mfma_f32_16x16x32_bf16 v[180:183], v[60:63], v[96:99], v[180:183]
    v_fmac_f32 v156, v224, v205
    v_fmac_f32 v156, v240, v204
    v_fmac_f32 v157, v225, v205
    v_fmac_f32 v157, v241, v204
    s_waitcnt lgkmcnt(13)
    v_mfma_f32_16x16x32_bf16 v[100:103], v[36:39], v[20:23], v[100:103]
    ds_read_b128 v[60:63], v11 offset:0
    v_fmac_f32 v154, v226, v201
    v_fmac_f32 v154, v242, v200
    v_fmac_f32 v155, v227, v201
    v_fmac_f32 v155, v243, v200
    s_waitcnt lgkmcnt(13)
    v_mfma_f32_16x16x32_bf16 v[104:107], v[36:39], v[24:27], v[104:107]
    ds_read_b64_tr_b16 v[76:77], v12 offset:26624
    v_fmac_f32 v150, v226, v197
    v_fmac_f32 v150, v242, v196
    v_fmac_f32 v151, v227, v197
    v_fmac_f32 v151, v243, v196
    s_waitcnt lgkmcnt(13)
    v_mfma_f32_16x16x32_bf16 v[108:111], v[36:39], v[28:31], v[108:111]
    ds_read_b64_tr_b16 v[78:79], v12 offset:26880
    v_mov_b32 v244, v199
    s_waitcnt lgkmcnt(13)
    v_mfma_f32_16x16x32_bf16 v[112:115], v[36:39], v[32:35], v[112:115]
    ds_read_b128 v[64:67], v11 offset:2048
    v_mov_b32 v245, v203
    s_waitcnt lgkmcnt(12)
    v_mfma_f32_16x16x32_bf16 v[128:131], v[40:43], v[32:35], v[128:131]
    ds_read_b128 v[68:71], v11 offset:4096
    v_mov_b32 v246, v207
    v_mfma_f32_16x16x32_bf16 v[124:127], v[40:43], v[28:31], v[124:127]
    ds_read_b128 v[72:75], v11 offset:6144
    v_mov_b32 v247, v211
    v_mfma_f32_16x16x32_bf16 v[120:123], v[40:43], v[24:27], v[120:123]
    ds_read_b64_tr_b16 v[80:81], v13 offset:26624
    v_mov_b32 v251, v210
    v_mfma_f32_16x16x32_bf16 v[116:119], v[40:43], v[20:23], v[116:119]
    ds_read_b64_tr_b16 v[82:83], v13 offset:26880
    v_mov_b32 v250, v206
    s_waitcnt lgkmcnt(14)
    v_mfma_f32_16x16x32_bf16 v[132:135], v[44:47], v[20:23], v[132:135]
    ds_read_b64_tr_b16 v[84:85], v12 offset:30720
    v_mov_b32 v249, v202
    v_mfma_f32_16x16x32_bf16 v[136:139], v[44:47], v[24:27], v[136:139]
    ds_read_b64_tr_b16 v[86:87], v12 offset:30976
    v_mov_b32 v248, v198
    v_mfma_f32_16x16x32_bf16 v[140:143], v[44:47], v[28:31], v[140:143]
    ds_read_b64_tr_b16 v[88:89], v13 offset:30720
    v_fmac_f32 v102, v214, v197
    v_fmac_f32 v102, v230, v196
    v_fmac_f32 v103, v215, v197
    v_fmac_f32 v103, v231, v196
    v_mfma_f32_16x16x32_bf16 v[144:147], v[44:47], v[32:35], v[144:147]
    ds_read_b64_tr_b16 v[90:91], v13 offset:30976
    v_fmac_f32 v106, v214, v201
    v_fmac_f32 v106, v230, v200
    v_fmac_f32 v107, v215, v201
    v_fmac_f32 v107, v231, v200
    s_waitcnt lgkmcnt(15)
    v_mfma_f32_16x16x32_bf16 v[160:163], v[48:51], v[32:35], v[160:163]
    ds_read_b64_tr_b16 v[92:93], v12 offset:34816
    v_fmac_f32 v110, v214, v205
    v_fmac_f32 v110, v230, v204
    v_fmac_f32 v111, v215, v205
    v_fmac_f32 v111, v231, v204
    v_mfma_f32_16x16x32_bf16 v[156:159], v[48:51], v[28:31], v[156:159]
    ds_read_b64_tr_b16 v[94:95], v12 offset:35072
    v_fmac_f32 v114, v214, v209
    v_fmac_f32 v114, v230, v208
    v_fmac_f32 v115, v215, v209
    v_fmac_f32 v115, v231, v208
    v_mfma_f32_16x16x32_bf16 v[152:155], v[48:51], v[24:27], v[152:155]
    ds_read_b64_tr_b16 v[96:97], v13 offset:34816
    v_fmac_f32 v130, v218, v209
    v_fmac_f32 v130, v234, v208
    v_fmac_f32 v131, v219, v209
    v_fmac_f32 v131, v235, v208
    v_mfma_f32_16x16x32_bf16 v[148:151], v[48:51], v[20:23], v[148:151]
    ds_read_b64_tr_b16 v[98:99], v13 offset:35072
    v_fmac_f32 v126, v218, v205
    v_fmac_f32 v126, v234, v204
    v_fmac_f32 v127, v219, v205
    v_fmac_f32 v127, v235, v204
    s_waitcnt lgkmcnt(15)
    v_mfma_f32_16x16x32_bf16 v[164:167], v[20:23], v[52:55], v[164:167]
    v_fmac_f32 v122, v218, v201
    v_fmac_f32 v122, v234, v200
    v_fmac_f32 v123, v219, v201
    v_fmac_f32 v123, v235, v200
    v_mfma_f32_16x16x32_bf16 v[168:171], v[24:27], v[52:55], v[168:171]
    v_fmac_f32 v118, v218, v197
    v_fmac_f32 v118, v234, v196
    v_fmac_f32 v119, v219, v197
    v_fmac_f32 v119, v235, v196
    v_mfma_f32_16x16x32_bf16 v[172:175], v[28:31], v[52:55], v[172:175]
    v_fmac_f32 v134, v222, v197
    v_fmac_f32 v134, v238, v196
    v_fmac_f32 v135, v223, v197
    v_fmac_f32 v135, v239, v196
    v_mfma_f32_16x16x32_bf16 v[176:179], v[32:35], v[52:55], v[176:179]
    v_fmac_f32 v138, v222, v201
    v_fmac_f32 v138, v238, v200
    v_fmac_f32 v139, v223, v201
    v_fmac_f32 v139, v239, v200
    v_mfma_f32_16x16x32_bf16 v[192:195], v[32:35], v[56:59], v[192:195]
    v_fmac_f32 v142, v222, v205
    v_fmac_f32 v142, v238, v204
    v_fmac_f32 v143, v223, v205
    v_fmac_f32 v143, v239, v204
    v_mfma_f32_16x16x32_bf16 v[188:191], v[28:31], v[56:59], v[188:191]
    v_fmac_f32 v146, v222, v209
    v_fmac_f32 v146, v238, v208
    v_fmac_f32 v147, v223, v209
    v_fmac_f32 v147, v239, v208
    v_mfma_f32_16x16x32_bf16 v[184:187], v[24:27], v[56:59], v[184:187]
    v_fmac_f32 v162, v226, v209
    v_fmac_f32 v162, v242, v208
    v_fmac_f32 v163, v227, v209
    v_fmac_f32 v163, v243, v208
    v_mfma_f32_16x16x32_bf16 v[180:183], v[20:23], v[56:59], v[180:183]
    v_fmac_f32 v158, v226, v205
    v_fmac_f32 v158, v242, v204
    v_fmac_f32 v159, v227, v205
    v_fmac_f32 v159, v243, v204
    s_waitcnt lgkmcnt(13)
    v_mfma_f32_16x16x32_bf16 v[100:103], v[76:79], v[60:63], v[100:103]
    ds_read_b128 v[212:215], v15 offset:1024
    s_waitcnt lgkmcnt(13)
    v_mfma_f32_16x16x32_bf16 v[104:107], v[76:79], v[64:67], v[104:107]
    ds_read_b128 v[216:219], v15 offset:1088
    s_waitcnt lgkmcnt(13)
    v_mfma_f32_16x16x32_bf16 v[108:111], v[76:79], v[68:71], v[108:111]
    ds_read_b128 v[220:223], v15 offset:1152
    s_waitcnt lgkmcnt(3)
    s_barrier
    v_mfma_f32_16x16x32_bf16 v[112:115], v[76:79], v[72:75], v[112:115]
    ds_read_b128 v[20:23], v8 offset:0
    ds_read_b128 v[224:227], v15 offset:1216
    v_mfma_f32_16x16x32_bf16 v[128:131], v[80:83], v[72:75], v[128:131]
    ds_read_b64_tr_b16 v[36:37], v12 offset:36864
    ds_read2_b32 v[230:231], v7 offset0:160 offset1:176
    v_mfma_f32_16x16x32_bf16 v[124:127], v[80:83], v[68:71], v[124:127]
    ds_read_b64_tr_b16 v[38:39], v12 offset:37120
    v_mfma_f32_16x16x32_bf16 v[120:123], v[80:83], v[64:67], v[120:123]
    ds_read_b128 v[24:27], v8 offset:2048
    v_mfma_f32_16x16x32_bf16 v[116:119], v[80:83], v[60:63], v[116:119]
    ds_read_b128 v[28:31], v8 offset:4096
    v_mfma_f32_16x16x32_bf16 v[132:135], v[84:87], v[60:63], v[132:135]
    ds_read_b128 v[32:35], v8 offset:6144
    v_mfma_f32_16x16x32_bf16 v[136:139], v[84:87], v[64:67], v[136:139]
    ds_read_b64_tr_b16 v[40:41], v13 offset:36864
    v_mfma_f32_16x16x32_bf16 v[140:143], v[84:87], v[68:71], v[140:143]
    ds_read_b64_tr_b16 v[42:43], v13 offset:37120
    v_mfma_f32_16x16x32_bf16 v[144:147], v[84:87], v[72:75], v[144:147]
    ds_read_b64_tr_b16 v[44:45], v12 offset:40960
    v_mfma_f32_16x16x32_bf16 v[160:163], v[88:91], v[72:75], v[160:163]
    ds_read_b64_tr_b16 v[46:47], v12 offset:41216
    v_mfma_f32_16x16x32_bf16 v[156:159], v[88:91], v[68:71], v[156:159]
    ds_read_b64_tr_b16 v[48:49], v13 offset:40960
    v_mfma_f32_16x16x32_bf16 v[152:155], v[88:91], v[64:67], v[152:155]
    ds_read_b64_tr_b16 v[50:51], v13 offset:41216
    v_mfma_f32_16x16x32_bf16 v[148:151], v[88:91], v[60:63], v[148:151]
    ds_read_b64_tr_b16 v[52:53], v12 offset:45056
    v_mfma_f32_16x16x32_bf16 v[164:167], v[60:63], v[92:95], v[164:167]
    ds_read_b64_tr_b16 v[54:55], v12 offset:45312
    v_mfma_f32_16x16x32_bf16 v[168:171], v[64:67], v[92:95], v[168:171]
    ds_read_b64_tr_b16 v[56:57], v13 offset:45056
    v_mfma_f32_16x16x32_bf16 v[172:175], v[68:71], v[92:95], v[172:175]
    ds_read_b64_tr_b16 v[58:59], v13 offset:45312
    v_mfma_f32_16x16x32_bf16 v[176:179], v[72:75], v[92:95], v[176:179]
    ds_read_b128 v[196:199], v15 offset:0
    v_mfma_f32_16x16x32_bf16 v[192:195], v[72:75], v[96:99], v[192:195]
    ds_read_b128 v[200:203], v15 offset:64
    v_mfma_f32_16x16x32_bf16 v[188:191], v[68:71], v[96:99], v[188:191]
    ds_read_b128 v[204:207], v15 offset:128
    v_mfma_f32_16x16x32_bf16 v[184:187], v[64:67], v[96:99], v[184:187]
    ds_read_b128 v[208:211], v15 offset:192
    v_mfma_f32_16x16x32_bf16 v[180:183], v[60:63], v[96:99], v[180:183]
    ds_read2_b32 v[228:229], v7 offset0:64 offset1:80
    s_waitcnt lgkmcnt(15)
    v_mfma_f32_16x16x32_bf16 v[100:103], v[36:39], v[20:23], v[100:103]
    ds_read_b128 v[60:63], v9 offset:0
    v_mfma_f32_16x16x32_bf16 v[104:107], v[36:39], v[24:27], v[104:107]
    ds_read_b64_tr_b16 v[76:77], v12 offset:38912
    v_mfma_f32_16x16x32_bf16 v[108:111], v[36:39], v[28:31], v[108:111]
    ds_read_b64_tr_b16 v[78:79], v12 offset:39168
    s_waitcnt lgkmcnt(3)
    v_fmac_f32 v164, v228, v212
    v_fmac_f32 v164, v230, v196
    v_fmac_f32 v165, v228, v213
    v_fmac_f32 v165, v230, v197
    v_fmac_f32 v166, v228, v214
    v_fmac_f32 v166, v230, v198
    v_fmac_f32 v167, v228, v215
    v_fmac_f32 v167, v230, v199
    v_mfma_f32_16x16x32_bf16 v[112:115], v[36:39], v[32:35], v[112:115]
    ds_read_b128 v[64:67], v9 offset:2048
    v_fmac_f32 v168, v228, v216
    v_fmac_f32 v168, v230, v200
    v_fmac_f32 v169, v228, v217
    v_fmac_f32 v169, v230, v201
    v_fmac_f32 v170, v228, v218
    v_fmac_f32 v170, v230, v202
    v_fmac_f32 v171, v228, v219
    v_fmac_f32 v171, v230, v203
    v_mfma_f32_16x16x32_bf16 v[128:131], v[40:43], v[32:35], v[128:131]
    ds_read_b128 v[68:71], v9 offset:4096
    v_fmac_f32 v172, v228, v220
    v_fmac_f32 v172, v230, v204
    v_fmac_f32 v173, v228, v221
    v_fmac_f32 v173, v230, v205
    v_fmac_f32 v174, v228, v222
    v_fmac_f32 v174, v230, v206
    v_fmac_f32 v175, v228, v223
    v_fmac_f32 v175, v230, v207
    v_mfma_f32_16x16x32_bf16 v[124:127], v[40:43], v[28:31], v[124:127]
    ds_read_b128 v[72:75], v9 offset:6144
    v_fmac_f32 v176, v228, v224
    v_fmac_f32 v176, v230, v208
    v_fmac_f32 v177, v228, v225
    v_fmac_f32 v177, v230, v209
    v_fmac_f32 v178, v228, v226
    v_fmac_f32 v178, v230, v210
    v_fmac_f32 v179, v228, v227
    v_fmac_f32 v179, v230, v211
    v_mfma_f32_16x16x32_bf16 v[120:123], v[40:43], v[24:27], v[120:123]
    ds_read_b64_tr_b16 v[80:81], v13 offset:38912
    v_fmac_f32 v192, v229, v224
    v_fmac_f32 v192, v231, v208
    v_fmac_f32 v193, v229, v225
    v_fmac_f32 v193, v231, v209
    v_fmac_f32 v194, v229, v226
    v_fmac_f32 v194, v231, v210
    v_fmac_f32 v195, v229, v227
    v_fmac_f32 v195, v231, v211
    v_mfma_f32_16x16x32_bf16 v[116:119], v[40:43], v[20:23], v[116:119]
    ds_read_b64_tr_b16 v[82:83], v13 offset:39168
    v_fmac_f32 v188, v229, v220
    v_fmac_f32 v188, v231, v204
    v_fmac_f32 v189, v229, v221
    v_fmac_f32 v189, v231, v205
    v_fmac_f32 v190, v229, v222
    v_fmac_f32 v190, v231, v206
    v_fmac_f32 v191, v229, v223
    v_fmac_f32 v191, v231, v207
    v_mfma_f32_16x16x32_bf16 v[132:135], v[44:47], v[20:23], v[132:135]
    ds_read_b64_tr_b16 v[84:85], v12 offset:43008
    v_fmac_f32 v184, v229, v216
    v_fmac_f32 v184, v231, v200
    v_fmac_f32 v185, v229, v217
    v_fmac_f32 v185, v231, v201
    v_fmac_f32 v186, v229, v218
    v_fmac_f32 v186, v231, v202
    v_fmac_f32 v187, v229, v219
    v_fmac_f32 v187, v231, v203
    v_mfma_f32_16x16x32_bf16 v[136:139], v[44:47], v[24:27], v[136:139]
    ds_read_b64_tr_b16 v[86:87], v12 offset:43264
    v_fmac_f32 v180, v229, v212
    v_fmac_f32 v180, v231, v196
    v_fmac_f32 v181, v229, v213
    v_fmac_f32 v181, v231, v197
    v_fmac_f32 v182, v229, v214
    v_fmac_f32 v182, v231, v198
    v_fmac_f32 v183, v229, v215
    v_fmac_f32 v183, v231, v199
    v_mfma_f32_16x16x32_bf16 v[140:143], v[44:47], v[28:31], v[140:143]
    ds_read_b64_tr_b16 v[88:89], v13 offset:43008
    v_mfma_f32_16x16x32_bf16 v[144:147], v[44:47], v[32:35], v[144:147]
    ds_read_b64_tr_b16 v[90:91], v13 offset:43264
    v_mfma_f32_16x16x32_bf16 v[160:163], v[48:51], v[32:35], v[160:163]
    ds_read_b64_tr_b16 v[92:93], v12 offset:47104
    v_mfma_f32_16x16x32_bf16 v[156:159], v[48:51], v[28:31], v[156:159]
    ds_read_b64_tr_b16 v[94:95], v12 offset:47360
    v_mfma_f32_16x16x32_bf16 v[152:155], v[48:51], v[24:27], v[152:155]
    ds_read_b64_tr_b16 v[96:97], v13 offset:47104
    v_mfma_f32_16x16x32_bf16 v[148:151], v[48:51], v[20:23], v[148:151]
    ds_read_b64_tr_b16 v[98:99], v13 offset:47360
    v_mfma_f32_16x16x32_bf16 v[164:167], v[20:23], v[52:55], v[164:167]
    v_mfma_f32_16x16x32_bf16 v[168:171], v[24:27], v[52:55], v[168:171]
    v_mfma_f32_16x16x32_bf16 v[172:175], v[28:31], v[52:55], v[172:175]
    v_mfma_f32_16x16x32_bf16 v[176:179], v[32:35], v[52:55], v[176:179]
    v_mfma_f32_16x16x32_bf16 v[192:195], v[32:35], v[56:59], v[192:195]
    v_mfma_f32_16x16x32_bf16 v[188:191], v[28:31], v[56:59], v[188:191]
    v_mfma_f32_16x16x32_bf16 v[184:187], v[24:27], v[56:59], v[184:187]
    v_mfma_f32_16x16x32_bf16 v[180:183], v[20:23], v[56:59], v[180:183]
    s_waitcnt lgkmcnt(13)
    v_mfma_f32_16x16x32_bf16 v[100:103], v[76:79], v[60:63], v[100:103]
    s_waitcnt lgkmcnt(12)
    v_mfma_f32_16x16x32_bf16 v[104:107], v[76:79], v[64:67], v[104:107]
    s_waitcnt lgkmcnt(11)
    v_mfma_f32_16x16x32_bf16 v[108:111], v[76:79], v[68:71], v[108:111]
    ds_read_b128 v[196:199], v15 offset:2048
    s_waitcnt lgkmcnt(11)
    v_mfma_f32_16x16x32_bf16 v[112:115], v[76:79], v[72:75], v[112:115]
    ds_read_b128 v[200:203], v15 offset:2112
    s_waitcnt lgkmcnt(10)
    v_mfma_f32_16x16x32_bf16 v[128:131], v[80:83], v[72:75], v[128:131]
    ds_read_b128 v[204:207], v15 offset:2176
    v_mfma_f32_16x16x32_bf16 v[124:127], v[80:83], v[68:71], v[124:127]
    ds_read_b128 v[208:211], v15 offset:2240
    v_mfma_f32_16x16x32_bf16 v[120:123], v[80:83], v[64:67], v[120:123]
    v_mfma_f32_16x16x32_bf16 v[116:119], v[80:83], v[60:63], v[116:119]
    s_waitcnt lgkmcnt(10)
    v_mfma_f32_16x16x32_bf16 v[132:135], v[84:87], v[60:63], v[132:135]
    v_mfma_f32_16x16x32_bf16 v[136:139], v[84:87], v[64:67], v[136:139]
    v_mfma_f32_16x16x32_bf16 v[140:143], v[84:87], v[68:71], v[140:143]
    v_mfma_f32_16x16x32_bf16 v[144:147], v[84:87], v[72:75], v[144:147]
    s_waitcnt lgkmcnt(8)
    v_mfma_f32_16x16x32_bf16 v[160:163], v[88:91], v[72:75], v[160:163]
    v_mfma_f32_16x16x32_bf16 v[156:159], v[88:91], v[68:71], v[156:159]
    v_mfma_f32_16x16x32_bf16 v[152:155], v[88:91], v[64:67], v[152:155]
    v_mfma_f32_16x16x32_bf16 v[148:151], v[88:91], v[60:63], v[148:151]
    s_waitcnt lgkmcnt(6)
    v_mfma_f32_16x16x32_bf16 v[164:167], v[60:63], v[92:95], v[164:167]
    v_mfma_f32_16x16x32_bf16 v[168:171], v[64:67], v[92:95], v[168:171]
    v_mfma_f32_16x16x32_bf16 v[172:175], v[68:71], v[92:95], v[172:175]
    v_mfma_f32_16x16x32_bf16 v[176:179], v[72:75], v[92:95], v[176:179]
    s_waitcnt lgkmcnt(4)
    v_mfma_f32_16x16x32_bf16 v[192:195], v[72:75], v[96:99], v[192:195]
    v_mfma_f32_16x16x32_bf16 v[188:191], v[68:71], v[96:99], v[188:191]
    v_mfma_f32_16x16x32_bf16 v[184:187], v[64:67], v[96:99], v[184:187]
    v_mfma_f32_16x16x32_bf16 v[180:183], v[60:63], v[96:99], v[180:183]
    s_lshl_b32 s24, s18, 13
    v_and_b32 v8, 7, v3
    v_lshrrev_b32 v6, 3, v3
    v_lshl_add_u32 v8, v6, 4, v8
    v_lshl_add_u32 v8, v4, 5, v8
    v_lshl_add_u32 v8, v8, 4, s24
    v_lshl_add_u32 v6, v4, 5, v3
    v_lshl_add_u32 v6, v6, 4, s24
    v_add_u32 v9, 65536, v8
    v_add_u32 v3, s24, v5
    v_add_u32 v3, 65536, v3
    v_mov_b32 v4, v2
    s_lshl_b32 s23, s16, 17
    s_lshl_b32 s24, s17, 3
    s_lshl_b32 s25, s18, 1
    s_add_u32 s24, s24, s25

    v_mul_f32 v132, v248, v132
    v_mul_f32 v148, v248, v148
    v_mul_f32 v133, v248, v133
    v_mul_f32 v149, v248, v149
    v_mul_f32 v134, v248, v134
    v_mul_f32 v150, v248, v150
    v_mul_f32 v135, v248, v135
    v_mul_f32 v151, v248, v151
    v_cvt_pk_bf16_f32 v24, v132, v133
    v_cvt_pk_bf16_f32 v25, v134, v135
    v_cvt_pk_bf16_f32 v26, v148, v149
    v_cvt_pk_bf16_f32 v27, v150, v151
    ds_write_b128 v8, v[24:27] offset:0
    v_mul_f32 v136, v249, v136
    v_mul_f32 v152, v249, v152
    v_mul_f32 v137, v249, v137
    v_mul_f32 v153, v249, v153
    v_mul_f32 v138, v249, v138
    v_mul_f32 v154, v249, v154
    v_mul_f32 v139, v249, v139
    v_mul_f32 v155, v249, v155
    v_cvt_pk_bf16_f32 v28, v136, v137
    v_cvt_pk_bf16_f32 v29, v138, v139
    v_cvt_pk_bf16_f32 v30, v152, v153
    v_cvt_pk_bf16_f32 v31, v154, v155
    ds_write_b128 v8, v[28:31] offset:128
    v_mul_f32 v140, v250, v140
    v_mul_f32 v156, v250, v156
    v_mul_f32 v141, v250, v141
    v_mul_f32 v157, v250, v157
    v_mul_f32 v142, v250, v142
    v_mul_f32 v158, v250, v158
    v_mul_f32 v143, v250, v143
    v_mul_f32 v159, v250, v159
    v_cvt_pk_bf16_f32 v32, v140, v141
    v_cvt_pk_bf16_f32 v33, v142, v143
    v_cvt_pk_bf16_f32 v34, v156, v157
    v_cvt_pk_bf16_f32 v35, v158, v159
    ds_write_b128 v8, v[32:35] offset:4096
    v_mul_f32 v144, v251, v144
    v_mul_f32 v160, v251, v160
    v_mul_f32 v145, v251, v145
    v_mul_f32 v161, v251, v161
    v_mul_f32 v146, v251, v146
    v_mul_f32 v162, v251, v162
    v_mul_f32 v147, v251, v147
    v_mul_f32 v163, v251, v163
    v_cvt_pk_bf16_f32 v36, v144, v145
    v_cvt_pk_bf16_f32 v37, v146, v147
    v_cvt_pk_bf16_f32 v38, v160, v161
    v_cvt_pk_bf16_f32 v39, v162, v163
    ds_write_b128 v8, v[36:39] offset:4224
    s_waitcnt lgkmcnt(4)
    v_mul_f32 v164, v196, v164
    v_mul_f32 v165, v197, v165
    v_mul_f32 v166, v198, v166
    v_mul_f32 v167, v199, v167
    v_mul_f32 v168, v200, v168
    v_mul_f32 v169, v201, v169
    v_mul_f32 v170, v202, v170
    v_mul_f32 v171, v203, v171
    v_cvt_pk_bf16_f32 v40, v164, v165
    v_cvt_pk_bf16_f32 v41, v166, v167
    v_cvt_pk_bf16_f32 v42, v168, v169
    v_cvt_pk_bf16_f32 v43, v170, v171
    ds_write_b128 v6, v[40:43] offset:2048
    v_mul_f32 v172, v204, v172
    v_mul_f32 v173, v205, v173
    v_mul_f32 v174, v206, v174
    v_mul_f32 v175, v207, v175
    v_mul_f32 v176, v208, v176
    v_mul_f32 v177, v209, v177
    v_mul_f32 v178, v210, v178
    v_mul_f32 v179, v211, v179
    v_cvt_pk_bf16_f32 v44, v172, v173
    v_cvt_pk_bf16_f32 v45, v174, v175
    v_cvt_pk_bf16_f32 v46, v176, v177
    v_cvt_pk_bf16_f32 v47, v178, v179
    ds_write_b128 v6, v[44:47] offset:6144
    v_mul_f32 v180, v196, v180
    v_mul_f32 v181, v197, v181
    v_mul_f32 v182, v198, v182
    v_mul_f32 v183, v199, v183
    v_mul_f32 v184, v200, v184
    v_mul_f32 v185, v201, v185
    v_mul_f32 v186, v202, v186
    v_mul_f32 v187, v203, v187
    v_cvt_pk_bf16_f32 v48, v180, v181
    v_cvt_pk_bf16_f32 v49, v182, v183
    v_cvt_pk_bf16_f32 v50, v184, v185
    v_cvt_pk_bf16_f32 v51, v186, v187
    ds_write_b128 v6, v[48:51] offset:2304
    v_mul_f32 v188, v204, v188
    v_mul_f32 v189, v205, v189
    v_mul_f32 v190, v206, v190
    v_mul_f32 v191, v207, v191
    v_mul_f32 v192, v208, v192
    v_mul_f32 v193, v209, v193
    v_mul_f32 v194, v210, v194
    v_mul_f32 v195, v211, v195
    v_cvt_pk_bf16_f32 v52, v188, v189
    v_cvt_pk_bf16_f32 v53, v190, v191
    v_cvt_pk_bf16_f32 v54, v192, v193
    v_cvt_pk_bf16_f32 v55, v194, v195
    ds_write_b128 v6, v[52:55] offset:6400
    v_mul_f32 v100, v244, v100
    v_mul_f32 v116, v244, v116
    v_mul_f32 v101, v244, v101
    v_mul_f32 v117, v244, v117
    v_mul_f32 v102, v244, v102
    v_mul_f32 v118, v244, v118
    v_mul_f32 v103, v244, v103
    v_mul_f32 v119, v244, v119
    v_cvt_pk_bf16_f32 v56, v100, v101
    v_cvt_pk_bf16_f32 v57, v102, v103
    v_cvt_pk_bf16_f32 v58, v116, v117
    v_cvt_pk_bf16_f32 v59, v118, v119
    ds_write_b128 v9, v[56:59] offset:0
    v_mul_f32 v104, v245, v104
    v_mul_f32 v120, v245, v120
    v_mul_f32 v105, v245, v105
    v_mul_f32 v121, v245, v121
    v_mul_f32 v106, v245, v106
    v_mul_f32 v122, v245, v122
    v_mul_f32 v107, v245, v107
    v_mul_f32 v123, v245, v123
    v_cvt_pk_bf16_f32 v60, v104, v105
    v_cvt_pk_bf16_f32 v61, v106, v107
    v_cvt_pk_bf16_f32 v62, v120, v121
    v_cvt_pk_bf16_f32 v63, v122, v123
    ds_write_b128 v9, v[60:63] offset:128
    v_mul_f32 v108, v246, v108
    v_mul_f32 v124, v246, v124
    v_mul_f32 v109, v246, v109
    v_mul_f32 v125, v246, v125
    v_mul_f32 v110, v246, v110
    v_mul_f32 v126, v246, v126
    v_mul_f32 v111, v246, v111
    v_mul_f32 v127, v246, v127
    v_cvt_pk_bf16_f32 v64, v108, v109
    v_cvt_pk_bf16_f32 v65, v110, v111
    v_cvt_pk_bf16_f32 v66, v124, v125
    v_cvt_pk_bf16_f32 v67, v126, v127
    ds_write_b128 v9, v[64:67] offset:2048
    v_mul_f32 v112, v247, v112
    v_mul_f32 v128, v247, v128
    v_mul_f32 v113, v247, v113
    v_mul_f32 v129, v247, v129
    v_mul_f32 v114, v247, v114
    v_mul_f32 v130, v247, v130
    v_mul_f32 v115, v247, v115
    v_mul_f32 v131, v247, v131
    v_cvt_pk_bf16_f32 v68, v112, v113
    v_cvt_pk_bf16_f32 v69, v114, v115
    v_cvt_pk_bf16_f32 v70, v128, v129
    v_cvt_pk_bf16_f32 v71, v130, v131
    ds_write_b128 v9, v[68:71] offset:2176
    ds_read_b128 v[8:11], v3 offset:0
    ds_read_b128 v[12:15], v3 offset:1024
    ds_read_b128 v[16:19], v3 offset:2048
    ds_read_b128 v[20:23], v3 offset:3072
    v_and_b32 v2, 4, v4
    v_cmp_eq_u32 vcc, 0, v2
    v_mov_b32 v7, 0x3f803f80
    v_and_b32 v2, 2, v4
    v_cndmask_b32 v144, 0, v7, vcc
    v_cndmask_b32 v145, 0, v7, vcc
    v_cndmask_b32 v146, v7, 0, vcc
    v_cndmask_b32 v147, v7, 0, vcc
    v_cmp_eq_u32 vcc, 0, v2
    v_mov_b32 v2, 0xeeeeeeee
    v_mov_b32 v7, 0x44444444
    s_nop 0
    v_cndmask_b32 v7, v2, v7, vcc

    v_mov_b32 v104, 0
    v_mov_b32 v105, 0
    v_mov_b32 v106, 0
    v_mov_b32 v107, 0
    v_mov_b32 v108, 0
    v_mov_b32 v109, 0
    v_mov_b32 v110, 0
    v_mov_b32 v111, 0
    v_mov_b32 v112, 0
    v_mov_b32 v113, 0
    v_mov_b32 v114, 0
    v_mov_b32 v115, 0
    v_mov_b32 v116, 0
    v_mov_b32 v117, 0
    v_mov_b32 v118, 0
    v_mov_b32 v119, 0
    v_mov_b32 v136, 0
    v_mov_b32 v137, 0
    v_mov_b32 v138, 0
    v_mov_b32 v139, 0
    v_mov_b32 v120, 0
    v_mov_b32 v121, 0
    v_mov_b32 v122, 0
    v_mov_b32 v123, 0
    v_mov_b32 v124, 0
    v_mov_b32 v125, 0
    v_mov_b32 v126, 0
    v_mov_b32 v127, 0
    v_mov_b32 v128, 0
    v_mov_b32 v129, 0
    v_mov_b32 v130, 0
    v_mov_b32 v131, 0
    v_mov_b32 v132, 0
    v_mov_b32 v133, 0
    v_mov_b32 v134, 0
    v_mov_b32 v135, 0
    v_mov_b32 v140, 0
    v_mov_b32 v141, 0
    v_mov_b32 v142, 0
    v_mov_b32 v143, 0
    v_mov_b32 v96, 0
    v_mov_b32 v97, 0
    v_mov_b32 v98, 0
    v_mov_b32 v99, 0
    v_mov_b32 v100, 0
    v_mov_b32 v101, 0
    v_mov_b32 v102, 0
    v_mov_b32 v103, 0
    v_mov_b32 v172, 0
    v_mov_b32 v173, 0
    v_mov_b32 v174, 0
    v_mov_b32 v175, 0
    v_mov_b32 v176, 0
    v_mov_b32 v177, 0
    v_mov_b32 v178, 0
    v_mov_b32 v179, 0
    s_waitcnt lgkmcnt(0)
    s_barrier
    s_setprio 2
    v_add_u32 v2, 0, v5
    v_add_u32 v3, 32768, v5
    s_mov_b32 s30, 32768
    s_mov_b32 s33, 0
    ds_read_b128 v[148:151], v2 offset:0
    ds_read_b128 v[152:155], v2 offset:1024
    ds_read_b128 v[156:159], v2 offset:4096
    ds_read_b128 v[160:163], v2 offset:5120
    s_waitcnt lgkmcnt(2)
    v_mfma_f32_32x32x16_bf16 v[56:71], v[148:151], v[8:11], 0
    v_mfma_f32_32x32x16_bf16 v[72:87], v[148:151], v[16:19], 0
    v_mfma_f32_32x32x16_bf16 v[56:71], v[152:155], v[12:15], v[56:71]
    v_mfma_f32_32x32x16_bf16 v[72:87], v[152:155], v[20:23], v[72:87]
    s_nop 9

    v_max3_f32 v88, v56, v57, v58
    v_max3_f32 v88, v88, v59, v60
    v_max3_f32 v88, v88, v61, v62
    v_max3_f32 v88, v88, v63, v64
    v_max3_f32 v88, v88, v65, v66
    v_max3_f32 v88, v88, v67, v68
    v_max3_f32 v88, v88, v69, v70
    v_max_f32 v88, v88, v71
    v_mov_b32 v89, v88
    s_nop 1
    v_permlane32_swap_b32 v88, v89
    s_nop 0
    v_max_f32 v88, v88, v89
    v_max3_f32 v90, v72, v73, v74
    v_max3_f32 v90, v90, v75, v76
    v_max3_f32 v90, v90, v77, v78
    v_max3_f32 v90, v90, v79, v80
    v_max3_f32 v90, v90, v81, v82
    v_max3_f32 v90, v90, v83, v84
    v_max3_f32 v90, v90, v85, v86
    v_max_f32 v90, v90, v87
    v_mov_b32 v91, v90
    s_nop 1
    v_permlane32_swap_b32 v90, v91
    s_nop 0
    v_max_f32 v90, v90, v91
    v_sub_f32 v40, 0, v90
    v_sub_f32 v41, 0, v90
    v_sub_f32 v42, 0, v90
    v_sub_f32 v43, 0, v90
    v_sub_f32 v44, 0, v90
    v_sub_f32 v45, 0, v90
    v_sub_f32 v46, 0, v90
    v_sub_f32 v47, 0, v90
    v_sub_f32 v48, 0, v90
    v_sub_f32 v49, 0, v90
    v_sub_f32 v50, 0, v90
    v_sub_f32 v51, 0, v90
    v_sub_f32 v52, 0, v90
    v_sub_f32 v53, 0, v90
    v_sub_f32 v54, 0, v90
    v_sub_f32 v55, 0, v90
    v_sub_f32 v24, 0, v88
    v_sub_f32 v56, v56, v88
    v_sub_f32 v25, 0, v88
    v_sub_f32 v57, v57, v88
    v_sub_f32 v26, 0, v88
    v_sub_f32 v58, v58, v88
    v_sub_f32 v27, 0, v88
    v_sub_f32 v59, v59, v88
    v_sub_f32 v28, 0, v88
    v_sub_f32 v60, v60, v88
    v_sub_f32 v29, 0, v88
    v_sub_f32 v61, v61, v88
    v_sub_f32 v30, 0, v88
    v_sub_f32 v62, v62, v88
    v_sub_f32 v31, 0, v88
    v_sub_f32 v63, v63, v88
    v_sub_f32 v32, 0, v88
    v_sub_f32 v64, v64, v88
    v_sub_f32 v33, 0, v88
    v_sub_f32 v65, v65, v88
    v_sub_f32 v34, 0, v88
    v_sub_f32 v66, v66, v88
    v_sub_f32 v35, 0, v88
    v_sub_f32 v67, v67, v88
    v_sub_f32 v36, 0, v88
    v_sub_f32 v68, v68, v88
    v_sub_f32 v37, 0, v88
    v_sub_f32 v69, v69, v88
    v_sub_f32 v38, 0, v88
    v_sub_f32 v70, v70, v88
    v_sub_f32 v39, 0, v88
    v_sub_f32 v71, v71, v88
    s_waitcnt lgkmcnt(0)
    .p2align 3
fa_loop:
    v_mfma_f32_32x32x16_bf16 v[72:87], v[148:151], v[16:19], v[40:55]
    v_exp_f32 v56, v56
    v_exp_f32 v57, v57
    v_exp_f32 v58, v58
    v_exp_f32 v59, v59
    v_mfma_f32_32x32x16_bf16 v[72:87], v[152:155], v[20:23], v[72:87]
    ds_read_b128 v[164:167], v2 offset:2048
    ds_read_b128 v[168:171], v2 offset:3072
    v_exp_f32 v60, v60
    v_exp_f32 v61, v61
    v_exp_f32 v62, v62
    v_cvt_pk_bf16_f32 v88, v56, v57
    v_cvt_pk_bf16_f32 v89, v58, v59
    v_mfma_f32_32x32x16_bf16 v[120:135], v[172:175], v[96:99], v[120:135]
    v_exp_f32 v63, v63
    v_cvt_pk_bf16_f32 v90, v60, v61
    v_exp_f32 v64, v64
    v_cvt_pk_bf16_f32 v91, v62, v63
    v_exp_f32 v65, v65
    v_mfma_f32_32x32x16_bf16 v[120:135], v[176:179], v[100:103], v[120:135]
    v_exp_f32 v66, v66
    v_cvt_pk_bf16_f32 v92, v64, v65
    v_exp_f32 v67, v67
    v_exp_f32 v68, v68
    v_cvt_pk_bf16_f32 v93, v66, v67
    v_smfmac_f32_16x16x64_bf16 v[140:143], v[144:147], v[96:103], v7
    v_exp_f32 v69, v69
    v_exp_f32 v70, v70
    v_exp_f32 v71, v71
    v_cvt_pk_bf16_f32 v94, v68, v69
    v_cvt_pk_bf16_f32 v95, v70, v71
    s_waitcnt lgkmcnt(2)
    v_mfma_f32_32x32x16_bf16 v[56:71], v[156:159], v[8:11], v[24:39]
    v_exp_f32 v72, v72
    v_exp_f32 v73, v73
    v_exp_f32 v74, v74
    v_exp_f32 v75, v75
    v_mfma_f32_32x32x16_bf16 v[56:71], v[160:163], v[12:15], v[56:71]
    ds_read_b128 v[148:151], v2 offset:8192
    ds_read_b128 v[152:155], v2 offset:9216
    v_exp_f32 v76, v76
    v_exp_f32 v77, v77
    v_exp_f32 v78, v78
    v_cvt_pk_bf16_f32 v96, v72, v73
    v_cvt_pk_bf16_f32 v97, v74, v75
    s_waitcnt lgkmcnt(2)
    v_mfma_f32_32x32x16_bf16 v[104:119], v[164:167], v[88:91], v[104:119]
    v_exp_f32 v79, v79
    v_cvt_pk_bf16_f32 v98, v76, v77
    v_exp_f32 v80, v80
    v_cvt_pk_bf16_f32 v99, v78, v79
    v_exp_f32 v81, v81
    v_mfma_f32_32x32x16_bf16 v[104:119], v[168:171], v[92:95], v[104:119]
    v_exp_f32 v82, v82
    v_cvt_pk_bf16_f32 v100, v80, v81
    v_exp_f32 v83, v83
    v_exp_f32 v84, v84
    v_cvt_pk_bf16_f32 v101, v82, v83
    v_smfmac_f32_16x16x64_bf16 v[136:139], v[144:147], v[88:95], v7
    v_exp_f32 v85, v85
    v_exp_f32 v86, v86
    v_exp_f32 v87, v87
    v_cvt_pk_bf16_f32 v102, v84, v85
    v_cvt_pk_bf16_f32 v103, v86, v87
    v_mfma_f32_32x32x16_bf16 v[72:87], v[156:159], v[16:19], v[40:55]
    v_exp_f32 v56, v56
    v_exp_f32 v57, v57
    v_exp_f32 v58, v58
    v_exp_f32 v59, v59
    v_mfma_f32_32x32x16_bf16 v[72:87], v[160:163], v[20:23], v[72:87]
    ds_read_b128 v[172:175], v2 offset:6144
    ds_read_b128 v[176:179], v2 offset:7168
    v_exp_f32 v60, v60
    v_exp_f32 v61, v61
    v_exp_f32 v62, v62
    v_cvt_pk_bf16_f32 v88, v56, v57
    v_cvt_pk_bf16_f32 v89, v58, v59
    v_mfma_f32_32x32x16_bf16 v[120:135], v[164:167], v[96:99], v[120:135]
    v_exp_f32 v63, v63
    v_cvt_pk_bf16_f32 v90, v60, v61
    v_exp_f32 v64, v64
    v_cvt_pk_bf16_f32 v91, v62, v63
    v_exp_f32 v65, v65
    v_mfma_f32_32x32x16_bf16 v[120:135], v[168:171], v[100:103], v[120:135]
    v_exp_f32 v66, v66
    v_cvt_pk_bf16_f32 v92, v64, v65
    v_exp_f32 v67, v67
    v_exp_f32 v68, v68
    v_cvt_pk_bf16_f32 v93, v66, v67
    v_smfmac_f32_16x16x64_bf16 v[140:143], v[144:147], v[96:103], v7
    v_exp_f32 v69, v69
    v_exp_f32 v70, v70
    v_exp_f32 v71, v71
    v_cvt_pk_bf16_f32 v94, v68, v69
    v_cvt_pk_bf16_f32 v95, v70, v71
    s_waitcnt lgkmcnt(2)
    v_mfma_f32_32x32x16_bf16 v[56:71], v[148:151], v[8:11], v[24:39]
    v_exp_f32 v72, v72
    v_exp_f32 v73, v73
    v_exp_f32 v74, v74
    v_exp_f32 v75, v75
    v_mfma_f32_32x32x16_bf16 v[56:71], v[152:155], v[12:15], v[56:71]
    ds_read_b128 v[156:159], v2 offset:12288
    ds_read_b128 v[160:163], v2 offset:13312
    v_exp_f32 v76, v76
    v_exp_f32 v77, v77
    v_exp_f32 v78, v78
    v_cvt_pk_bf16_f32 v96, v72, v73
    v_cvt_pk_bf16_f32 v97, v74, v75
    s_waitcnt lgkmcnt(2)
    v_mfma_f32_32x32x16_bf16 v[104:119], v[172:175], v[88:91], v[104:119]
    v_exp_f32 v79, v79
    v_cvt_pk_bf16_f32 v98, v76, v77
    v_exp_f32 v80, v80
    v_cvt_pk_bf16_f32 v99, v78, v79
    v_exp_f32 v81, v81
    v_mfma_f32_32x32x16_bf16 v[104:119], v[176:179], v[92:95], v[104:119]
    v_exp_f32 v82, v82
    v_cvt_pk_bf16_f32 v100, v80, v81
    v_exp_f32 v83, v83
    v_exp_f32 v84, v84
    v_cvt_pk_bf16_f32 v101, v82, v83
    v_smfmac_f32_16x16x64_bf16 v[136:139], v[144:147], v[88:95], v7
    v_exp_f32 v85, v85
    v_exp_f32 v86, v86
    v_exp_f32 v87, v87
    v_cvt_pk_bf16_f32 v102, v84, v85
    v_cvt_pk_bf16_f32 v103, v86, v87
    v_mfma_f32_32x32x16_bf16 v[72:87], v[148:151], v[16:19], v[40:55]
    v_exp_f32 v56, v56
    v_exp_f32 v57, v57
    v_exp_f32 v58, v58
    v_exp_f32 v59, v59
    v_mfma_f32_32x32x16_bf16 v[72:87], v[152:155], v[20:23], v[72:87]
    ds_read_b128 v[164:167], v2 offset:10240
    ds_read_b128 v[168:171], v2 offset:11264
    v_exp_f32 v60, v60
    v_exp_f32 v61, v61
    v_exp_f32 v62, v62
    v_cvt_pk_bf16_f32 v88, v56, v57
    v_cvt_pk_bf16_f32 v89, v58, v59
    v_mfma_f32_32x32x16_bf16 v[120:135], v[172:175], v[96:99], v[120:135]
    v_exp_f32 v63, v63
    v_cvt_pk_bf16_f32 v90, v60, v61
    v_exp_f32 v64, v64
    v_cvt_pk_bf16_f32 v91, v62, v63
    v_exp_f32 v65, v65
    v_mfma_f32_32x32x16_bf16 v[120:135], v[176:179], v[100:103], v[120:135]
    v_exp_f32 v66, v66
    v_cvt_pk_bf16_f32 v92, v64, v65
    v_exp_f32 v67, v67
    v_exp_f32 v68, v68
    v_cvt_pk_bf16_f32 v93, v66, v67
    v_smfmac_f32_16x16x64_bf16 v[140:143], v[144:147], v[96:103], v7
    v_exp_f32 v69, v69
    v_exp_f32 v70, v70
    v_exp_f32 v71, v71
    v_cvt_pk_bf16_f32 v94, v68, v69
    v_cvt_pk_bf16_f32 v95, v70, v71
    s_waitcnt lgkmcnt(2)
    v_mfma_f32_32x32x16_bf16 v[56:71], v[156:159], v[8:11], v[24:39]
    v_exp_f32 v72, v72
    v_exp_f32 v73, v73
    v_exp_f32 v74, v74
    v_exp_f32 v75, v75
    v_mfma_f32_32x32x16_bf16 v[56:71], v[160:163], v[12:15], v[56:71]
    ds_read_b128 v[148:151], v2 offset:16384
    ds_read_b128 v[152:155], v2 offset:17408
    v_exp_f32 v76, v76
    v_exp_f32 v77, v77
    v_exp_f32 v78, v78
    v_cvt_pk_bf16_f32 v96, v72, v73
    v_cvt_pk_bf16_f32 v97, v74, v75
    s_waitcnt lgkmcnt(2)
    v_mfma_f32_32x32x16_bf16 v[104:119], v[164:167], v[88:91], v[104:119]
    v_exp_f32 v79, v79
    v_cvt_pk_bf16_f32 v98, v76, v77
    v_exp_f32 v80, v80
    v_cvt_pk_bf16_f32 v99, v78, v79
    v_exp_f32 v81, v81
    v_mfma_f32_32x32x16_bf16 v[104:119], v[168:171], v[92:95], v[104:119]
    v_exp_f32 v82, v82
    v_cvt_pk_bf16_f32 v100, v80, v81
    v_exp_f32 v83, v83
    v_exp_f32 v84, v84
    v_cvt_pk_bf16_f32 v101, v82, v83
    v_smfmac_f32_16x16x64_bf16 v[136:139], v[144:147], v[88:95], v7
    v_exp_f32 v85, v85
    v_exp_f32 v86, v86
    v_exp_f32 v87, v87
    v_cvt_pk_bf16_f32 v102, v84, v85
    v_cvt_pk_bf16_f32 v103, v86, v87
    v_mfma_f32_32x32x16_bf16 v[72:87], v[156:159], v[16:19], v[40:55]
    v_exp_f32 v56, v56
    v_exp_f32 v57, v57
    v_exp_f32 v58, v58
    v_exp_f32 v59, v59
    v_mfma_f32_32x32x16_bf16 v[72:87], v[160:163], v[20:23], v[72:87]
    ds_read_b128 v[172:175], v2 offset:14336
    ds_read_b128 v[176:179], v2 offset:15360
    v_exp_f32 v60, v60
    v_exp_f32 v61, v61
    v_exp_f32 v62, v62
    v_cvt_pk_bf16_f32 v88, v56, v57
    v_cvt_pk_bf16_f32 v89, v58, v59
    v_mfma_f32_32x32x16_bf16 v[120:135], v[164:167], v[96:99], v[120:135]
    v_exp_f32 v63, v63
    v_cvt_pk_bf16_f32 v90, v60, v61
    v_exp_f32 v64, v64
    v_cvt_pk_bf16_f32 v91, v62, v63
    v_exp_f32 v65, v65
    v_mfma_f32_32x32x16_bf16 v[120:135], v[168:171], v[100:103], v[120:135]
    v_exp_f32 v66, v66
    v_cvt_pk_bf16_f32 v92, v64, v65
    v_exp_f32 v67, v67
    v_exp_f32 v68, v68
    v_cvt_pk_bf16_f32 v93, v66, v67
    v_smfmac_f32_16x16x64_bf16 v[140:143], v[144:147], v[96:103], v7
    v_exp_f32 v69, v69
    v_exp_f32 v70, v70
    v_exp_f32 v71, v71
    v_cvt_pk_bf16_f32 v94, v68, v69
    v_cvt_pk_bf16_f32 v95, v70, v71
    s_waitcnt lgkmcnt(2)
    v_mfma_f32_32x32x16_bf16 v[56:71], v[148:151], v[8:11], v[24:39]
    v_exp_f32 v72, v72
    v_exp_f32 v73, v73
    v_exp_f32 v74, v74
    v_exp_f32 v75, v75
    v_mfma_f32_32x32x16_bf16 v[56:71], v[152:155], v[12:15], v[56:71]
    ds_read_b128 v[156:159], v2 offset:20480
    ds_read_b128 v[160:163], v2 offset:21504
    v_exp_f32 v76, v76
    v_exp_f32 v77, v77
    v_exp_f32 v78, v78
    v_cvt_pk_bf16_f32 v96, v72, v73
    v_cvt_pk_bf16_f32 v97, v74, v75
    s_waitcnt lgkmcnt(2)
    v_mfma_f32_32x32x16_bf16 v[104:119], v[172:175], v[88:91], v[104:119]
    v_exp_f32 v79, v79
    v_cvt_pk_bf16_f32 v98, v76, v77
    v_exp_f32 v80, v80
    v_cvt_pk_bf16_f32 v99, v78, v79
    v_exp_f32 v81, v81
    v_mfma_f32_32x32x16_bf16 v[104:119], v[176:179], v[92:95], v[104:119]
    v_exp_f32 v82, v82
    v_cvt_pk_bf16_f32 v100, v80, v81
    v_exp_f32 v83, v83
    v_exp_f32 v84, v84
    v_cvt_pk_bf16_f32 v101, v82, v83
    v_smfmac_f32_16x16x64_bf16 v[136:139], v[144:147], v[88:95], v7
    v_exp_f32 v85, v85
    v_exp_f32 v86, v86
    v_exp_f32 v87, v87
    v_cvt_pk_bf16_f32 v102, v84, v85
    v_cvt_pk_bf16_f32 v103, v86, v87
    v_mfma_f32_32x32x16_bf16 v[72:87], v[148:151], v[16:19], v[40:55]
    v_exp_f32 v56, v56
    v_exp_f32 v57, v57
    v_exp_f32 v58, v58
    v_exp_f32 v59, v59
    v_mfma_f32_32x32x16_bf16 v[72:87], v[152:155], v[20:23], v[72:87]
    ds_read_b128 v[164:167], v2 offset:18432
    ds_read_b128 v[168:171], v2 offset:19456
    v_exp_f32 v60, v60
    v_exp_f32 v61, v61
    v_exp_f32 v62, v62
    v_cvt_pk_bf16_f32 v88, v56, v57
    v_cvt_pk_bf16_f32 v89, v58, v59
    v_mfma_f32_32x32x16_bf16 v[120:135], v[172:175], v[96:99], v[120:135]
    v_exp_f32 v63, v63
    v_cvt_pk_bf16_f32 v90, v60, v61
    v_exp_f32 v64, v64
    v_cvt_pk_bf16_f32 v91, v62, v63
    v_exp_f32 v65, v65
    v_mfma_f32_32x32x16_bf16 v[120:135], v[176:179], v[100:103], v[120:135]
    v_exp_f32 v66, v66
    v_cvt_pk_bf16_f32 v92, v64, v65
    v_exp_f32 v67, v67
    v_exp_f32 v68, v68
    v_cvt_pk_bf16_f32 v93, v66, v67
    v_smfmac_f32_16x16x64_bf16 v[140:143], v[144:147], v[96:103], v7
    v_exp_f32 v69, v69
    v_exp_f32 v70, v70
    v_exp_f32 v71, v71
    v_cvt_pk_bf16_f32 v94, v68, v69
    v_cvt_pk_bf16_f32 v95, v70, v71
    s_waitcnt lgkmcnt(2)
    v_mfma_f32_32x32x16_bf16 v[56:71], v[156:159], v[8:11], v[24:39]
    v_exp_f32 v72, v72
    v_exp_f32 v73, v73
    v_exp_f32 v74, v74
    v_exp_f32 v75, v75
    v_mfma_f32_32x32x16_bf16 v[56:71], v[160:163], v[12:15], v[56:71]
    ds_read_b128 v[148:151], v2 offset:24576
    ds_read_b128 v[152:155], v2 offset:25600
    v_exp_f32 v76, v76
    v_exp_f32 v77, v77
    v_exp_f32 v78, v78
    v_cvt_pk_bf16_f32 v96, v72, v73
    v_cvt_pk_bf16_f32 v97, v74, v75
    s_waitcnt lgkmcnt(2)
    v_mfma_f32_32x32x16_bf16 v[104:119], v[164:167], v[88:91], v[104:119]
    v_exp_f32 v79, v79
    v_cvt_pk_bf16_f32 v98, v76, v77
    v_exp_f32 v80, v80
    v_cvt_pk_bf16_f32 v99, v78, v79
    v_exp_f32 v81, v81
    v_mfma_f32_32x32x16_bf16 v[104:119], v[168:171], v[92:95], v[104:119]
    v_exp_f32 v82, v82
    v_cvt_pk_bf16_f32 v100, v80, v81
    v_exp_f32 v83, v83
    v_exp_f32 v84, v84
    v_cvt_pk_bf16_f32 v101, v82, v83
    v_smfmac_f32_16x16x64_bf16 v[136:139], v[144:147], v[88:95], v7
    v_exp_f32 v85, v85
    v_exp_f32 v86, v86
    v_exp_f32 v87, v87
    v_cvt_pk_bf16_f32 v102, v84, v85
    v_cvt_pk_bf16_f32 v103, v86, v87
    v_mfma_f32_32x32x16_bf16 v[72:87], v[156:159], v[16:19], v[40:55]
    v_exp_f32 v56, v56
    v_exp_f32 v57, v57
    v_exp_f32 v58, v58
    v_exp_f32 v59, v59
    v_mfma_f32_32x32x16_bf16 v[72:87], v[160:163], v[20:23], v[72:87]
    ds_read_b128 v[172:175], v2 offset:22528
    ds_read_b128 v[176:179], v2 offset:23552
    v_exp_f32 v60, v60
    v_exp_f32 v61, v61
    v_exp_f32 v62, v62
    v_cvt_pk_bf16_f32 v88, v56, v57
    v_cvt_pk_bf16_f32 v89, v58, v59
    v_mfma_f32_32x32x16_bf16 v[120:135], v[164:167], v[96:99], v[120:135]
    v_exp_f32 v63, v63
    v_cvt_pk_bf16_f32 v90, v60, v61
    v_exp_f32 v64, v64
    v_cvt_pk_bf16_f32 v91, v62, v63
    v_exp_f32 v65, v65
    v_mfma_f32_32x32x16_bf16 v[120:135], v[168:171], v[100:103], v[120:135]
    v_exp_f32 v66, v66
    v_cvt_pk_bf16_f32 v92, v64, v65
    v_exp_f32 v67, v67
    v_exp_f32 v68, v68
    v_cvt_pk_bf16_f32 v93, v66, v67
    v_smfmac_f32_16x16x64_bf16 v[140:143], v[144:147], v[96:103], v7
    v_exp_f32 v69, v69
    v_exp_f32 v70, v70
    v_exp_f32 v71, v71
    v_cvt_pk_bf16_f32 v94, v68, v69
    v_cvt_pk_bf16_f32 v95, v70, v71
    s_waitcnt lgkmcnt(2)
    v_mfma_f32_32x32x16_bf16 v[56:71], v[148:151], v[8:11], v[24:39]
    v_exp_f32 v72, v72
    v_exp_f32 v73, v73
    v_exp_f32 v74, v74
    v_exp_f32 v75, v75
    v_mfma_f32_32x32x16_bf16 v[56:71], v[152:155], v[12:15], v[56:71]
    ds_read_b128 v[156:159], v2 offset:28672
    ds_read_b128 v[160:163], v2 offset:29696
    v_exp_f32 v76, v76
    v_exp_f32 v77, v77
    v_exp_f32 v78, v78
    v_cvt_pk_bf16_f32 v96, v72, v73
    v_cvt_pk_bf16_f32 v97, v74, v75
    s_waitcnt lgkmcnt(2)
    v_mfma_f32_32x32x16_bf16 v[104:119], v[172:175], v[88:91], v[104:119]
    v_exp_f32 v79, v79
    v_cvt_pk_bf16_f32 v98, v76, v77
    v_exp_f32 v80, v80
    v_cvt_pk_bf16_f32 v99, v78, v79
    v_exp_f32 v81, v81
    v_mfma_f32_32x32x16_bf16 v[104:119], v[176:179], v[92:95], v[104:119]
    v_exp_f32 v82, v82
    v_cvt_pk_bf16_f32 v100, v80, v81
    v_exp_f32 v83, v83
    v_exp_f32 v84, v84
    v_cvt_pk_bf16_f32 v101, v82, v83
    v_smfmac_f32_16x16x64_bf16 v[136:139], v[144:147], v[88:95], v7
    v_exp_f32 v85, v85
    v_exp_f32 v86, v86
    v_exp_f32 v87, v87
    v_cvt_pk_bf16_f32 v102, v84, v85
    v_cvt_pk_bf16_f32 v103, v86, v87
    v_mfma_f32_32x32x16_bf16 v[72:87], v[148:151], v[16:19], v[40:55]
    v_exp_f32 v56, v56
    v_exp_f32 v57, v57
    v_exp_f32 v58, v58
    v_exp_f32 v59, v59
    v_mfma_f32_32x32x16_bf16 v[72:87], v[152:155], v[20:23], v[72:87]
    ds_read_b128 v[164:167], v2 offset:26624
    ds_read_b128 v[168:171], v2 offset:27648
    v_exp_f32 v60, v60
    v_exp_f32 v61, v61
    v_exp_f32 v62, v62
    v_cvt_pk_bf16_f32 v88, v56, v57
    v_cvt_pk_bf16_f32 v89, v58, v59
    v_mfma_f32_32x32x16_bf16 v[120:135], v[172:175], v[96:99], v[120:135]
    v_exp_f32 v63, v63
    v_cvt_pk_bf16_f32 v90, v60, v61
    v_exp_f32 v64, v64
    v_cvt_pk_bf16_f32 v91, v62, v63
    v_exp_f32 v65, v65
    v_mfma_f32_32x32x16_bf16 v[120:135], v[176:179], v[100:103], v[120:135]
    v_exp_f32 v66, v66
    v_cvt_pk_bf16_f32 v92, v64, v65
    v_exp_f32 v67, v67
    v_exp_f32 v68, v68
    v_cvt_pk_bf16_f32 v93, v66, v67
    v_smfmac_f32_16x16x64_bf16 v[140:143], v[144:147], v[96:103], v7
    v_exp_f32 v69, v69
    v_exp_f32 v70, v70
    v_exp_f32 v71, v71
    v_cvt_pk_bf16_f32 v94, v68, v69
    v_cvt_pk_bf16_f32 v95, v70, v71
    s_waitcnt lgkmcnt(2)
    v_mfma_f32_32x32x16_bf16 v[56:71], v[156:159], v[8:11], v[24:39]
    v_exp_f32 v72, v72
    v_exp_f32 v73, v73
    v_exp_f32 v74, v74
    v_exp_f32 v75, v75
    v_mfma_f32_32x32x16_bf16 v[56:71], v[160:163], v[12:15], v[56:71]
    s_barrier
    ds_read_b128 v[148:151], v3 offset:0
    ds_read_b128 v[152:155], v3 offset:1024
    v_exp_f32 v76, v76
    v_exp_f32 v77, v77
    v_exp_f32 v78, v78
    v_cvt_pk_bf16_f32 v96, v72, v73
    v_cvt_pk_bf16_f32 v97, v74, v75
    s_waitcnt lgkmcnt(2)
    v_mfma_f32_32x32x16_bf16 v[104:119], v[164:167], v[88:91], v[104:119]
    v_exp_f32 v79, v79
    v_cvt_pk_bf16_f32 v98, v76, v77
    v_exp_f32 v80, v80
    v_cvt_pk_bf16_f32 v99, v78, v79
    v_exp_f32 v81, v81
    v_mfma_f32_32x32x16_bf16 v[104:119], v[168:171], v[92:95], v[104:119]
    v_exp_f32 v82, v82
    v_cvt_pk_bf16_f32 v100, v80, v81
    v_exp_f32 v83, v83
    v_exp_f32 v84, v84
    v_cvt_pk_bf16_f32 v101, v82, v83
    v_smfmac_f32_16x16x64_bf16 v[136:139], v[144:147], v[88:95], v7
    v_exp_f32 v85, v85
    v_exp_f32 v86, v86
    v_exp_f32 v87, v87
    v_cvt_pk_bf16_f32 v102, v84, v85
    v_cvt_pk_bf16_f32 v103, v86, v87
    v_mfma_f32_32x32x16_bf16 v[72:87], v[156:159], v[16:19], v[40:55]
    v_exp_f32 v56, v56
    v_exp_f32 v57, v57
    v_exp_f32 v58, v58
    v_exp_f32 v59, v59
    v_mfma_f32_32x32x16_bf16 v[72:87], v[160:163], v[20:23], v[72:87]
    ds_read_b128 v[172:175], v2 offset:30720
    ds_read_b128 v[176:179], v2 offset:31744
    v_exp_f32 v60, v60
    v_exp_f32 v61, v61
    v_exp_f32 v62, v62
    v_cvt_pk_bf16_f32 v88, v56, v57
    v_cvt_pk_bf16_f32 v89, v58, v59
    v_mfma_f32_32x32x16_bf16 v[120:135], v[164:167], v[96:99], v[120:135]
    v_exp_f32 v63, v63
    v_cvt_pk_bf16_f32 v90, v60, v61
    v_exp_f32 v64, v64
    v_cvt_pk_bf16_f32 v91, v62, v63
    v_exp_f32 v65, v65
    v_mfma_f32_32x32x16_bf16 v[120:135], v[168:171], v[100:103], v[120:135]
    v_exp_f32 v66, v66
    v_cvt_pk_bf16_f32 v92, v64, v65
    v_exp_f32 v67, v67
    v_exp_f32 v68, v68
    v_cvt_pk_bf16_f32 v93, v66, v67
    v_smfmac_f32_16x16x64_bf16 v[140:143], v[144:147], v[96:103], v7
    v_exp_f32 v69, v69
    v_exp_f32 v70, v70
    v_exp_f32 v71, v71
    v_cvt_pk_bf16_f32 v94, v68, v69
    v_cvt_pk_bf16_f32 v95, v70, v71
    s_waitcnt lgkmcnt(2)
    v_mfma_f32_32x32x16_bf16 v[56:71], v[148:151], v[8:11], v[24:39]
    v_exp_f32 v72, v72
    v_exp_f32 v73, v73
    v_exp_f32 v74, v74
    v_exp_f32 v75, v75
    v_mfma_f32_32x32x16_bf16 v[56:71], v[152:155], v[12:15], v[56:71]
    ds_read_b128 v[156:159], v3 offset:4096
    ds_read_b128 v[160:163], v3 offset:5120
    v_exp_f32 v76, v76
    v_exp_f32 v77, v77
    v_exp_f32 v78, v78
    v_cvt_pk_bf16_f32 v96, v72, v73
    v_cvt_pk_bf16_f32 v97, v74, v75
    s_waitcnt lgkmcnt(2)
    v_mfma_f32_32x32x16_bf16 v[104:119], v[172:175], v[88:91], v[104:119]
    v_exp_f32 v79, v79
    v_cvt_pk_bf16_f32 v98, v76, v77
    v_exp_f32 v80, v80
    v_cvt_pk_bf16_f32 v99, v78, v79
    v_exp_f32 v81, v81
    v_mfma_f32_32x32x16_bf16 v[104:119], v[176:179], v[92:95], v[104:119]
    v_exp_f32 v82, v82
    v_cvt_pk_bf16_f32 v100, v80, v81
    v_exp_f32 v83, v83
    v_exp_f32 v84, v84
    v_cvt_pk_bf16_f32 v101, v82, v83
    v_smfmac_f32_16x16x64_bf16 v[136:139], v[144:147], v[88:95], v7
    v_exp_f32 v85, v85
    v_exp_f32 v86, v86
    v_exp_f32 v87, v87
    v_cvt_pk_bf16_f32 v102, v84, v85
    v_cvt_pk_bf16_f32 v103, v86, v87
    v_mov_b32 v2, v3
    s_add_u32 s30, s30, 32768
    s_cmp_ge_u32 s30, 131072
    s_cselect_b32 s30, 0, s30
    s_add_u32 s31, s30, 0
    v_add_u32 v3, s31, v5
    s_add_u32 s33, s33, 1
    s_cmp_lt_u32 s33, 8
    s_cbranch_scc1 fa_loop

    s_waitcnt lgkmcnt(0)
    s_barrier
    v_mfma_f32_32x32x16_bf16 v[120:135], v[172:175], v[96:99], v[120:135]
    v_mfma_f32_32x32x16_bf16 v[120:135], v[176:179], v[100:103], v[120:135]
    v_smfmac_f32_16x16x64_bf16 v[140:143], v[144:147], v[96:103], v7
    s_lshl_b32 s25, s24, 5
    s_add_u32 s25, s25, s16
    s_lshl_b32 s25, s25, 11
    s_add_u32 s25, s25, 17825792
    s_add_u32 s26, s25, 65536
    s_mov_b32 s34, 1317011456

    v_add_f32 v136, v136, v138
    v_mul_f32 v56, 0, v104
    v_fmac_f32 v56, 0, v105
    v_fmac_f32 v56, 0, v106
    v_fmac_f32 v56, 0, v107
    v_fmac_f32 v56, 0, v108
    v_fmac_f32 v56, 0, v109
    v_fmac_f32 v56, 0, v110
    v_fmac_f32 v56, 0, v111
    v_fmac_f32 v56, 0, v112
    v_fmac_f32 v56, 0, v113
    v_fmac_f32 v56, 0, v114
    v_fmac_f32 v56, 0, v115
    v_fmac_f32 v56, 0, v116
    v_fmac_f32 v56, 0, v117
    v_fmac_f32 v56, 0, v118
    v_fmac_f32 v56, 0, v119
    v_add_f32 v56, v56, v136
    v_add_f32 v140, v140, v142
    v_mul_f32 v57, 0, v120
    v_fmac_f32 v57, 0, v121
    v_fmac_f32 v57, 0, v122
    v_fmac_f32 v57, 0, v123
    v_fmac_f32 v57, 0, v124
    v_fmac_f32 v57, 0, v125
    v_fmac_f32 v57, 0, v126
    v_fmac_f32 v57, 0, v127
    v_fmac_f32 v57, 0, v128
    v_fmac_f32 v57, 0, v129
    v_fmac_f32 v57, 0, v130
    v_fmac_f32 v57, 0, v131
    v_fmac_f32 v57, 0, v132
    v_fmac_f32 v57, 0, v133
    v_fmac_f32 v57, 0, v134
    v_fmac_f32 v57, 0, v135
    v_add_f32 v57, v57, v140
    v_add_f32 v56, v56, v57
    v_cmp_nlt_f32 vcc, v56, s34
    s_nop 1
    s_cmp_lg_u64 vcc, 0
    s_cbranch_scc1 fa_safe

fa_fin:
    v_rcp_f32 v56, v136
    v_rcp_f32 v57, v140
    v_mul_f32 v104, v104, v56
    v_mul_f32 v105, v105, v56
    v_mul_f32 v106, v106, v56
    v_mul_f32 v107, v107, v56
    v_mul_f32 v108, v108, v56
    v_mul_f32 v109, v109, v56
    v_mul_f32 v110, v110, v56
    v_mul_f32 v111, v111, v56
    v_mul_f32 v112, v112, v56
    v_mul_f32 v113, v113, v56
    v_mul_f32 v114, v114, v56
    v_mul_f32 v115, v115, v56
    v_mul_f32 v116, v116, v56
    v_mul_f32 v117, v117, v56
    v_mul_f32 v118, v118, v56
    v_mul_f32 v119, v119, v56
    v_cvt_pk_bf16_f32 v88, v104, v105
    v_cvt_pk_bf16_f32 v89, v106, v107
    v_cvt_pk_bf16_f32 v90, v108, v109
    v_cvt_pk_bf16_f32 v91, v110, v111
    v_cvt_pk_bf16_f32 v92, v112, v113
    v_cvt_pk_bf16_f32 v93, v114, v115
    v_cvt_pk_bf16_f32 v94, v116, v117
    v_cvt_pk_bf16_f32 v95, v118, v119
    buffer_store_dwordx4 v[88:91], v5, s[12:15], s25 offen sc1
    buffer_store_dwordx4 v[92:95], v5, s[12:15], s25 offen offset:1024 sc1
    v_mul_f32 v120, v120, v57
    v_mul_f32 v121, v121, v57
    v_mul_f32 v122, v122, v57
    v_mul_f32 v123, v123, v57
    v_mul_f32 v124, v124, v57
    v_mul_f32 v125, v125, v57
    v_mul_f32 v126, v126, v57
    v_mul_f32 v127, v127, v57
    v_mul_f32 v128, v128, v57
    v_mul_f32 v129, v129, v57
    v_mul_f32 v130, v130, v57
    v_mul_f32 v131, v131, v57
    v_mul_f32 v132, v132, v57
    v_mul_f32 v133, v133, v57
    v_mul_f32 v134, v134, v57
    v_mul_f32 v135, v135, v57
    v_cvt_pk_bf16_f32 v96, v120, v121
    v_cvt_pk_bf16_f32 v97, v122, v123
    v_cvt_pk_bf16_f32 v98, v124, v125
    v_cvt_pk_bf16_f32 v99, v126, v127
    v_cvt_pk_bf16_f32 v100, v128, v129
    v_cvt_pk_bf16_f32 v101, v130, v131
    v_cvt_pk_bf16_f32 v102, v132, v133
    v_cvt_pk_bf16_f32 v103, v134, v135
    buffer_store_dwordx4 v[96:99], v5, s[12:15], s26 offen sc1
    buffer_store_dwordx4 v[100:103], v5, s[12:15], s26 offen offset:1024 sc1
    s_lshr_b32 s25, s24, 1
    s_lshl_b32 s25, s25, 8
    s_lshl_b32 s26, s16, 3
    s_add_u32 s25, s25, s26
    s_add_u32 s25, s25, 3407872
    v_mov_b32 v8, s72
    v_mov_b32 v9, s73
    v_mov_b32 v10, 0
    s_mov_b64 exec, 1
    s_waitcnt vmcnt(0)
    buffer_store_dwordx2 v[8:9], v10, s[12:15], s25 offen sc1
    s_mov_b64 exec, -1

tail_entry:
    s_setprio 0
    s_mov_b32 s100, s72
    s_mov_b32 s101, s73
    s_cmp_ge_u32 s2, 256
    s_cbranch_scc1 tail_kernel_end

    s_load_dwordx2 s[4:5], s[0:1], 16
    s_load_dwordx2 s[6:7], s[0:1], 96
    s_load_dwordx2 s[36:37], s[0:1], 0
    s_load_dwordx2 s[38:39], s[0:1], 32
    s_load_dwordx2 s[60:61], s[0:1], 56
    s_load_dwordx2 s[62:63], s[0:1], 80
    v_lshrrev_b32 v1, 6, v0
    v_and_b32 v2, 63, v0
    s_and_b32 s20, s2, 7
    s_lshr_b32 s21, s2, 3
    v_readfirstlane_b32 s18, v1
    s_lshr_b32 s16, s20, 1
    s_lshl_b32 s16, s16, 3
    s_and_b32 s22, s21, 7
    s_add_u32 s16, s16, s22
    s_and_b32 s17, s20, 1
    s_lshl_b32 s17, s17, 2
    s_lshr_b32 s22, s21, 3
    s_add_u32 s17, s17, s22
    s_mov_b32 s70, 0x40000
    s_mul_i32 s64, s20, 28
    s_add_u32 s64, s64, s21
    s_cmp_ge_u32 s21, 28
    s_cselect_b32 s65, 1, 0
    s_cselect_b32 s64, 0, s64
    s_waitcnt lgkmcnt(0)

    s_mov_b32 s8, s4
    s_and_b32 s9, s5, 0xffff
    s_mov_b32 s10, 2097152
    s_mov_b32 s11, 0x00020000
    s_mov_b32 s12, s6
    s_and_b32 s13, s7, 0xffff
    s_mov_b32 s14, 268435456
    s_mov_b32 s15, 0x00020000
    s_mov_b32 s44, s38
    s_and_b32 s45, s39, 0xffff
    s_mov_b32 s46, 2048
    s_mov_b32 s47, 0x00020000
    s_mov_b32 s48, s62
    s_and_b32 s49, s63, 0xffff
    s_mov_b32 s50, 4194304
    s_mov_b32 s51, 0x00020000
    s_mov_b32 s52, s60
    s_and_b32 s53, s61, 0xffff
    s_mov_b32 s54, 7340032
    s_mov_b32 s55, 0x00020000
    s_cmp_eq_u32 s65, 0
    s_cselect_b32 s54, s54, 0
    v_lshrrev_b32 v7, 4, v2
    v_and_b32 v15, 15, v2
    v_lshlrev_b32 v15, 4, v15
    v_lshl_add_u32 v15, v7, 11, v15
    s_lshl_b32 s66, s64, 15
    s_lshl_b32 s67, s18, 8
    s_add_u32 s66, s66, s67
    s_add_u32 s67, s66, 8192
    s_add_u32 s68, s66, 16384
    s_add_u32 s69, s66, 24576
    s_cmp_ge_u32 s18, 4
    s_cbranch_scc1 tail_producer

    s_mov_b32 s40, s36
    s_and_b32 s41, s37, 0xffff
    s_mov_b32 s42, 4194304
    s_mov_b32 s43, 0x00020000
    v_and_b32 v3, 31, v2
    v_lshrrev_b32 v4, 5, v2
    v_lshlrev_b32 v5, 11, v3
    v_lshl_add_u32 v5, v4, 3, v5
    s_lshl_b32 s24, s16, 17
    s_lshl_b32 s25, s17, 8
    s_lshl_b32 s26, s18, 6
    s_add_u32 s25, s25, s26
    s_add_u32 s26, s24, s25
    s_add_u32 s27, s26, 65536
    v_lshlrev_b32 v6, 3, v4
    s_add_u32 s28, s25, 4096
    s_add_u32 s29, s25, 8192
    v_lshlrev_b32 v8, 4, v2
    v_add_u32 v9, 49152, v8
    v_add_u32 v10, 98304, v8
    v_lshrrev_b32 v7, 2, v2
    v_and_b32 v7, 3, v7
    v_lshl_add_u32 v11, v4, 2, v7
    v_lshlrev_b32 v11, 8, v11
    v_xor_b32 v7, s18, v7
    v_lshl_add_u32 v11, v7, 6, v11
    v_lshrrev_b32 v7, 4, v2
    v_and_b32 v7, 1, v7
    v_lshl_add_u32 v11, v7, 5, v11
    v_and_b32 v7, 3, v2
    v_lshl_add_u32 v11, v7, 3, v11
    v_add_u32 v11, 8192, v11
    v_add_u32 v12, 49152, v11
    v_add_u32 v13, 98304, v11

    v_and_b32 v7, 15, v3
    s_lshl_b32 s30, s18, 2
    v_xor_b32 v7, s30, v7
    v_lshlrev_b32 v7, 4, v7
    v_lshl_add_u32 v7, v3, 8, v7
    v_add_u32 v7, v7, v6
    v_add_u32 v144, 147456, v7
    v_xor_b32 v145, 16, v144
    v_xor_b32 v146, 32, v144
    v_xor_b32 v147, 48, v144
    s_lshl_b32 s30, s18, 6
    s_add_u32 s30, s30, 147456
    v_add_u32 v5, s30, v6

    v_mov_b32 v16, 0
    v_mov_b32 v17, 0
    v_mov_b32 v18, 0
    v_mov_b32 v19, 0
    v_mov_b32 v20, 0
    v_mov_b32 v21, 0
    v_mov_b32 v22, 0
    v_mov_b32 v23, 0
    v_mov_b32 v24, 0
    v_mov_b32 v25, 0
    v_mov_b32 v26, 0
    v_mov_b32 v27, 0
    v_mov_b32 v28, 0
    v_mov_b32 v29, 0
    v_mov_b32 v30, 0
    v_mov_b32 v31, 0
    v_mov_b32 v32, 0
    v_mov_b32 v33, 0
    v_mov_b32 v34, 0
    v_mov_b32 v35, 0
    v_mov_b32 v36, 0
    v_mov_b32 v37, 0
    v_mov_b32 v38, 0
    v_mov_b32 v39, 0
    v_mov_b32 v40, 0
    v_mov_b32 v41, 0
    v_mov_b32 v42, 0
    v_mov_b32 v43, 0
    v_mov_b32 v44, 0
    v_mov_b32 v45, 0
    v_mov_b32 v46, 0
    v_mov_b32 v47, 0
    s_barrier
    ds_read_b64_tr_b16 v[56:57], v11 offset:0
    ds_read_b64_tr_b16 v[58:59], v11 offset:2048
    ds_read_b128 v[48:51], v8 offset:0
    ds_read_b128 v[52:55], v8 offset:4096
    ds_read_b64_tr_b16 v[68:69], v11 offset:4096
    ds_read_b64_tr_b16 v[70:71], v11 offset:6144
    ds_read_b128 v[60:63], v8 offset:1024
    ds_read_b128 v[64:67], v8 offset:5120
    ds_read_b64_tr_b16 v[80:81], v11 offset:8192
    ds_read_b64_tr_b16 v[82:83], v11 offset:10240
    ds_read_b128 v[72:75], v8 offset:2048
    ds_read_b128 v[76:79], v8 offset:6144
    ds_read_b64_tr_b16 v[92:93], v11 offset:12288
    ds_read_b64_tr_b16 v[94:95], v11 offset:14336
    ds_read_b128 v[84:87], v8 offset:3072
    ds_read_b128 v[88:91], v8 offset:7168
    ds_read_b64 v[160:161], v144 offset:0
    ds_read_b64 v[162:163], v145 offset:0
    ds_read_b64 v[164:165], v146 offset:0
    ds_read_b64 v[166:167], v147 offset:0
    ds_read_b64 v[168:169], v144 offset:8192
    ds_read_b64 v[170:171], v145 offset:8192
    ds_read_b64 v[172:173], v146 offset:8192
    ds_read_b64 v[174:175], v147 offset:8192
    s_waitcnt lgkmcnt(0)
    v_mfma_f32_32x32x16_bf16 v[16:31], v[56:59], v[48:51], v[16:31]
    s_barrier
    ds_read_b64_tr_b16 v[104:105], v11 offset:24576
    ds_read_b64_tr_b16 v[106:107], v11 offset:26624
    ds_read_b128 v[96:99], v8 offset:24576
    v_mfma_f32_32x32x16_bf16 v[32:47], v[56:59], v[52:55], v[32:47]
    ds_read_b128 v[100:103], v8 offset:28672
    ds_read_b64_tr_b16 v[116:117], v11 offset:28672
    ds_read_b64_tr_b16 v[118:119], v11 offset:30720
    v_mfma_f32_32x32x16_bf16 v[16:31], v[68:71], v[60:63], v[16:31]
    ds_read_b128 v[108:111], v8 offset:25600
    ds_read_b128 v[112:115], v8 offset:29696
    ds_read_b64_tr_b16 v[128:129], v11 offset:32768
    v_mfma_f32_32x32x16_bf16 v[32:47], v[68:71], v[64:67], v[32:47]
    ds_read_b64_tr_b16 v[130:131], v11 offset:34816
    ds_read_b128 v[120:123], v8 offset:26624
    ds_read_b128 v[124:127], v8 offset:30720
    v_mfma_f32_32x32x16_bf16 v[16:31], v[80:83], v[72:75], v[16:31]
    ds_read_b64_tr_b16 v[140:141], v11 offset:36864
    ds_read_b64_tr_b16 v[142:143], v11 offset:38912
    ds_read_b128 v[132:135], v8 offset:27648
    v_mfma_f32_32x32x16_bf16 v[32:47], v[80:83], v[76:79], v[32:47]
    ds_read_b128 v[136:139], v8 offset:31744
    v_mfma_f32_32x32x16_bf16 v[16:31], v[92:95], v[84:87], v[16:31]
    v_mfma_f32_32x32x16_bf16 v[32:47], v[92:95], v[88:91], v[32:47]
    s_waitcnt lgkmcnt(0)
    v_mfma_f32_32x32x16_bf16 v[16:31], v[104:107], v[96:99], v[16:31]
    s_barrier
    ds_read_b64_tr_b16 v[56:57], v12 offset:0
    ds_read_b64_tr_b16 v[58:59], v12 offset:2048
    ds_read_b128 v[48:51], v9 offset:0
    v_mfma_f32_32x32x16_bf16 v[32:47], v[104:107], v[100:103], v[32:47]
    ds_read_b128 v[52:55], v9 offset:4096
    ds_read_b64_tr_b16 v[68:69], v12 offset:4096
    ds_read_b64_tr_b16 v[70:71], v12 offset:6144
    v_mfma_f32_32x32x16_bf16 v[16:31], v[116:119], v[108:111], v[16:31]
    ds_read_b128 v[60:63], v9 offset:1024
    ds_read_b128 v[64:67], v9 offset:5120
    ds_read_b64_tr_b16 v[80:81], v12 offset:8192
    v_mfma_f32_32x32x16_bf16 v[32:47], v[116:119], v[112:115], v[32:47]
    ds_read_b64_tr_b16 v[82:83], v12 offset:10240
    ds_read_b128 v[72:75], v9 offset:2048
    ds_read_b128 v[76:79], v9 offset:6144
    v_mfma_f32_32x32x16_bf16 v[16:31], v[128:131], v[120:123], v[16:31]
    ds_read_b64_tr_b16 v[92:93], v12 offset:12288
    ds_read_b64_tr_b16 v[94:95], v12 offset:14336
    ds_read_b128 v[84:87], v9 offset:3072
    v_mfma_f32_32x32x16_bf16 v[32:47], v[128:131], v[124:127], v[32:47]
    ds_read_b128 v[88:91], v9 offset:7168
    v_mfma_f32_32x32x16_bf16 v[16:31], v[140:143], v[132:135], v[16:31]
    v_mfma_f32_32x32x16_bf16 v[32:47], v[140:143], v[136:139], v[32:47]
    s_waitcnt lgkmcnt(0)
    v_mfma_f32_32x32x16_bf16 v[16:31], v[56:59], v[48:51], v[16:31]
    s_barrier
    ds_read_b64_tr_b16 v[104:105], v12 offset:24576
    ds_read_b64_tr_b16 v[106:107], v12 offset:26624
    ds_read_b128 v[96:99], v9 offset:24576
    v_mfma_f32_32x32x16_bf16 v[32:47], v[56:59], v[52:55], v[32:47]
    ds_read_b128 v[100:103], v9 offset:28672
    ds_read_b64_tr_b16 v[116:117], v12 offset:28672
    ds_read_b64_tr_b16 v[118:119], v12 offset:30720
    v_mfma_f32_32x32x16_bf16 v[16:31], v[68:71], v[60:63], v[16:31]
    ds_read_b128 v[108:111], v9 offset:25600
    ds_read_b128 v[112:115], v9 offset:29696
    ds_read_b64_tr_b16 v[128:129], v12 offset:32768
    v_mfma_f32_32x32x16_bf16 v[32:47], v[68:71], v[64:67], v[32:47]
    ds_read_b64_tr_b16 v[130:131], v12 offset:34816
    ds_read_b128 v[120:123], v9 offset:26624
    ds_read_b128 v[124:127], v9 offset:30720
    v_mfma_f32_32x32x16_bf16 v[16:31], v[80:83], v[72:75], v[16:31]
    ds_read_b64_tr_b16 v[140:141], v12 offset:36864
    ds_read_b64_tr_b16 v[142:143], v12 offset:38912
    ds_read_b128 v[132:135], v9 offset:27648
    v_mfma_f32_32x32x16_bf16 v[32:47], v[80:83], v[76:79], v[32:47]
    ds_read_b128 v[136:139], v9 offset:31744
    v_mfma_f32_32x32x16_bf16 v[16:31], v[92:95], v[84:87], v[16:31]
    v_mfma_f32_32x32x16_bf16 v[32:47], v[92:95], v[88:91], v[32:47]
    s_waitcnt lgkmcnt(0)
    v_mfma_f32_32x32x16_bf16 v[16:31], v[104:107], v[96:99], v[16:31]
    s_barrier
    ds_read_b64_tr_b16 v[56:57], v13 offset:0
    ds_read_b64_tr_b16 v[58:59], v13 offset:2048
    ds_read_b128 v[48:51], v10 offset:0
    v_mfma_f32_32x32x16_bf16 v[32:47], v[104:107], v[100:103], v[32:47]
    ds_read_b128 v[52:55], v10 offset:4096
    ds_read_b64_tr_b16 v[68:69], v13 offset:4096
    ds_read_b64_tr_b16 v[70:71], v13 offset:6144
    v_mfma_f32_32x32x16_bf16 v[16:31], v[116:119], v[108:111], v[16:31]
    ds_read_b128 v[60:63], v10 offset:1024
    ds_read_b128 v[64:67], v10 offset:5120
    ds_read_b64_tr_b16 v[80:81], v13 offset:8192
    v_mfma_f32_32x32x16_bf16 v[32:47], v[116:119], v[112:115], v[32:47]
    ds_read_b64_tr_b16 v[82:83], v13 offset:10240
    ds_read_b128 v[72:75], v10 offset:2048
    ds_read_b128 v[76:79], v10 offset:6144
    v_mfma_f32_32x32x16_bf16 v[16:31], v[128:131], v[120:123], v[16:31]
    ds_read_b64_tr_b16 v[92:93], v13 offset:12288
    ds_read_b64_tr_b16 v[94:95], v13 offset:14336
    ds_read_b128 v[84:87], v10 offset:3072
    v_mfma_f32_32x32x16_bf16 v[32:47], v[128:131], v[124:127], v[32:47]
    ds_read_b128 v[88:91], v10 offset:7168
    v_mfma_f32_32x32x16_bf16 v[16:31], v[140:143], v[132:135], v[16:31]
    v_mfma_f32_32x32x16_bf16 v[32:47], v[140:143], v[136:139], v[32:47]
    buffer_load_dwordx4 v[232:235], v15, s[52:55], s66 offen
    buffer_load_dwordx4 v[236:239], v15, s[52:55], s67 offen
    buffer_load_dwordx4 v[240:243], v15, s[52:55], s68 offen
    buffer_load_dwordx4 v[244:247], v15, s[52:55], s69 offen
    s_waitcnt lgkmcnt(0)
    v_mfma_f32_32x32x16_bf16 v[16:31], v[56:59], v[48:51], v[16:31]
    s_barrier
    ds_read_b64_tr_b16 v[104:105], v13 offset:24576
    ds_read_b64_tr_b16 v[106:107], v13 offset:26624
    ds_read_b128 v[96:99], v10 offset:24576
    v_mfma_f32_32x32x16_bf16 v[32:47], v[56:59], v[52:55], v[32:47]
    ds_read_b128 v[100:103], v10 offset:28672
    ds_read_b64_tr_b16 v[116:117], v13 offset:28672
    ds_read_b64_tr_b16 v[118:119], v13 offset:30720
    v_mfma_f32_32x32x16_bf16 v[16:31], v[68:71], v[60:63], v[16:31]
    ds_read_b128 v[108:111], v10 offset:25600
    ds_read_b128 v[112:115], v10 offset:29696
    ds_read_b64_tr_b16 v[128:129], v13 offset:32768
    v_mfma_f32_32x32x16_bf16 v[32:47], v[68:71], v[64:67], v[32:47]
    ds_read_b64_tr_b16 v[130:131], v13 offset:34816
    ds_read_b128 v[120:123], v10 offset:26624
    ds_read_b128 v[124:127], v10 offset:30720
    v_mfma_f32_32x32x16_bf16 v[16:31], v[80:83], v[72:75], v[16:31]
    ds_read_b64_tr_b16 v[140:141], v13 offset:36864
    ds_read_b64_tr_b16 v[142:143], v13 offset:38912
    ds_read_b128 v[132:135], v10 offset:27648
    v_mfma_f32_32x32x16_bf16 v[32:47], v[80:83], v[76:79], v[32:47]
    ds_read_b128 v[136:139], v10 offset:31744
    v_mfma_f32_32x32x16_bf16 v[16:31], v[92:95], v[84:87], v[16:31]
    v_mfma_f32_32x32x16_bf16 v[32:47], v[92:95], v[88:91], v[32:47]
    s_waitcnt lgkmcnt(0)
    v_mfma_f32_32x32x16_bf16 v[16:31], v[104:107], v[96:99], v[16:31]
    s_barrier
    ds_read_b64_tr_b16 v[56:57], v11 offset:0
    ds_read_b64_tr_b16 v[58:59], v11 offset:2048
    ds_read_b128 v[48:51], v8 offset:0
    v_mfma_f32_32x32x16_bf16 v[32:47], v[104:107], v[100:103], v[32:47]
    ds_read_b128 v[52:55], v8 offset:4096
    ds_read_b64_tr_b16 v[68:69], v11 offset:4096
    ds_read_b64_tr_b16 v[70:71], v11 offset:6144
    v_mfma_f32_32x32x16_bf16 v[16:31], v[116:119], v[108:111], v[16:31]
    ds_read_b128 v[60:63], v8 offset:1024
    ds_read_b128 v[64:67], v8 offset:5120
    ds_read_b64_tr_b16 v[80:81], v11 offset:8192
    v_mfma_f32_32x32x16_bf16 v[32:47], v[116:119], v[112:115], v[32:47]
    ds_read_b64_tr_b16 v[82:83], v11 offset:10240
    ds_read_b128 v[72:75], v8 offset:2048
    ds_read_b128 v[76:79], v8 offset:6144
    v_mfma_f32_32x32x16_bf16 v[16:31], v[128:131], v[120:123], v[16:31]
    ds_read_b64_tr_b16 v[92:93], v11 offset:12288
    ds_read_b64_tr_b16 v[94:95], v11 offset:14336
    ds_read_b128 v[84:87], v8 offset:3072
    v_mfma_f32_32x32x16_bf16 v[32:47], v[128:131], v[124:127], v[32:47]
    ds_read_b128 v[88:91], v8 offset:7168
    v_mfma_f32_32x32x16_bf16 v[16:31], v[140:143], v[132:135], v[16:31]
    v_mfma_f32_32x32x16_bf16 v[32:47], v[140:143], v[136:139], v[32:47]
    s_waitcnt lgkmcnt(0)
    v_mfma_f32_32x32x16_bf16 v[16:31], v[56:59], v[48:51], v[16:31]
    s_barrier
    ds_read_b64_tr_b16 v[104:105], v11 offset:24576
    ds_read_b64_tr_b16 v[106:107], v11 offset:26624
    ds_read_b128 v[96:99], v8 offset:24576
    v_mfma_f32_32x32x16_bf16 v[32:47], v[56:59], v[52:55], v[32:47]
    ds_read_b128 v[100:103], v8 offset:28672
    ds_read_b64_tr_b16 v[116:117], v11 offset:28672
    ds_read_b64_tr_b16 v[118:119], v11 offset:30720
    v_mfma_f32_32x32x16_bf16 v[16:31], v[68:71], v[60:63], v[16:31]
    ds_read_b128 v[108:111], v8 offset:25600
    ds_read_b128 v[112:115], v8 offset:29696
    ds_read_b64_tr_b16 v[128:129], v11 offset:32768
    v_mfma_f32_32x32x16_bf16 v[32:47], v[68:71], v[64:67], v[32:47]
    ds_read_b64_tr_b16 v[130:131], v11 offset:34816
    ds_read_b128 v[120:123], v8 offset:26624
    ds_read_b128 v[124:127], v8 offset:30720
    v_mfma_f32_32x32x16_bf16 v[16:31], v[80:83], v[72:75], v[16:31]
    ds_read_b64_tr_b16 v[140:141], v11 offset:36864
    ds_read_b64_tr_b16 v[142:143], v11 offset:38912
    ds_read_b128 v[132:135], v8 offset:27648
    v_mfma_f32_32x32x16_bf16 v[32:47], v[80:83], v[76:79], v[32:47]
    ds_read_b128 v[136:139], v8 offset:31744
    v_mfma_f32_32x32x16_bf16 v[16:31], v[92:95], v[84:87], v[16:31]
    v_mfma_f32_32x32x16_bf16 v[32:47], v[92:95], v[88:91], v[32:47]
    s_waitcnt lgkmcnt(0)
    v_mfma_f32_32x32x16_bf16 v[16:31], v[104:107], v[96:99], v[16:31]
    s_barrier
    ds_read_b64_tr_b16 v[56:57], v12 offset:0
    ds_read_b64_tr_b16 v[58:59], v12 offset:2048
    ds_read_b128 v[48:51], v9 offset:0
    v_mfma_f32_32x32x16_bf16 v[32:47], v[104:107], v[100:103], v[32:47]
    ds_read_b128 v[52:55], v9 offset:4096
    ds_read_b64_tr_b16 v[68:69], v12 offset:4096
    ds_read_b64_tr_b16 v[70:71], v12 offset:6144
    v_mfma_f32_32x32x16_bf16 v[16:31], v[116:119], v[108:111], v[16:31]
    ds_read_b128 v[60:63], v9 offset:1024
    ds_read_b128 v[64:67], v9 offset:5120
    ds_read_b64_tr_b16 v[80:81], v12 offset:8192
    v_mfma_f32_32x32x16_bf16 v[32:47], v[116:119], v[112:115], v[32:47]
    ds_read_b64_tr_b16 v[82:83], v12 offset:10240
    ds_read_b128 v[72:75], v9 offset:2048
    ds_read_b128 v[76:79], v9 offset:6144
    v_mfma_f32_32x32x16_bf16 v[16:31], v[128:131], v[120:123], v[16:31]
    ds_read_b64_tr_b16 v[92:93], v12 offset:12288
    ds_read_b64_tr_b16 v[94:95], v12 offset:14336
    ds_read_b128 v[84:87], v9 offset:3072
    v_mfma_f32_32x32x16_bf16 v[32:47], v[128:131], v[124:127], v[32:47]
    ds_read_b128 v[88:91], v9 offset:7168
    v_mfma_f32_32x32x16_bf16 v[16:31], v[140:143], v[132:135], v[16:31]
    v_mfma_f32_32x32x16_bf16 v[32:47], v[140:143], v[136:139], v[32:47]
    s_waitcnt lgkmcnt(0)
    v_mfma_f32_32x32x16_bf16 v[16:31], v[56:59], v[48:51], v[16:31]
    s_barrier
    ds_read_b64_tr_b16 v[104:105], v12 offset:24576
    ds_read_b64_tr_b16 v[106:107], v12 offset:26624
    ds_read_b128 v[96:99], v9 offset:24576
    v_mfma_f32_32x32x16_bf16 v[32:47], v[56:59], v[52:55], v[32:47]
    ds_read_b128 v[100:103], v9 offset:28672
    ds_read_b64_tr_b16 v[116:117], v12 offset:28672
    ds_read_b64_tr_b16 v[118:119], v12 offset:30720
    v_mfma_f32_32x32x16_bf16 v[16:31], v[68:71], v[60:63], v[16:31]
    ds_read_b128 v[108:111], v9 offset:25600
    ds_read_b128 v[112:115], v9 offset:29696
    ds_read_b64_tr_b16 v[128:129], v12 offset:32768
    v_mfma_f32_32x32x16_bf16 v[32:47], v[68:71], v[64:67], v[32:47]
    ds_read_b64_tr_b16 v[130:131], v12 offset:34816
    ds_read_b128 v[120:123], v9 offset:26624
    ds_read_b128 v[124:127], v9 offset:30720
    v_mfma_f32_32x32x16_bf16 v[16:31], v[80:83], v[72:75], v[16:31]
    ds_read_b64_tr_b16 v[140:141], v12 offset:36864
    ds_read_b64_tr_b16 v[142:143], v12 offset:38912
    ds_read_b128 v[132:135], v9 offset:27648
    v_mfma_f32_32x32x16_bf16 v[32:47], v[80:83], v[76:79], v[32:47]
    ds_read_b128 v[136:139], v9 offset:31744
    v_mfma_f32_32x32x16_bf16 v[16:31], v[92:95], v[84:87], v[16:31]
    v_mfma_f32_32x32x16_bf16 v[32:47], v[92:95], v[88:91], v[32:47]
    ds_read2_b64 v[184:187], v5 offset0:0 offset1:2
    ds_read2_b64 v[188:191], v5 offset0:4 offset1:6
    ds_read2_b64 v[216:219], v5 offset0:32 offset1:34
    ds_read2_b64 v[220:223], v5 offset0:36 offset1:38
    ds_read2_b64 v[200:203], v5 offset0:64 offset1:66
    ds_read2_b64 v[204:207], v5 offset0:68 offset1:70
    ds_read2_b64 v[224:227], v5 offset0:96 offset1:98
    ds_read2_b64 v[228:231], v5 offset0:100 offset1:102
    ds_read2_b64 v[248:251], v5 offset0:128 offset1:130
    ds_read2_b64 v[252:255], v5 offset0:132 offset1:134
    s_waitcnt lgkmcnt(0)
    v_mfma_f32_32x32x16_bf16 v[16:31], v[104:107], v[96:99], v[16:31]
    s_barrier
    ds_read_b64_tr_b16 v[56:57], v13 offset:0
    ds_read_b64_tr_b16 v[58:59], v13 offset:2048
    ds_read_b128 v[48:51], v10 offset:0
    v_mfma_f32_32x32x16_bf16 v[32:47], v[104:107], v[100:103], v[32:47]
    s_waitcnt vmcnt(0)
    v_lshlrev_b32 v144, 16, v160
    v_and_b32 v145, 0xffff0000, v160
    ds_read_b128 v[52:55], v10 offset:4096
    ds_read_b64_tr_b16 v[68:69], v13 offset:4096
    ds_read_b64_tr_b16 v[70:71], v13 offset:6144
    v_mfma_f32_32x32x16_bf16 v[16:31], v[116:119], v[108:111], v[16:31]
    v_lshlrev_b32 v146, 16, v161
    v_and_b32 v147, 0xffff0000, v161
    v_lshlrev_b32 v148, 16, v162
    ds_read_b128 v[60:63], v10 offset:1024
    ds_read_b128 v[64:67], v10 offset:5120
    ds_read_b64_tr_b16 v[80:81], v13 offset:8192
    v_mfma_f32_32x32x16_bf16 v[32:47], v[116:119], v[112:115], v[32:47]
    v_and_b32 v149, 0xffff0000, v162
    v_lshlrev_b32 v150, 16, v163
    v_and_b32 v151, 0xffff0000, v163
    ds_read_b64_tr_b16 v[82:83], v13 offset:10240
    ds_read_b128 v[72:75], v10 offset:2048
    ds_read_b128 v[76:79], v10 offset:6144
    v_mfma_f32_32x32x16_bf16 v[16:31], v[128:131], v[120:123], v[16:31]
    v_lshlrev_b32 v152, 16, v164
    v_and_b32 v153, 0xffff0000, v164
    v_lshlrev_b32 v154, 16, v165
    ds_read_b64_tr_b16 v[92:93], v13 offset:12288
    ds_read_b64_tr_b16 v[94:95], v13 offset:14336
    ds_read_b128 v[84:87], v10 offset:3072
    v_mfma_f32_32x32x16_bf16 v[32:47], v[128:131], v[124:127], v[32:47]
    v_and_b32 v155, 0xffff0000, v165
    v_lshlrev_b32 v156, 16, v166
    v_and_b32 v157, 0xffff0000, v166
    ds_read_b128 v[88:91], v10 offset:7168
    v_mfma_f32_32x32x16_bf16 v[16:31], v[140:143], v[132:135], v[16:31]
    v_lshlrev_b32 v158, 16, v167
    v_and_b32 v159, 0xffff0000, v167
    v_mfma_f32_32x32x16_bf16 v[32:47], v[140:143], v[136:139], v[32:47]
    s_waitcnt lgkmcnt(0)
    v_mfma_f32_32x32x16_bf16 v[16:31], v[56:59], v[48:51], v[16:31]
    s_barrier
    ds_read_b64_tr_b16 v[104:105], v13 offset:24576
    ds_read_b64_tr_b16 v[106:107], v13 offset:26624
    ds_read_b128 v[96:99], v10 offset:24576
    v_mfma_f32_32x32x16_bf16 v[32:47], v[56:59], v[52:55], v[32:47]
    v_lshlrev_b32 v160, 16, v168
    v_and_b32 v161, 0xffff0000, v168
    v_lshlrev_b32 v162, 16, v169
    v_and_b32 v163, 0xffff0000, v169
    v_lshlrev_b32 v164, 16, v170
    ds_read_b128 v[100:103], v10 offset:28672
    ds_read_b64_tr_b16 v[116:117], v13 offset:28672
    ds_read_b64_tr_b16 v[118:119], v13 offset:30720
    v_mfma_f32_32x32x16_bf16 v[16:31], v[68:71], v[60:63], v[16:31]
    v_and_b32 v165, 0xffff0000, v170
    v_lshlrev_b32 v166, 16, v171
    v_and_b32 v167, 0xffff0000, v171
    v_lshlrev_b32 v168, 16, v172
    v_and_b32 v169, 0xffff0000, v172
    ds_read_b128 v[108:111], v10 offset:25600
    ds_read_b128 v[112:115], v10 offset:29696
    ds_read_b64_tr_b16 v[128:129], v13 offset:32768
    v_mfma_f32_32x32x16_bf16 v[32:47], v[68:71], v[64:67], v[32:47]
    v_lshlrev_b32 v170, 16, v173
    v_and_b32 v171, 0xffff0000, v173
    v_lshlrev_b32 v172, 16, v174
    v_and_b32 v173, 0xffff0000, v174
    v_lshlrev_b32 v174, 16, v175
    ds_read_b64_tr_b16 v[130:131], v13 offset:34816
    ds_read_b128 v[120:123], v10 offset:26624
    ds_read_b128 v[124:127], v10 offset:30720
    v_mfma_f32_32x32x16_bf16 v[16:31], v[80:83], v[72:75], v[16:31]
    v_and_b32 v175, 0xffff0000, v175
    v_lshlrev_b32 v176, 16, v184
    v_and_b32 v177, 0xffff0000, v184
    v_lshlrev_b32 v178, 16, v185
    v_and_b32 v179, 0xffff0000, v185
    ds_read_b64_tr_b16 v[140:141], v13 offset:36864
    ds_read_b64_tr_b16 v[142:143], v13 offset:38912
    ds_read_b128 v[132:135], v10 offset:27648
    v_mfma_f32_32x32x16_bf16 v[32:47], v[80:83], v[76:79], v[32:47]
    v_lshlrev_b32 v180, 16, v186
    v_and_b32 v181, 0xffff0000, v186
    v_lshlrev_b32 v182, 16, v187
    v_and_b32 v183, 0xffff0000, v187
    v_lshlrev_b32 v184, 16, v188
    ds_read_b128 v[136:139], v10 offset:31744
    v_mfma_f32_32x32x16_bf16 v[16:31], v[92:95], v[84:87], v[16:31]
    v_and_b32 v185, 0xffff0000, v188
    v_lshlrev_b32 v186, 16, v189
    v_and_b32 v187, 0xffff0000, v189
    v_lshlrev_b32 v188, 16, v190
    v_and_b32 v189, 0xffff0000, v190
    v_mfma_f32_32x32x16_bf16 v[32:47], v[92:95], v[88:91], v[32:47]
    v_lshlrev_b32 v190, 16, v191
    v_and_b32 v191, 0xffff0000, v191
    s_waitcnt lgkmcnt(0)
    v_mfma_f32_32x32x16_bf16 v[16:31], v[104:107], v[96:99], v[16:31]
    s_barrier
    ds_read_b64_tr_b16 v[56:57], v11 offset:0
    ds_read_b64_tr_b16 v[58:59], v11 offset:2048
    ds_read_b128 v[48:51], v8 offset:0
    v_mfma_f32_32x32x16_bf16 v[32:47], v[104:107], v[100:103], v[32:47]
    v_lshlrev_b32 v192, 16, v200
    v_and_b32 v193, 0xffff0000, v200
    v_add_f32 v192, 1.0, v192
    v_add_f32 v193, 1.0, v193
    v_cvt_pk_bf16_f32 v208, v192, v193
    v_lshlrev_b32 v194, 16, v201
    ds_read_b128 v[52:55], v8 offset:4096
    ds_read_b64_tr_b16 v[68:69], v11 offset:4096
    ds_read_b64_tr_b16 v[70:71], v11 offset:6144
    v_mfma_f32_32x32x16_bf16 v[16:31], v[116:119], v[108:111], v[16:31]
    v_and_b32 v195, 0xffff0000, v201
    v_add_f32 v194, 1.0, v194
    v_add_f32 v195, 1.0, v195
    v_cvt_pk_bf16_f32 v209, v194, v195
    v_lshlrev_b32 v196, 16, v202
    v_and_b32 v197, 0xffff0000, v202
    ds_read_b128 v[60:63], v8 offset:1024
    ds_read_b128 v[64:67], v8 offset:5120
    ds_read_b64_tr_b16 v[80:81], v11 offset:8192
    v_mfma_f32_32x32x16_bf16 v[32:47], v[116:119], v[112:115], v[32:47]
    v_add_f32 v196, 1.0, v196
    v_add_f32 v197, 1.0, v197
    v_cvt_pk_bf16_f32 v210, v196, v197
    v_lshlrev_b32 v198, 16, v203
    v_and_b32 v199, 0xffff0000, v203
    v_add_f32 v198, 1.0, v198
    ds_read_b64_tr_b16 v[82:83], v11 offset:10240
    ds_read_b128 v[72:75], v8 offset:2048
    ds_read_b128 v[76:79], v8 offset:6144
    v_mfma_f32_32x32x16_bf16 v[16:31], v[128:131], v[120:123], v[16:31]
    v_add_f32 v199, 1.0, v199
    v_cvt_pk_bf16_f32 v211, v198, v199
    v_lshlrev_b32 v200, 16, v204
    v_and_b32 v201, 0xffff0000, v204
    v_add_f32 v200, 1.0, v200
    v_add_f32 v201, 1.0, v201
    ds_read_b64_tr_b16 v[92:93], v11 offset:12288
    ds_read_b64_tr_b16 v[94:95], v11 offset:14336
    ds_read_b128 v[84:87], v8 offset:3072
    v_mfma_f32_32x32x16_bf16 v[32:47], v[128:131], v[124:127], v[32:47]
    v_cvt_pk_bf16_f32 v212, v200, v201
    v_lshlrev_b32 v202, 16, v205
    v_and_b32 v203, 0xffff0000, v205
    v_add_f32 v202, 1.0, v202
    v_add_f32 v203, 1.0, v203
    v_cvt_pk_bf16_f32 v213, v202, v203
    ds_read_b128 v[88:91], v8 offset:7168
    v_mfma_f32_32x32x16_bf16 v[16:31], v[140:143], v[132:135], v[16:31]
    v_lshlrev_b32 v204, 16, v206
    v_and_b32 v205, 0xffff0000, v206
    v_add_f32 v204, 1.0, v204
    v_add_f32 v205, 1.0, v205
    v_cvt_pk_bf16_f32 v214, v204, v205
    v_lshlrev_b32 v206, 16, v207
    v_mfma_f32_32x32x16_bf16 v[32:47], v[140:143], v[136:139], v[32:47]
    v_and_b32 v207, 0xffff0000, v207
    v_add_f32 v206, 1.0, v206
    v_add_f32 v207, 1.0, v207
    v_cvt_pk_bf16_f32 v215, v206, v207
    s_waitcnt lgkmcnt(0)
    v_mfma_f32_32x32x16_bf16 v[16:31], v[56:59], v[48:51], v[16:31]
    s_barrier
    ds_read_b64_tr_b16 v[104:105], v11 offset:24576
    ds_read_b64_tr_b16 v[106:107], v11 offset:26624
    ds_read_b128 v[96:99], v8 offset:24576
    v_mfma_f32_32x32x16_bf16 v[32:47], v[56:59], v[52:55], v[32:47]
    v_lshlrev_b32 v192, 16, v208
    v_and_b32 v193, 0xffff0000, v208
    v_lshlrev_b32 v6, 16, v248
    v_and_b32 v7, 0xffff0000, v248
    v_mul_f32 v192, v192, v6
    v_mul_f32 v193, v193, v7
    v_lshlrev_b32 v194, 16, v209
    ds_read_b128 v[100:103], v8 offset:28672
    ds_read_b64_tr_b16 v[116:117], v11 offset:28672
    ds_read_b64_tr_b16 v[118:119], v11 offset:30720
    v_mfma_f32_32x32x16_bf16 v[16:31], v[68:71], v[60:63], v[16:31]
    v_and_b32 v195, 0xffff0000, v209
    v_lshlrev_b32 v6, 16, v249
    v_and_b32 v7, 0xffff0000, v249
    v_mul_f32 v194, v194, v6
    v_mul_f32 v195, v195, v7
    v_lshlrev_b32 v196, 16, v210
    v_and_b32 v197, 0xffff0000, v210
    ds_read_b128 v[108:111], v8 offset:25600
    ds_read_b128 v[112:115], v8 offset:29696
    ds_read_b64_tr_b16 v[128:129], v11 offset:32768
    v_mfma_f32_32x32x16_bf16 v[32:47], v[68:71], v[64:67], v[32:47]
    v_lshlrev_b32 v6, 16, v250
    v_and_b32 v7, 0xffff0000, v250
    v_mul_f32 v196, v196, v6
    v_mul_f32 v197, v197, v7
    v_lshlrev_b32 v198, 16, v211
    v_and_b32 v199, 0xffff0000, v211
    v_lshlrev_b32 v6, 16, v251
    ds_read_b64_tr_b16 v[130:131], v11 offset:34816
    ds_read_b128 v[120:123], v8 offset:26624
    ds_read_b128 v[124:127], v8 offset:30720
    v_mfma_f32_32x32x16_bf16 v[16:31], v[80:83], v[72:75], v[16:31]
    v_and_b32 v7, 0xffff0000, v251
    v_mul_f32 v198, v198, v6
    v_mul_f32 v199, v199, v7
    v_lshlrev_b32 v200, 16, v212
    v_and_b32 v201, 0xffff0000, v212
    v_lshlrev_b32 v6, 16, v252
    v_and_b32 v7, 0xffff0000, v252
    ds_read_b64_tr_b16 v[140:141], v11 offset:36864
    ds_read_b64_tr_b16 v[142:143], v11 offset:38912
    ds_read_b128 v[132:135], v8 offset:27648
    v_mfma_f32_32x32x16_bf16 v[32:47], v[80:83], v[76:79], v[32:47]
    v_mul_f32 v200, v200, v6
    v_mul_f32 v201, v201, v7
    v_lshlrev_b32 v202, 16, v213
    v_and_b32 v203, 0xffff0000, v213
    v_lshlrev_b32 v6, 16, v253
    v_and_b32 v7, 0xffff0000, v253
    v_mul_f32 v202, v202, v6
    ds_read_b128 v[136:139], v8 offset:31744
    v_mfma_f32_32x32x16_bf16 v[16:31], v[92:95], v[84:87], v[16:31]
    v_mul_f32 v203, v203, v7
    v_lshlrev_b32 v204, 16, v214
    v_and_b32 v205, 0xffff0000, v214
    v_lshlrev_b32 v6, 16, v254
    v_and_b32 v7, 0xffff0000, v254
    v_mul_f32 v204, v204, v6
    v_mul_f32 v205, v205, v7
    v_mfma_f32_32x32x16_bf16 v[32:47], v[92:95], v[88:91], v[32:47]
    v_lshlrev_b32 v206, 16, v215
    v_and_b32 v207, 0xffff0000, v215
    v_lshlrev_b32 v6, 16, v255
    v_and_b32 v7, 0xffff0000, v255
    v_mul_f32 v206, v206, v6
    v_mul_f32 v207, v207, v7
    s_waitcnt lgkmcnt(0)
    v_mfma_f32_32x32x16_bf16 v[16:31], v[104:107], v[96:99], v[16:31]
    s_barrier
    ds_read_b64_tr_b16 v[56:57], v12 offset:0
    ds_read_b64_tr_b16 v[58:59], v12 offset:2048
    ds_read_b128 v[48:51], v9 offset:0
    v_mfma_f32_32x32x16_bf16 v[32:47], v[104:107], v[100:103], v[32:47]
    v_add_f32 v14, v192, v193
    v_add_f32 v14, v14, v194
    v_add_f32 v14, v14, v195
    v_add_f32 v14, v14, v196
    v_add_f32 v14, v14, v197
    v_add_f32 v14, v14, v198
    ds_read_b128 v[52:55], v9 offset:4096
    ds_read_b64_tr_b16 v[68:69], v12 offset:4096
    ds_read_b64_tr_b16 v[70:71], v12 offset:6144
    v_mfma_f32_32x32x16_bf16 v[16:31], v[116:119], v[108:111], v[16:31]
    v_add_f32 v14, v14, v199
    v_add_f32 v14, v14, v200
    v_add_f32 v14, v14, v201
    v_add_f32 v14, v14, v202
    v_add_f32 v14, v14, v203
    v_add_f32 v14, v14, v204
    ds_read_b128 v[60:63], v9 offset:1024
    ds_read_b128 v[64:67], v9 offset:5120
    ds_read_b64_tr_b16 v[80:81], v12 offset:8192
    v_mfma_f32_32x32x16_bf16 v[32:47], v[116:119], v[112:115], v[32:47]
    v_add_f32 v14, v14, v205
    v_add_f32 v14, v14, v206
    v_add_f32 v14, v14, v207
    v_lshlrev_b32 v6, 3, v3
    v_lshl_add_u32 v6, v4, 3, v6
    s_lshl_b32 s30, s18, 6
    ds_read_b64_tr_b16 v[82:83], v12 offset:10240
    ds_read_b128 v[72:75], v9 offset:2048
    ds_read_b128 v[76:79], v9 offset:6144
    v_mfma_f32_32x32x16_bf16 v[16:31], v[128:131], v[120:123], v[16:31]
    v_add_u32 v6, s30, v6
    v_lshlrev_b32 v7, 8, v3
    v_add_u32 v7, 24576, v7
    v_add_u32 v248, 0, v6
    v_and_b32 v248, 255, v248
    v_add_u32 v248, v248, v7
    ds_read_b64_tr_b16 v[92:93], v12 offset:12288
    ds_read_b64_tr_b16 v[94:95], v12 offset:14336
    ds_read_b128 v[84:87], v9 offset:3072
    v_mfma_f32_32x32x16_bf16 v[32:47], v[128:131], v[124:127], v[32:47]
    v_add_u32 v249, 16, v6
    v_and_b32 v249, 255, v249
    v_add_u32 v249, v249, v7
    v_add_u32 v250, 32, v6
    v_and_b32 v250, 255, v250
    v_add_u32 v250, v250, v7
    ds_read_b128 v[88:91], v9 offset:7168
    v_mfma_f32_32x32x16_bf16 v[16:31], v[140:143], v[132:135], v[16:31]
    v_add_u32 v251, 48, v6
    v_and_b32 v251, 255, v251
    v_add_u32 v251, v251, v7
    s_lshl_b32 s30, s18, 11
    v_lshlrev_b32 v6, 10, v4
    v_lshl_add_u32 v6, v3, 4, v6
    v_mfma_f32_32x32x16_bf16 v[32:47], v[140:143], v[136:139], v[32:47]
    v_add_u32 v252, s30, v6
    v_lshlrev_b32 v253, 3, v3
    v_lshlrev_b32 v5, 11, v3
    v_lshl_add_u32 v5, v4, 4, v5
    s_waitcnt lgkmcnt(0)
    v_mfma_f32_32x32x16_bf16 v[16:31], v[56:59], v[48:51], v[16:31]
    s_barrier
    ds_read_b64_tr_b16 v[104:105], v12 offset:24576
    ds_read_b64_tr_b16 v[106:107], v12 offset:26624
    ds_read_b128 v[96:99], v9 offset:24576
    v_mfma_f32_32x32x16_bf16 v[32:47], v[56:59], v[52:55], v[32:47]
    ds_read_b128 v[100:103], v9 offset:28672
    ds_read_b64_tr_b16 v[116:117], v12 offset:28672
    ds_read_b64_tr_b16 v[118:119], v12 offset:30720
    v_mfma_f32_32x32x16_bf16 v[16:31], v[68:71], v[60:63], v[16:31]
    ds_read_b128 v[108:111], v9 offset:25600
    ds_read_b128 v[112:115], v9 offset:29696
    ds_read_b64_tr_b16 v[128:129], v12 offset:32768
    v_mfma_f32_32x32x16_bf16 v[32:47], v[68:71], v[64:67], v[32:47]
    ds_read_b64_tr_b16 v[130:131], v12 offset:34816
    ds_read_b128 v[120:123], v9 offset:26624
    ds_read_b128 v[124:127], v9 offset:30720
    v_mfma_f32_32x32x16_bf16 v[16:31], v[80:83], v[72:75], v[16:31]
    ds_read_b64_tr_b16 v[140:141], v12 offset:36864
    ds_read_b64_tr_b16 v[142:143], v12 offset:38912
    ds_read_b128 v[132:135], v9 offset:27648
    v_mfma_f32_32x32x16_bf16 v[32:47], v[80:83], v[76:79], v[32:47]
    ds_read_b128 v[136:139], v9 offset:31744
    v_mfma_f32_32x32x16_bf16 v[16:31], v[92:95], v[84:87], v[16:31]
    v_mfma_f32_32x32x16_bf16 v[32:47], v[92:95], v[88:91], v[32:47]
    s_waitcnt lgkmcnt(0)
    v_mfma_f32_32x32x16_bf16 v[16:31], v[104:107], v[96:99], v[16:31]
    v_mfma_f32_32x32x16_bf16 v[16:31], v[116:119], v[108:111], v[16:31]
    v_mfma_f32_32x32x16_bf16 v[16:31], v[128:131], v[120:123], v[16:31]
    v_mfma_f32_32x32x16_bf16 v[16:31], v[140:143], v[132:135], v[16:31]
    v_mfma_f32_32x32x16_bf16 v[32:47], v[104:107], v[100:103], v[32:47]
    v_mfma_f32_32x32x16_bf16 v[32:47], v[116:119], v[112:115], v[32:47]
    v_mfma_f32_32x32x16_bf16 v[32:47], v[128:131], v[124:127], v[32:47]
    v_mfma_f32_32x32x16_bf16 v[32:47], v[140:143], v[136:139], v[32:47]
    v_cvt_pk_bf16_f32 v72, v16, v17
    v_cvt_pk_bf16_f32 v73, v18, v19
    v_cvt_pk_bf16_f32 v74, v20, v21
    v_cvt_pk_bf16_f32 v75, v22, v23
    v_cvt_pk_bf16_f32 v76, v24, v25
    v_cvt_pk_bf16_f32 v77, v26, v27
    v_cvt_pk_bf16_f32 v78, v28, v29
    v_cvt_pk_bf16_f32 v79, v30, v31
    v_lshlrev_b32 v16, 16, v72
    v_and_b32 v17, 0xffff0000, v72
    v_lshlrev_b32 v18, 16, v73
    v_and_b32 v19, 0xffff0000, v73
    v_lshlrev_b32 v20, 16, v74
    v_and_b32 v21, 0xffff0000, v74
    v_lshlrev_b32 v22, 16, v75
    v_and_b32 v23, 0xffff0000, v75
    v_lshlrev_b32 v24, 16, v76
    v_and_b32 v25, 0xffff0000, v76
    v_lshlrev_b32 v26, 16, v77
    v_and_b32 v27, 0xffff0000, v77
    v_lshlrev_b32 v28, 16, v78
    v_and_b32 v29, 0xffff0000, v78
    v_lshlrev_b32 v30, 16, v79
    v_and_b32 v31, 0xffff0000, v79
    v_pk_mul_f32 v[16:17], v[16:17], v[176:177]
    v_pk_mul_f32 v[18:19], v[18:19], v[178:179]
    v_pk_mul_f32 v[20:21], v[20:21], v[180:181]
    v_pk_mul_f32 v[22:23], v[22:23], v[182:183]
    v_pk_mul_f32 v[24:25], v[24:25], v[184:185]
    v_pk_mul_f32 v[26:27], v[26:27], v[186:187]
    v_pk_mul_f32 v[28:29], v[28:29], v[188:189]
    v_pk_mul_f32 v[30:31], v[30:31], v[190:191]
    v_cvt_pk_bf16_f32 v72, v16, v17
    v_cvt_pk_bf16_f32 v73, v18, v19
    v_cvt_pk_bf16_f32 v74, v20, v21
    v_cvt_pk_bf16_f32 v75, v22, v23
    v_cvt_pk_bf16_f32 v76, v24, v25
    v_cvt_pk_bf16_f32 v77, v26, v27
    v_cvt_pk_bf16_f32 v78, v28, v29
    v_cvt_pk_bf16_f32 v79, v30, v31
    v_lshlrev_b32 v16, 16, v72
    v_and_b32 v17, 0xffff0000, v72
    v_lshlrev_b32 v18, 16, v73
    v_and_b32 v19, 0xffff0000, v73
    v_lshlrev_b32 v20, 16, v74
    v_and_b32 v21, 0xffff0000, v74
    v_lshlrev_b32 v22, 16, v75
    v_and_b32 v23, 0xffff0000, v75
    v_lshlrev_b32 v24, 16, v76
    v_and_b32 v25, 0xffff0000, v76
    v_lshlrev_b32 v26, 16, v77
    v_and_b32 v27, 0xffff0000, v77
    v_lshlrev_b32 v28, 16, v78
    v_and_b32 v29, 0xffff0000, v78
    v_lshlrev_b32 v30, 16, v79
    v_and_b32 v31, 0xffff0000, v79
    v_pk_add_f32 v[16:17], v[16:17], v[144:145]
    v_pk_add_f32 v[18:19], v[18:19], v[146:147]
    v_pk_add_f32 v[20:21], v[20:21], v[148:149]
    v_pk_add_f32 v[22:23], v[22:23], v[150:151]
    v_pk_add_f32 v[24:25], v[24:25], v[152:153]
    v_pk_add_f32 v[26:27], v[26:27], v[154:155]
    v_pk_add_f32 v[28:29], v[28:29], v[156:157]
    v_pk_add_f32 v[30:31], v[30:31], v[158:159]
    v_cvt_pk_bf16_f32 v48, v16, v17
    v_cvt_pk_bf16_f32 v49, v18, v19
    v_cvt_pk_bf16_f32 v50, v20, v21
    v_cvt_pk_bf16_f32 v51, v22, v23
    v_cvt_pk_bf16_f32 v52, v24, v25
    v_cvt_pk_bf16_f32 v53, v26, v27
    v_cvt_pk_bf16_f32 v54, v28, v29
    v_cvt_pk_bf16_f32 v55, v30, v31
    v_lshlrev_b32 v16, 16, v48
    v_and_b32 v17, 0xffff0000, v48
    v_lshlrev_b32 v18, 16, v49
    v_and_b32 v19, 0xffff0000, v49
    v_lshlrev_b32 v20, 16, v50
    v_and_b32 v21, 0xffff0000, v50
    v_lshlrev_b32 v22, 16, v51
    v_and_b32 v23, 0xffff0000, v51
    v_lshlrev_b32 v24, 16, v52
    v_and_b32 v25, 0xffff0000, v52
    v_lshlrev_b32 v26, 16, v53
    v_and_b32 v27, 0xffff0000, v53
    v_lshlrev_b32 v28, 16, v54
    v_and_b32 v29, 0xffff0000, v54
    v_lshlrev_b32 v30, 16, v55
    v_and_b32 v31, 0xffff0000, v55
    ds_write_b64 v248, v[48:49] offset:0
    ds_write_b64 v249, v[50:51] offset:0
    ds_write_b64 v250, v[52:53] offset:0
    ds_write_b64 v251, v[54:55] offset:0
    v_pk_add_f32 v[72:73], v[16:17], v[18:19]
    v_pk_add_f32 v[74:75], v[20:21], v[22:23]
    v_pk_add_f32 v[76:77], v[24:25], v[26:27]
    v_pk_add_f32 v[78:79], v[28:29], v[30:31]
    v_pk_mul_f32 v[80:81], v[16:17], v[192:193]
    v_pk_mul_f32 v[82:83], v[18:19], v[194:195]
    v_pk_add_f32 v[72:73], v[72:73], v[74:75]
    v_pk_add_f32 v[76:77], v[76:77], v[78:79]
    v_pk_fma_f32 v[80:81], v[20:21], v[196:197], v[80:81]
    v_pk_fma_f32 v[82:83], v[22:23], v[198:199], v[82:83]
    v_pk_add_f32 v[72:73], v[72:73], v[76:77]
    v_pk_fma_f32 v[80:81], v[24:25], v[200:201], v[80:81]
    v_pk_fma_f32 v[82:83], v[26:27], v[202:203], v[82:83]
    v_add_f32 v64, v72, v73
    v_pk_fma_f32 v[80:81], v[28:29], v[204:205], v[80:81]
    v_pk_fma_f32 v[82:83], v[30:31], v[206:207], v[82:83]
    v_mul_f32 v72, 0x3d800000, v64
    v_pk_add_f32 v[80:81], v[80:81], v[82:83]
    v_mov_b32 v67, v14
    v_add_f32 v66, v80, v81
    v_pk_add_f32 v[80:81], v[16:17], v[72:73] op_sel_hi:[1,0] neg_lo:[0,1] neg_hi:[0,1]
    v_pk_add_f32 v[82:83], v[18:19], v[72:73] op_sel_hi:[1,0] neg_lo:[0,1] neg_hi:[0,1]
    v_pk_add_f32 v[84:85], v[20:21], v[72:73] op_sel_hi:[1,0] neg_lo:[0,1] neg_hi:[0,1]
    v_pk_add_f32 v[86:87], v[22:23], v[72:73] op_sel_hi:[1,0] neg_lo:[0,1] neg_hi:[0,1]
    v_pk_add_f32 v[88:89], v[24:25], v[72:73] op_sel_hi:[1,0] neg_lo:[0,1] neg_hi:[0,1]
    v_pk_add_f32 v[90:91], v[26:27], v[72:73] op_sel_hi:[1,0] neg_lo:[0,1] neg_hi:[0,1]
    v_pk_add_f32 v[92:93], v[28:29], v[72:73] op_sel_hi:[1,0] neg_lo:[0,1] neg_hi:[0,1]
    v_pk_add_f32 v[94:95], v[30:31], v[72:73] op_sel_hi:[1,0] neg_lo:[0,1] neg_hi:[0,1]
    v_pk_mul_f32 v[74:75], v[80:81], v[80:81]
    v_pk_mul_f32 v[76:77], v[82:83], v[82:83]
    v_pk_fma_f32 v[74:75], v[84:85], v[84:85], v[74:75]
    v_pk_fma_f32 v[76:77], v[86:87], v[86:87], v[76:77]
    v_pk_fma_f32 v[74:75], v[88:89], v[88:89], v[74:75]
    v_pk_fma_f32 v[76:77], v[90:91], v[90:91], v[76:77]
    v_pk_fma_f32 v[74:75], v[92:93], v[92:93], v[74:75]
    v_pk_fma_f32 v[76:77], v[94:95], v[94:95], v[76:77]
    v_pk_add_f32 v[74:75], v[74:75], v[76:77]
    v_add_f32 v65, v74, v75
    ds_write_b128 v252, v[64:67] offset:49152
    v_cvt_pk_bf16_f32 v72, v32, v33
    v_cvt_pk_bf16_f32 v73, v34, v35
    v_cvt_pk_bf16_f32 v74, v36, v37
    v_cvt_pk_bf16_f32 v75, v38, v39
    v_cvt_pk_bf16_f32 v76, v40, v41
    v_cvt_pk_bf16_f32 v77, v42, v43
    v_cvt_pk_bf16_f32 v78, v44, v45
    v_cvt_pk_bf16_f32 v79, v46, v47
    v_lshlrev_b32 v32, 16, v72
    v_and_b32 v33, 0xffff0000, v72
    v_lshlrev_b32 v34, 16, v73
    v_and_b32 v35, 0xffff0000, v73
    v_lshlrev_b32 v36, 16, v74
    v_and_b32 v37, 0xffff0000, v74
    v_lshlrev_b32 v38, 16, v75
    v_and_b32 v39, 0xffff0000, v75
    v_lshlrev_b32 v40, 16, v76
    v_and_b32 v41, 0xffff0000, v76
    v_lshlrev_b32 v42, 16, v77
    v_and_b32 v43, 0xffff0000, v77
    v_lshlrev_b32 v44, 16, v78
    v_and_b32 v45, 0xffff0000, v78
    v_lshlrev_b32 v46, 16, v79
    v_and_b32 v47, 0xffff0000, v79
    v_pk_mul_f32 v[32:33], v[32:33], v[176:177]
    v_pk_mul_f32 v[34:35], v[34:35], v[178:179]
    v_pk_mul_f32 v[36:37], v[36:37], v[180:181]
    v_pk_mul_f32 v[38:39], v[38:39], v[182:183]
    v_pk_mul_f32 v[40:41], v[40:41], v[184:185]
    v_pk_mul_f32 v[42:43], v[42:43], v[186:187]
    v_pk_mul_f32 v[44:45], v[44:45], v[188:189]
    v_pk_mul_f32 v[46:47], v[46:47], v[190:191]
    v_cvt_pk_bf16_f32 v72, v32, v33
    v_cvt_pk_bf16_f32 v73, v34, v35
    v_cvt_pk_bf16_f32 v74, v36, v37
    v_cvt_pk_bf16_f32 v75, v38, v39
    v_cvt_pk_bf16_f32 v76, v40, v41
    v_cvt_pk_bf16_f32 v77, v42, v43
    v_cvt_pk_bf16_f32 v78, v44, v45
    v_cvt_pk_bf16_f32 v79, v46, v47
    v_lshlrev_b32 v32, 16, v72
    v_and_b32 v33, 0xffff0000, v72
    v_lshlrev_b32 v34, 16, v73
    v_and_b32 v35, 0xffff0000, v73
    v_lshlrev_b32 v36, 16, v74
    v_and_b32 v37, 0xffff0000, v74
    v_lshlrev_b32 v38, 16, v75
    v_and_b32 v39, 0xffff0000, v75
    v_lshlrev_b32 v40, 16, v76
    v_and_b32 v41, 0xffff0000, v76
    v_lshlrev_b32 v42, 16, v77
    v_and_b32 v43, 0xffff0000, v77
    v_lshlrev_b32 v44, 16, v78
    v_and_b32 v45, 0xffff0000, v78
    v_lshlrev_b32 v46, 16, v79
    v_and_b32 v47, 0xffff0000, v79
    v_pk_add_f32 v[32:33], v[32:33], v[160:161]
    v_pk_add_f32 v[34:35], v[34:35], v[162:163]
    v_pk_add_f32 v[36:37], v[36:37], v[164:165]
    v_pk_add_f32 v[38:39], v[38:39], v[166:167]
    v_pk_add_f32 v[40:41], v[40:41], v[168:169]
    v_pk_add_f32 v[42:43], v[42:43], v[170:171]
    v_pk_add_f32 v[44:45], v[44:45], v[172:173]
    v_pk_add_f32 v[46:47], v[46:47], v[174:175]
    v_cvt_pk_bf16_f32 v56, v32, v33
    v_cvt_pk_bf16_f32 v57, v34, v35
    v_cvt_pk_bf16_f32 v58, v36, v37
    v_cvt_pk_bf16_f32 v59, v38, v39
    v_cvt_pk_bf16_f32 v60, v40, v41
    v_cvt_pk_bf16_f32 v61, v42, v43
    v_cvt_pk_bf16_f32 v62, v44, v45
    v_cvt_pk_bf16_f32 v63, v46, v47
    v_lshlrev_b32 v32, 16, v56
    v_and_b32 v33, 0xffff0000, v56
    v_lshlrev_b32 v34, 16, v57
    v_and_b32 v35, 0xffff0000, v57
    v_lshlrev_b32 v36, 16, v58
    v_and_b32 v37, 0xffff0000, v58
    v_lshlrev_b32 v38, 16, v59
    v_and_b32 v39, 0xffff0000, v59
    v_lshlrev_b32 v40, 16, v60
    v_and_b32 v41, 0xffff0000, v60
    v_lshlrev_b32 v42, 16, v61
    v_and_b32 v43, 0xffff0000, v61
    v_lshlrev_b32 v44, 16, v62
    v_and_b32 v45, 0xffff0000, v62
    v_lshlrev_b32 v46, 16, v63
    v_and_b32 v47, 0xffff0000, v63
    ds_write_b64 v248, v[56:57] offset:8192
    ds_write_b64 v249, v[58:59] offset:8192
    ds_write_b64 v250, v[60:61] offset:8192
    ds_write_b64 v251, v[62:63] offset:8192
    v_pk_add_f32 v[72:73], v[32:33], v[34:35]
    v_pk_add_f32 v[74:75], v[36:37], v[38:39]
    v_pk_add_f32 v[76:77], v[40:41], v[42:43]
    v_pk_add_f32 v[78:79], v[44:45], v[46:47]
    v_pk_mul_f32 v[80:81], v[32:33], v[192:193]
    v_pk_mul_f32 v[82:83], v[34:35], v[194:195]
    v_pk_add_f32 v[72:73], v[72:73], v[74:75]
    v_pk_add_f32 v[76:77], v[76:77], v[78:79]
    v_pk_fma_f32 v[80:81], v[36:37], v[196:197], v[80:81]
    v_pk_fma_f32 v[82:83], v[38:39], v[198:199], v[82:83]
    v_pk_add_f32 v[72:73], v[72:73], v[76:77]
    v_pk_fma_f32 v[80:81], v[40:41], v[200:201], v[80:81]
    v_pk_fma_f32 v[82:83], v[42:43], v[202:203], v[82:83]
    v_add_f32 v68, v72, v73
    v_pk_fma_f32 v[80:81], v[44:45], v[204:205], v[80:81]
    v_pk_fma_f32 v[82:83], v[46:47], v[206:207], v[82:83]
    v_mul_f32 v72, 0x3d800000, v68
    v_pk_add_f32 v[80:81], v[80:81], v[82:83]
    v_mov_b32 v71, v14
    v_add_f32 v70, v80, v81
    v_pk_add_f32 v[80:81], v[32:33], v[72:73] op_sel_hi:[1,0] neg_lo:[0,1] neg_hi:[0,1]
    v_pk_add_f32 v[82:83], v[34:35], v[72:73] op_sel_hi:[1,0] neg_lo:[0,1] neg_hi:[0,1]
    v_pk_add_f32 v[84:85], v[36:37], v[72:73] op_sel_hi:[1,0] neg_lo:[0,1] neg_hi:[0,1]
    v_pk_add_f32 v[86:87], v[38:39], v[72:73] op_sel_hi:[1,0] neg_lo:[0,1] neg_hi:[0,1]
    v_pk_add_f32 v[88:89], v[40:41], v[72:73] op_sel_hi:[1,0] neg_lo:[0,1] neg_hi:[0,1]
    v_pk_add_f32 v[90:91], v[42:43], v[72:73] op_sel_hi:[1,0] neg_lo:[0,1] neg_hi:[0,1]
    v_pk_add_f32 v[92:93], v[44:45], v[72:73] op_sel_hi:[1,0] neg_lo:[0,1] neg_hi:[0,1]
    v_pk_add_f32 v[94:95], v[46:47], v[72:73] op_sel_hi:[1,0] neg_lo:[0,1] neg_hi:[0,1]
    v_pk_mul_f32 v[74:75], v[80:81], v[80:81]
    v_pk_mul_f32 v[76:77], v[82:83], v[82:83]
    v_pk_fma_f32 v[74:75], v[84:85], v[84:85], v[74:75]
    v_pk_fma_f32 v[76:77], v[86:87], v[86:87], v[76:77]
    v_pk_fma_f32 v[74:75], v[88:89], v[88:89], v[74:75]
    v_pk_fma_f32 v[76:77], v[90:91], v[90:91], v[76:77]
    v_pk_fma_f32 v[74:75], v[92:93], v[92:93], v[74:75]
    v_pk_fma_f32 v[76:77], v[94:95], v[94:95], v[76:77]
    v_pk_add_f32 v[74:75], v[74:75], v[76:77]
    v_add_f32 v69, v74, v75
    ds_write_b128 v252, v[68:71] offset:49664
    s_waitcnt lgkmcnt(0)
    s_barrier
    s_waitcnt vmcnt(0)
    v_lshlrev_b32 v96, 16, v208
    v_and_b32 v97, 0xffff0000, v208
    v_lshlrev_b32 v112, 16, v216
    v_and_b32 v113, 0xffff0000, v216
    v_lshlrev_b32 v128, 16, v224
    v_and_b32 v129, 0xffff0000, v224
    v_lshlrev_b32 v98, 16, v209
    v_and_b32 v99, 0xffff0000, v209
    v_lshlrev_b32 v114, 16, v217
    v_and_b32 v115, 0xffff0000, v217
    v_lshlrev_b32 v130, 16, v225
    v_and_b32 v131, 0xffff0000, v225
    v_lshlrev_b32 v100, 16, v210
    v_and_b32 v101, 0xffff0000, v210
    v_lshlrev_b32 v116, 16, v218
    v_and_b32 v117, 0xffff0000, v218
    v_lshlrev_b32 v132, 16, v226
    v_and_b32 v133, 0xffff0000, v226
    v_lshlrev_b32 v102, 16, v211
    v_and_b32 v103, 0xffff0000, v211
    v_lshlrev_b32 v118, 16, v219
    v_and_b32 v119, 0xffff0000, v219
    v_lshlrev_b32 v134, 16, v227
    v_and_b32 v135, 0xffff0000, v227
    v_lshlrev_b32 v104, 16, v212
    v_and_b32 v105, 0xffff0000, v212
    v_lshlrev_b32 v120, 16, v220
    v_and_b32 v121, 0xffff0000, v220
    v_lshlrev_b32 v136, 16, v228
    v_and_b32 v137, 0xffff0000, v228
    v_lshlrev_b32 v106, 16, v213
    v_and_b32 v107, 0xffff0000, v213
    v_lshlrev_b32 v122, 16, v221
    v_and_b32 v123, 0xffff0000, v221
    v_lshlrev_b32 v138, 16, v229
    v_and_b32 v139, 0xffff0000, v229
    v_lshlrev_b32 v108, 16, v214
    v_and_b32 v109, 0xffff0000, v214
    v_lshlrev_b32 v124, 16, v222
    v_and_b32 v125, 0xffff0000, v222
    v_lshlrev_b32 v140, 16, v230
    v_and_b32 v141, 0xffff0000, v230
    v_lshlrev_b32 v110, 16, v215
    v_and_b32 v111, 0xffff0000, v215
    v_lshlrev_b32 v126, 16, v223
    v_and_b32 v127, 0xffff0000, v223
    v_lshlrev_b32 v142, 16, v231
    v_and_b32 v143, 0xffff0000, v231
    v_mov_b32 v7, 57856
    v_add_u32 v6, 32, v3
    s_barrier
    ds_read_b64 v[64:65], v253 offset:57344
    ds_read_b64 v[66:67], v253 offset:57600
    ds_read_b32 v7, v7
    s_waitcnt lgkmcnt(0)
    v_readfirstlane_b32 s30, v7

    v_pk_add_f32 v[80:81], v[16:17], v[64:65] op_sel_hi:[1,0] neg_lo:[0,1] neg_hi:[0,1]
    v_pk_add_f32 v[82:83], v[18:19], v[64:65] op_sel_hi:[1,0] neg_lo:[0,1] neg_hi:[0,1]
    v_pk_add_f32 v[84:85], v[20:21], v[64:65] op_sel_hi:[1,0] neg_lo:[0,1] neg_hi:[0,1]
    v_pk_add_f32 v[86:87], v[22:23], v[64:65] op_sel_hi:[1,0] neg_lo:[0,1] neg_hi:[0,1]
    v_pk_add_f32 v[88:89], v[24:25], v[64:65] op_sel_hi:[1,0] neg_lo:[0,1] neg_hi:[0,1]
    v_pk_add_f32 v[90:91], v[26:27], v[64:65] op_sel_hi:[1,0] neg_lo:[0,1] neg_hi:[0,1]
    v_pk_add_f32 v[92:93], v[28:29], v[64:65] op_sel_hi:[1,0] neg_lo:[0,1] neg_hi:[0,1]
    v_pk_add_f32 v[94:95], v[30:31], v[64:65] op_sel_hi:[1,0] neg_lo:[0,1] neg_hi:[0,1]
    v_cvt_pk_bf16_f32 v72, v80, v81
    v_cvt_pk_bf16_f32 v73, v82, v83
    v_cvt_pk_bf16_f32 v74, v84, v85
    v_cvt_pk_bf16_f32 v75, v86, v87
    v_cvt_pk_bf16_f32 v76, v88, v89
    v_cvt_pk_bf16_f32 v77, v90, v91
    v_cvt_pk_bf16_f32 v78, v92, v93
    v_cvt_pk_bf16_f32 v79, v94, v95
    v_lshlrev_b32 v80, 16, v72
    v_and_b32 v81, 0xffff0000, v72
    v_lshlrev_b32 v82, 16, v73
    v_and_b32 v83, 0xffff0000, v73
    v_lshlrev_b32 v84, 16, v74
    v_and_b32 v85, 0xffff0000, v74
    v_lshlrev_b32 v86, 16, v75
    v_and_b32 v87, 0xffff0000, v75
    v_lshlrev_b32 v88, 16, v76
    v_and_b32 v89, 0xffff0000, v76
    v_lshlrev_b32 v90, 16, v77
    v_and_b32 v91, 0xffff0000, v77
    v_lshlrev_b32 v92, 16, v78
    v_and_b32 v93, 0xffff0000, v78
    v_lshlrev_b32 v94, 16, v79
    v_and_b32 v95, 0xffff0000, v79
    v_pk_mul_f32 v[80:81], v[80:81], v[64:65] op_sel:[0,1] op_sel_hi:[1,1]
    v_pk_mul_f32 v[82:83], v[82:83], v[64:65] op_sel:[0,1] op_sel_hi:[1,1]
    v_pk_mul_f32 v[84:85], v[84:85], v[64:65] op_sel:[0,1] op_sel_hi:[1,1]
    v_pk_mul_f32 v[86:87], v[86:87], v[64:65] op_sel:[0,1] op_sel_hi:[1,1]
    v_pk_mul_f32 v[88:89], v[88:89], v[64:65] op_sel:[0,1] op_sel_hi:[1,1]
    v_pk_mul_f32 v[90:91], v[90:91], v[64:65] op_sel:[0,1] op_sel_hi:[1,1]
    v_pk_mul_f32 v[92:93], v[92:93], v[64:65] op_sel:[0,1] op_sel_hi:[1,1]
    v_pk_mul_f32 v[94:95], v[94:95], v[64:65] op_sel:[0,1] op_sel_hi:[1,1]
    v_cvt_pk_bf16_f32 v72, v80, v81
    v_cvt_pk_bf16_f32 v73, v82, v83
    v_cvt_pk_bf16_f32 v74, v84, v85
    v_cvt_pk_bf16_f32 v75, v86, v87
    v_cvt_pk_bf16_f32 v76, v88, v89
    v_cvt_pk_bf16_f32 v77, v90, v91
    v_cvt_pk_bf16_f32 v78, v92, v93
    v_cvt_pk_bf16_f32 v79, v94, v95
    v_lshlrev_b32 v80, 16, v72
    v_and_b32 v81, 0xffff0000, v72
    v_lshlrev_b32 v82, 16, v73
    v_and_b32 v83, 0xffff0000, v73
    v_lshlrev_b32 v84, 16, v74
    v_and_b32 v85, 0xffff0000, v74
    v_lshlrev_b32 v86, 16, v75
    v_and_b32 v87, 0xffff0000, v75
    v_lshlrev_b32 v88, 16, v76
    v_and_b32 v89, 0xffff0000, v76
    v_lshlrev_b32 v90, 16, v77
    v_and_b32 v91, 0xffff0000, v77
    v_lshlrev_b32 v92, 16, v78
    v_and_b32 v93, 0xffff0000, v78
    v_lshlrev_b32 v94, 16, v79
    v_and_b32 v95, 0xffff0000, v79
    v_pk_mul_f32 v[80:81], v[80:81], v[96:97]
    v_pk_mul_f32 v[82:83], v[82:83], v[98:99]
    v_pk_mul_f32 v[84:85], v[84:85], v[100:101]
    v_pk_mul_f32 v[86:87], v[86:87], v[102:103]
    v_pk_mul_f32 v[88:89], v[88:89], v[104:105]
    v_pk_mul_f32 v[90:91], v[90:91], v[106:107]
    v_pk_mul_f32 v[92:93], v[92:93], v[108:109]
    v_pk_mul_f32 v[94:95], v[94:95], v[110:111]
    v_cvt_pk_bf16_f32 v72, v80, v81
    v_cvt_pk_bf16_f32 v73, v82, v83
    v_cvt_pk_bf16_f32 v74, v84, v85
    v_cvt_pk_bf16_f32 v75, v86, v87
    v_cvt_pk_bf16_f32 v76, v88, v89
    v_cvt_pk_bf16_f32 v77, v90, v91
    v_cvt_pk_bf16_f32 v78, v92, v93
    v_cvt_pk_bf16_f32 v79, v94, v95
    v_lshlrev_b32 v80, 16, v72
    v_and_b32 v81, 0xffff0000, v72
    v_lshlrev_b32 v82, 16, v73
    v_and_b32 v83, 0xffff0000, v73
    v_lshlrev_b32 v84, 16, v74
    v_and_b32 v85, 0xffff0000, v74
    v_lshlrev_b32 v86, 16, v75
    v_and_b32 v87, 0xffff0000, v75
    v_lshlrev_b32 v88, 16, v76
    v_and_b32 v89, 0xffff0000, v76
    v_lshlrev_b32 v90, 16, v77
    v_and_b32 v91, 0xffff0000, v77
    v_lshlrev_b32 v92, 16, v78
    v_and_b32 v93, 0xffff0000, v78
    v_lshlrev_b32 v94, 16, v79
    v_and_b32 v95, 0xffff0000, v79
    v_pk_add_f32 v[80:81], v[80:81], v[112:113]
    v_pk_add_f32 v[82:83], v[82:83], v[114:115]
    v_pk_add_f32 v[84:85], v[84:85], v[116:117]
    v_pk_add_f32 v[86:87], v[86:87], v[118:119]
    v_pk_add_f32 v[88:89], v[88:89], v[120:121]
    v_pk_add_f32 v[90:91], v[90:91], v[122:123]
    v_pk_add_f32 v[92:93], v[92:93], v[124:125]
    v_pk_add_f32 v[94:95], v[94:95], v[126:127]
    v_cvt_pk_bf16_f32 v72, v80, v81
    v_cvt_pk_bf16_f32 v73, v82, v83
    v_cvt_pk_bf16_f32 v74, v84, v85
    v_cvt_pk_bf16_f32 v75, v86, v87
    v_cvt_pk_bf16_f32 v76, v88, v89
    v_cvt_pk_bf16_f32 v77, v90, v91
    v_cvt_pk_bf16_f32 v78, v92, v93
    v_cvt_pk_bf16_f32 v79, v94, v95
    v_lshlrev_b32 v80, 16, v72
    v_and_b32 v81, 0xffff0000, v72
    v_lshlrev_b32 v82, 16, v73
    v_and_b32 v83, 0xffff0000, v73
    v_lshlrev_b32 v84, 16, v74
    v_and_b32 v85, 0xffff0000, v74
    v_lshlrev_b32 v86, 16, v75
    v_and_b32 v87, 0xffff0000, v75
    v_lshlrev_b32 v88, 16, v76
    v_and_b32 v89, 0xffff0000, v76
    v_lshlrev_b32 v90, 16, v77
    v_and_b32 v91, 0xffff0000, v77
    v_lshlrev_b32 v92, 16, v78
    v_and_b32 v93, 0xffff0000, v78
    v_lshlrev_b32 v94, 16, v79
    v_and_b32 v95, 0xffff0000, v79
    v_pk_mul_f32 v[80:81], v[80:81], v[128:129]
    v_pk_mul_f32 v[82:83], v[82:83], v[130:131]
    v_pk_mul_f32 v[84:85], v[84:85], v[132:133]
    v_pk_mul_f32 v[86:87], v[86:87], v[134:135]
    v_pk_mul_f32 v[88:89], v[88:89], v[136:137]
    v_pk_mul_f32 v[90:91], v[90:91], v[138:139]
    v_pk_mul_f32 v[92:93], v[92:93], v[140:141]
    v_pk_mul_f32 v[94:95], v[94:95], v[142:143]
    v_cvt_pk_bf16_f32 v72, v80, v81
    v_cvt_pk_bf16_f32 v73, v82, v83
    v_cvt_pk_bf16_f32 v74, v84, v85
    v_cvt_pk_bf16_f32 v75, v86, v87
    v_cvt_pk_bf16_f32 v76, v88, v89
    v_cvt_pk_bf16_f32 v77, v90, v91
    v_cvt_pk_bf16_f32 v78, v92, v93
    v_cvt_pk_bf16_f32 v79, v94, v95
    v_lshlrev_b32 v80, 16, v72
    v_and_b32 v81, 0xffff0000, v72
    v_lshlrev_b32 v82, 16, v73
    v_and_b32 v83, 0xffff0000, v73
    v_lshlrev_b32 v84, 16, v74
    v_and_b32 v85, 0xffff0000, v74
    v_lshlrev_b32 v86, 16, v75
    v_and_b32 v87, 0xffff0000, v75
    v_lshlrev_b32 v88, 16, v76
    v_and_b32 v89, 0xffff0000, v76
    v_lshlrev_b32 v90, 16, v77
    v_and_b32 v91, 0xffff0000, v77
    v_lshlrev_b32 v92, 16, v78
    v_and_b32 v93, 0xffff0000, v78
    v_lshlrev_b32 v94, 16, v79
    v_and_b32 v95, 0xffff0000, v79
    v_pk_add_f32 v[80:81], v[80:81], v[16:17]
    v_pk_add_f32 v[82:83], v[82:83], v[18:19]
    v_pk_add_f32 v[84:85], v[84:85], v[20:21]
    v_pk_add_f32 v[86:87], v[86:87], v[22:23]
    v_pk_add_f32 v[88:89], v[88:89], v[24:25]
    v_pk_add_f32 v[90:91], v[90:91], v[26:27]
    v_pk_add_f32 v[92:93], v[92:93], v[28:29]
    v_pk_add_f32 v[94:95], v[94:95], v[30:31]
    v_cvt_pk_bf16_f32 v48, v80, v81
    v_cvt_pk_bf16_f32 v49, v82, v83
    v_cvt_pk_bf16_f32 v50, v84, v85
    v_cvt_pk_bf16_f32 v51, v86, v87
    v_cvt_pk_bf16_f32 v52, v88, v89
    v_cvt_pk_bf16_f32 v53, v90, v91
    v_cvt_pk_bf16_f32 v54, v92, v93
    v_cvt_pk_bf16_f32 v55, v94, v95
    v_cmp_ne_u32 vcc, s30, v3
    v_permlane32_swap_b32 v48, v50
    v_permlane32_swap_b32 v49, v51
    v_permlane32_swap_b32 v52, v54
    v_permlane32_swap_b32 v53, v55
    s_mov_b64 exec, vcc
    buffer_store_dwordx4 v[48:51], v5, s[48:51], s26 offen offset:0
    buffer_store_dwordx4 v[52:55], v5, s[48:51], s26 offen offset:32
    s_mov_b64 exec, -1
    v_pk_add_f32 v[80:81], v[32:33], v[66:67] op_sel_hi:[1,0] neg_lo:[0,1] neg_hi:[0,1]
    v_pk_add_f32 v[82:83], v[34:35], v[66:67] op_sel_hi:[1,0] neg_lo:[0,1] neg_hi:[0,1]
    v_pk_add_f32 v[84:85], v[36:37], v[66:67] op_sel_hi:[1,0] neg_lo:[0,1] neg_hi:[0,1]
    v_pk_add_f32 v[86:87], v[38:39], v[66:67] op_sel_hi:[1,0] neg_lo:[0,1] neg_hi:[0,1]
    v_pk_add_f32 v[88:89], v[40:41], v[66:67] op_sel_hi:[1,0] neg_lo:[0,1] neg_hi:[0,1]
    v_pk_add_f32 v[90:91], v[42:43], v[66:67] op_sel_hi:[1,0] neg_lo:[0,1] neg_hi:[0,1]
    v_pk_add_f32 v[92:93], v[44:45], v[66:67] op_sel_hi:[1,0] neg_lo:[0,1] neg_hi:[0,1]
    v_pk_add_f32 v[94:95], v[46:47], v[66:67] op_sel_hi:[1,0] neg_lo:[0,1] neg_hi:[0,1]
    v_cvt_pk_bf16_f32 v72, v80, v81
    v_cvt_pk_bf16_f32 v73, v82, v83
    v_cvt_pk_bf16_f32 v74, v84, v85
    v_cvt_pk_bf16_f32 v75, v86, v87
    v_cvt_pk_bf16_f32 v76, v88, v89
    v_cvt_pk_bf16_f32 v77, v90, v91
    v_cvt_pk_bf16_f32 v78, v92, v93
    v_cvt_pk_bf16_f32 v79, v94, v95
    v_lshlrev_b32 v80, 16, v72
    v_and_b32 v81, 0xffff0000, v72
    v_lshlrev_b32 v82, 16, v73
    v_and_b32 v83, 0xffff0000, v73
    v_lshlrev_b32 v84, 16, v74
    v_and_b32 v85, 0xffff0000, v74
    v_lshlrev_b32 v86, 16, v75
    v_and_b32 v87, 0xffff0000, v75
    v_lshlrev_b32 v88, 16, v76
    v_and_b32 v89, 0xffff0000, v76
    v_lshlrev_b32 v90, 16, v77
    v_and_b32 v91, 0xffff0000, v77
    v_lshlrev_b32 v92, 16, v78
    v_and_b32 v93, 0xffff0000, v78
    v_lshlrev_b32 v94, 16, v79
    v_and_b32 v95, 0xffff0000, v79
    v_pk_mul_f32 v[80:81], v[80:81], v[66:67] op_sel:[0,1] op_sel_hi:[1,1]
    v_pk_mul_f32 v[82:83], v[82:83], v[66:67] op_sel:[0,1] op_sel_hi:[1,1]
    v_pk_mul_f32 v[84:85], v[84:85], v[66:67] op_sel:[0,1] op_sel_hi:[1,1]
    v_pk_mul_f32 v[86:87], v[86:87], v[66:67] op_sel:[0,1] op_sel_hi:[1,1]
    v_pk_mul_f32 v[88:89], v[88:89], v[66:67] op_sel:[0,1] op_sel_hi:[1,1]
    v_pk_mul_f32 v[90:91], v[90:91], v[66:67] op_sel:[0,1] op_sel_hi:[1,1]
    v_pk_mul_f32 v[92:93], v[92:93], v[66:67] op_sel:[0,1] op_sel_hi:[1,1]
    v_pk_mul_f32 v[94:95], v[94:95], v[66:67] op_sel:[0,1] op_sel_hi:[1,1]
    v_cvt_pk_bf16_f32 v72, v80, v81
    v_cvt_pk_bf16_f32 v73, v82, v83
    v_cvt_pk_bf16_f32 v74, v84, v85
    v_cvt_pk_bf16_f32 v75, v86, v87
    v_cvt_pk_bf16_f32 v76, v88, v89
    v_cvt_pk_bf16_f32 v77, v90, v91
    v_cvt_pk_bf16_f32 v78, v92, v93
    v_cvt_pk_bf16_f32 v79, v94, v95
    v_lshlrev_b32 v80, 16, v72
    v_and_b32 v81, 0xffff0000, v72
    v_lshlrev_b32 v82, 16, v73
    v_and_b32 v83, 0xffff0000, v73
    v_lshlrev_b32 v84, 16, v74
    v_and_b32 v85, 0xffff0000, v74
    v_lshlrev_b32 v86, 16, v75
    v_and_b32 v87, 0xffff0000, v75
    v_lshlrev_b32 v88, 16, v76
    v_and_b32 v89, 0xffff0000, v76
    v_lshlrev_b32 v90, 16, v77
    v_and_b32 v91, 0xffff0000, v77
    v_lshlrev_b32 v92, 16, v78
    v_and_b32 v93, 0xffff0000, v78
    v_lshlrev_b32 v94, 16, v79
    v_and_b32 v95, 0xffff0000, v79
    v_pk_mul_f32 v[80:81], v[80:81], v[96:97]
    v_pk_mul_f32 v[82:83], v[82:83], v[98:99]
    v_pk_mul_f32 v[84:85], v[84:85], v[100:101]
    v_pk_mul_f32 v[86:87], v[86:87], v[102:103]
    v_pk_mul_f32 v[88:89], v[88:89], v[104:105]
    v_pk_mul_f32 v[90:91], v[90:91], v[106:107]
    v_pk_mul_f32 v[92:93], v[92:93], v[108:109]
    v_pk_mul_f32 v[94:95], v[94:95], v[110:111]
    v_cvt_pk_bf16_f32 v72, v80, v81
    v_cvt_pk_bf16_f32 v73, v82, v83
    v_cvt_pk_bf16_f32 v74, v84, v85
    v_cvt_pk_bf16_f32 v75, v86, v87
    v_cvt_pk_bf16_f32 v76, v88, v89
    v_cvt_pk_bf16_f32 v77, v90, v91
    v_cvt_pk_bf16_f32 v78, v92, v93
    v_cvt_pk_bf16_f32 v79, v94, v95
    v_lshlrev_b32 v80, 16, v72
    v_and_b32 v81, 0xffff0000, v72
    v_lshlrev_b32 v82, 16, v73
    v_and_b32 v83, 0xffff0000, v73
    v_lshlrev_b32 v84, 16, v74
    v_and_b32 v85, 0xffff0000, v74
    v_lshlrev_b32 v86, 16, v75
    v_and_b32 v87, 0xffff0000, v75
    v_lshlrev_b32 v88, 16, v76
    v_and_b32 v89, 0xffff0000, v76
    v_lshlrev_b32 v90, 16, v77
    v_and_b32 v91, 0xffff0000, v77
    v_lshlrev_b32 v92, 16, v78
    v_and_b32 v93, 0xffff0000, v78
    v_lshlrev_b32 v94, 16, v79
    v_and_b32 v95, 0xffff0000, v79
    v_pk_add_f32 v[80:81], v[80:81], v[112:113]
    v_pk_add_f32 v[82:83], v[82:83], v[114:115]
    v_pk_add_f32 v[84:85], v[84:85], v[116:117]
    v_pk_add_f32 v[86:87], v[86:87], v[118:119]
    v_pk_add_f32 v[88:89], v[88:89], v[120:121]
    v_pk_add_f32 v[90:91], v[90:91], v[122:123]
    v_pk_add_f32 v[92:93], v[92:93], v[124:125]
    v_pk_add_f32 v[94:95], v[94:95], v[126:127]
    v_cvt_pk_bf16_f32 v72, v80, v81
    v_cvt_pk_bf16_f32 v73, v82, v83
    v_cvt_pk_bf16_f32 v74, v84, v85
    v_cvt_pk_bf16_f32 v75, v86, v87
    v_cvt_pk_bf16_f32 v76, v88, v89
    v_cvt_pk_bf16_f32 v77, v90, v91
    v_cvt_pk_bf16_f32 v78, v92, v93
    v_cvt_pk_bf16_f32 v79, v94, v95
    v_lshlrev_b32 v80, 16, v72
    v_and_b32 v81, 0xffff0000, v72
    v_lshlrev_b32 v82, 16, v73
    v_and_b32 v83, 0xffff0000, v73
    v_lshlrev_b32 v84, 16, v74
    v_and_b32 v85, 0xffff0000, v74
    v_lshlrev_b32 v86, 16, v75
    v_and_b32 v87, 0xffff0000, v75
    v_lshlrev_b32 v88, 16, v76
    v_and_b32 v89, 0xffff0000, v76
    v_lshlrev_b32 v90, 16, v77
    v_and_b32 v91, 0xffff0000, v77
    v_lshlrev_b32 v92, 16, v78
    v_and_b32 v93, 0xffff0000, v78
    v_lshlrev_b32 v94, 16, v79
    v_and_b32 v95, 0xffff0000, v79
    v_pk_mul_f32 v[80:81], v[80:81], v[128:129]
    v_pk_mul_f32 v[82:83], v[82:83], v[130:131]
    v_pk_mul_f32 v[84:85], v[84:85], v[132:133]
    v_pk_mul_f32 v[86:87], v[86:87], v[134:135]
    v_pk_mul_f32 v[88:89], v[88:89], v[136:137]
    v_pk_mul_f32 v[90:91], v[90:91], v[138:139]
    v_pk_mul_f32 v[92:93], v[92:93], v[140:141]
    v_pk_mul_f32 v[94:95], v[94:95], v[142:143]
    v_cvt_pk_bf16_f32 v72, v80, v81
    v_cvt_pk_bf16_f32 v73, v82, v83
    v_cvt_pk_bf16_f32 v74, v84, v85
    v_cvt_pk_bf16_f32 v75, v86, v87
    v_cvt_pk_bf16_f32 v76, v88, v89
    v_cvt_pk_bf16_f32 v77, v90, v91
    v_cvt_pk_bf16_f32 v78, v92, v93
    v_cvt_pk_bf16_f32 v79, v94, v95
    v_lshlrev_b32 v80, 16, v72
    v_and_b32 v81, 0xffff0000, v72
    v_lshlrev_b32 v82, 16, v73
    v_and_b32 v83, 0xffff0000, v73
    v_lshlrev_b32 v84, 16, v74
    v_and_b32 v85, 0xffff0000, v74
    v_lshlrev_b32 v86, 16, v75
    v_and_b32 v87, 0xffff0000, v75
    v_lshlrev_b32 v88, 16, v76
    v_and_b32 v89, 0xffff0000, v76
    v_lshlrev_b32 v90, 16, v77
    v_and_b32 v91, 0xffff0000, v77
    v_lshlrev_b32 v92, 16, v78
    v_and_b32 v93, 0xffff0000, v78
    v_lshlrev_b32 v94, 16, v79
    v_and_b32 v95, 0xffff0000, v79
    v_pk_add_f32 v[80:81], v[80:81], v[32:33]
    v_pk_add_f32 v[82:83], v[82:83], v[34:35]
    v_pk_add_f32 v[84:85], v[84:85], v[36:37]
    v_pk_add_f32 v[86:87], v[86:87], v[38:39]
    v_pk_add_f32 v[88:89], v[88:89], v[40:41]
    v_pk_add_f32 v[90:91], v[90:91], v[42:43]
    v_pk_add_f32 v[92:93], v[92:93], v[44:45]
    v_pk_add_f32 v[94:95], v[94:95], v[46:47]
    v_cvt_pk_bf16_f32 v56, v80, v81
    v_cvt_pk_bf16_f32 v57, v82, v83
    v_cvt_pk_bf16_f32 v58, v84, v85
    v_cvt_pk_bf16_f32 v59, v86, v87
    v_cvt_pk_bf16_f32 v60, v88, v89
    v_cvt_pk_bf16_f32 v61, v90, v91
    v_cvt_pk_bf16_f32 v62, v92, v93
    v_cvt_pk_bf16_f32 v63, v94, v95
    v_cmp_ne_u32 vcc, s30, v6
    v_permlane32_swap_b32 v56, v58
    v_permlane32_swap_b32 v57, v59
    v_permlane32_swap_b32 v60, v62
    v_permlane32_swap_b32 v61, v63
    s_mov_b64 exec, vcc
    buffer_store_dwordx4 v[56:59], v5, s[48:51], s27 offen offset:0
    buffer_store_dwordx4 v[60:63], v5, s[48:51], s27 offen offset:32
    s_mov_b64 exec, -1
    s_mov_b32 s19, s18
    s_cmp_lg_u32 s65, 0
    s_cbranch_scc1 tail_red
    s_barrier
    s_branch tail_down

tail_producer:
    s_sub_u32 s19, s18, 4
    v_lshlrev_b32 v8, 4, v2
    v_lshrrev_b32 v3, 4, v2
    s_lshl_b32 s23, s19, 2
    v_add_u32 v4, s23, v3
    v_lshlrev_b32 v9, 11, v4
    v_lshrrev_b32 v5, 2, v2
    v_xor_b32 v5, v5, v3
    v_and_b32 v5, 3, v5
    v_lshl_add_u32 v9, v5, 6, v9
    v_and_b32 v5, 3, v2
    v_lshl_add_u32 v9, v5, 4, v9
    s_lshl_b32 s25, s16, 1
    s_lshr_b32 s24, s19, 1
    s_add_u32 s25, s25, s24
    s_lshl_b32 s25, s25, 16
    s_and_b32 s24, s19, 1
    s_lshl_b32 s24, s24, 11
    s_add_u32 s25, s25, s24
    s_add_u32 s25, s25, 17825792
    s_lshl_b32 s26, s17, 8
    s_lshl_b32 s27, s19, 11
    s_lshl_b32 s29, s19, 10

    s_mov_b32 s40, s36
    s_and_b32 s41, s37, 0xffff
    s_mov_b32 s42, 4194304
    s_mov_b32 s43, 0x00020000
    v_and_b32 v29, 15, v2
    v_xor_b32 v12, v29, v3
    v_lshlrev_b32 v12, 4, v12
    v_lshl_add_u32 v12, v3, 11, v12
    v_xor_b32 v13, 64, v12
    v_xor_b32 v14, 0x80, v12
    v_xor_b32 v28, 0xc0, v12
    s_lshl_b32 s60, s16, 17
    s_add_u32 s60, s60, s26
    s_lshl_b32 s61, s19, 15
    s_add_u32 s60, s60, s61
    s_lshl_b32 s61, s19, 12
    v_lshlrev_b32 v29, 4, v29
    v_lshl_add_u32 v30, v3, 11, v29

    s_lshl_b32 s74, s19, 13
    v_subrev_u32 v31, s74, v9
    v_lshrrev_b32 v34, 1, v2
    v_and_b32 v35, 1, v2
    v_lshlrev_b32 v35, 3, v35
    v_lshl_add_u32 v34, v34, 6, v35
    v_lshlrev_b32 v35, 3, v2
    s_lshl_b32 s78, s19, 9
    s_add_u32 s78, s78, 3440640
    s_lshl_b32 s79, s16, 8
    s_lshl_b32 s74, s19, 4
    s_add_u32 s79, s79, s74
    s_add_u32 s79, s79, 3407872
    s_lshl_b32 s77, s16, 17
    s_add_u32 s77, s77, 17825792
    s_mov_b32 s62, 0x55
    s_mov_b32 s63, 0
    s_barrier

    s_add_u32 m0, s61, 147456
    s_add_u32 s28, s60, 0
    buffer_load_dwordx4 v12, s[40:43], s28 offen lds
    s_add_u32 m0, s61, 148480
    s_add_u32 s28, s60, 8192
    buffer_load_dwordx4 v13, s[40:43], s28 offen lds
    s_add_u32 m0, s61, 149504
    s_add_u32 s28, s60, 16384
    buffer_load_dwordx4 v14, s[40:43], s28 offen lds
    s_add_u32 m0, s61, 150528
    s_add_u32 s28, s60, 24576
    buffer_load_dwordx4 v28, s[40:43], s28 offen lds
    s_cmp_lg_u32 s19, 0
    s_cbranch_scc1 qkv_kernel_own1
    tail_pk0:
    s_and_b32 s74, s62, s63
    s_cbranch_scc1 tail_go0
    s_mov_b64 exec, 0xff
    buffer_load_dwordx2 v[32:33], v34, s[12:15], s79 offen sc1
    s_waitcnt vmcnt(0)
    v_xor_b32 v32, s100, v32
    v_xor_b32 v33, s101, v33
    v_or_b32 v32, v32, v33
    v_cmp_eq_u32 vcc, 0, v32
    s_mov_b64 exec, -1
    s_nop 1
    s_lshr_b32 s63, vcc_lo, 1
    s_and_b32 s63, s63, vcc_lo
    s_sub_u32 s70, s70, 1
    s_cselect_b32 s63, -1, s63
    s_branch tail_pk0
    tail_go0:
    s_ff1_i32_b32 s74, s74
    s_bitset0_b32 s62, s74
    s_lshl_b32 s74, s74, 1
    s_add_u32 s74, s74, s19
    s_lshl_b32 s75, s74, 12
    s_add_u32 s75, s75, s77
    s_lshl_b32 s74, s74, 17
    s_add_u32 s74, s74, s26

    s_mov_b32 m0, 0
    s_add_u32 s28, s75, 0
    buffer_load_dwordx4 v8, s[12:15], s28 offen lds
    buffer_load_dwordx4 v8, s[12:15], s28 offen offset:1024 lds
    s_mov_b32 m0, 2048
    s_add_u32 s28, s75, 2048
    buffer_load_dwordx4 v8, s[12:15], s28 offen lds
    buffer_load_dwordx4 v8, s[12:15], s28 offen offset:1024 lds
    s_mov_b32 m0, 4096
    s_add_u32 s28, s75, 65536
    buffer_load_dwordx4 v8, s[12:15], s28 offen lds
    buffer_load_dwordx4 v8, s[12:15], s28 offen offset:1024 lds
    s_mov_b32 m0, 6144
    s_add_u32 s28, s75, 67584
    buffer_load_dwordx4 v8, s[12:15], s28 offen lds
    buffer_load_dwordx4 v8, s[12:15], s28 offen offset:1024 lds
    s_mov_b32 m0, 8192
    s_add_u32 s28, s74, 0
    buffer_load_dwordx4 v31, s[8:11], s28 offen lds
    s_mov_b32 m0, 9216
    s_add_u32 s28, s74, 8192
    buffer_load_dwordx4 v31, s[8:11], s28 offen lds
    s_mov_b32 m0, 10240
    s_add_u32 s28, s74, 16384
    buffer_load_dwordx4 v31, s[8:11], s28 offen lds
    s_mov_b32 m0, 11264
    s_add_u32 s28, s74, 24576
    buffer_load_dwordx4 v31, s[8:11], s28 offen lds
    s_mov_b32 m0, 12288
    s_add_u32 s28, s74, 32768
    buffer_load_dwordx4 v31, s[8:11], s28 offen lds
    s_mov_b32 m0, 13312
    s_add_u32 s28, s74, 40960
    buffer_load_dwordx4 v31, s[8:11], s28 offen lds
    s_mov_b32 m0, 14336
    s_add_u32 s28, s74, 49152
    buffer_load_dwordx4 v31, s[8:11], s28 offen lds
    s_mov_b32 m0, 15360
    s_add_u32 s28, s74, 57344
    buffer_load_dwordx4 v31, s[8:11], s28 offen lds
    s_mov_b32 m0, 16384
    s_add_u32 s28, s74, 65536
    buffer_load_dwordx4 v31, s[8:11], s28 offen lds
    s_mov_b32 m0, 17408
    s_add_u32 s28, s74, 73728
    buffer_load_dwordx4 v31, s[8:11], s28 offen lds
    s_mov_b32 m0, 18432
    s_add_u32 s28, s74, 81920
    buffer_load_dwordx4 v31, s[8:11], s28 offen lds
    s_mov_b32 m0, 19456
    s_add_u32 s28, s74, 90112
    buffer_load_dwordx4 v31, s[8:11], s28 offen lds
    s_mov_b32 m0, 20480
    s_add_u32 s28, s74, 98304
    buffer_load_dwordx4 v31, s[8:11], s28 offen lds
    s_mov_b32 m0, 21504
    s_add_u32 s28, s74, 106496
    buffer_load_dwordx4 v31, s[8:11], s28 offen lds
    s_mov_b32 m0, 22528
    s_add_u32 s28, s74, 114688
    buffer_load_dwordx4 v31, s[8:11], s28 offen lds
    s_mov_b32 m0, 23552
    s_add_u32 s28, s74, 122880
    buffer_load_dwordx4 v31, s[8:11], s28 offen lds
qkv_kernel_own1:
    s_cmp_lg_u32 s19, 1
    s_cbranch_scc1 qkv_kernel_own2
    tail_pk1:
    s_and_b32 s74, s62, s63
    s_cbranch_scc1 tail_go1
    s_mov_b64 exec, 0xff
    buffer_load_dwordx2 v[32:33], v34, s[12:15], s79 offen sc1
    s_waitcnt vmcnt(0)
    v_xor_b32 v32, s100, v32
    v_xor_b32 v33, s101, v33
    v_or_b32 v32, v32, v33
    v_cmp_eq_u32 vcc, 0, v32
    s_mov_b64 exec, -1
    s_nop 1
    s_lshr_b32 s63, vcc_lo, 1
    s_and_b32 s63, s63, vcc_lo
    s_sub_u32 s70, s70, 1
    s_cselect_b32 s63, -1, s63
    s_branch tail_pk1
    tail_go1:
    s_ff1_i32_b32 s74, s74
    s_bitset0_b32 s62, s74
    s_lshl_b32 s74, s74, 1
    s_add_u32 s74, s74, s19
    s_lshl_b32 s75, s74, 12
    s_add_u32 s75, s75, s77
    s_lshl_b32 s74, s74, 17
    s_add_u32 s74, s74, s26

    s_mov_b32 m0, 24576
    s_add_u32 s28, s75, 0
    buffer_load_dwordx4 v8, s[12:15], s28 offen lds
    buffer_load_dwordx4 v8, s[12:15], s28 offen offset:1024 lds
    s_mov_b32 m0, 26624
    s_add_u32 s28, s75, 2048
    buffer_load_dwordx4 v8, s[12:15], s28 offen lds
    buffer_load_dwordx4 v8, s[12:15], s28 offen offset:1024 lds
    s_mov_b32 m0, 28672
    s_add_u32 s28, s75, 65536
    buffer_load_dwordx4 v8, s[12:15], s28 offen lds
    buffer_load_dwordx4 v8, s[12:15], s28 offen offset:1024 lds
    s_mov_b32 m0, 30720
    s_add_u32 s28, s75, 67584
    buffer_load_dwordx4 v8, s[12:15], s28 offen lds
    buffer_load_dwordx4 v8, s[12:15], s28 offen offset:1024 lds
    s_mov_b32 m0, 32768
    s_add_u32 s28, s74, 0
    buffer_load_dwordx4 v31, s[8:11], s28 offen lds
    s_mov_b32 m0, 33792
    s_add_u32 s28, s74, 8192
    buffer_load_dwordx4 v31, s[8:11], s28 offen lds
    s_mov_b32 m0, 34816
    s_add_u32 s28, s74, 16384
    buffer_load_dwordx4 v31, s[8:11], s28 offen lds
    s_mov_b32 m0, 35840
    s_add_u32 s28, s74, 24576
    buffer_load_dwordx4 v31, s[8:11], s28 offen lds
    s_mov_b32 m0, 36864
    s_add_u32 s28, s74, 32768
    buffer_load_dwordx4 v31, s[8:11], s28 offen lds
    s_mov_b32 m0, 37888
    s_add_u32 s28, s74, 40960
    buffer_load_dwordx4 v31, s[8:11], s28 offen lds
    s_mov_b32 m0, 38912
    s_add_u32 s28, s74, 49152
    buffer_load_dwordx4 v31, s[8:11], s28 offen lds
    s_mov_b32 m0, 39936
    s_add_u32 s28, s74, 57344
    buffer_load_dwordx4 v31, s[8:11], s28 offen lds
    s_mov_b32 m0, 40960
    s_add_u32 s28, s74, 65536
    buffer_load_dwordx4 v31, s[8:11], s28 offen lds
    s_mov_b32 m0, 41984
    s_add_u32 s28, s74, 73728
    buffer_load_dwordx4 v31, s[8:11], s28 offen lds
    s_mov_b32 m0, 43008
    s_add_u32 s28, s74, 81920
    buffer_load_dwordx4 v31, s[8:11], s28 offen lds
    s_mov_b32 m0, 44032
    s_add_u32 s28, s74, 90112
    buffer_load_dwordx4 v31, s[8:11], s28 offen lds
    s_mov_b32 m0, 45056
    s_add_u32 s28, s74, 98304
    buffer_load_dwordx4 v31, s[8:11], s28 offen lds
    s_mov_b32 m0, 46080
    s_add_u32 s28, s74, 106496
    buffer_load_dwordx4 v31, s[8:11], s28 offen lds
    s_mov_b32 m0, 47104
    s_add_u32 s28, s74, 114688
    buffer_load_dwordx4 v31, s[8:11], s28 offen lds
    s_mov_b32 m0, 48128
    s_add_u32 s28, s74, 122880
    buffer_load_dwordx4 v31, s[8:11], s28 offen lds
qkv_kernel_own2:
    s_cmp_lg_u32 s19, 2
    s_cbranch_scc1 qkv_kernel_own3
    tail_pk2:
    s_and_b32 s74, s62, s63
    s_cbranch_scc1 tail_go2
    s_mov_b64 exec, 0xff
    buffer_load_dwordx2 v[32:33], v34, s[12:15], s79 offen sc1
    s_waitcnt vmcnt(0)
    v_xor_b32 v32, s100, v32
    v_xor_b32 v33, s101, v33
    v_or_b32 v32, v32, v33
    v_cmp_eq_u32 vcc, 0, v32
    s_mov_b64 exec, -1
    s_nop 1
    s_lshr_b32 s63, vcc_lo, 1
    s_and_b32 s63, s63, vcc_lo
    s_sub_u32 s70, s70, 1
    s_cselect_b32 s63, -1, s63
    s_branch tail_pk2
    tail_go2:
    s_ff1_i32_b32 s74, s74
    s_bitset0_b32 s62, s74
    s_lshl_b32 s74, s74, 1
    s_add_u32 s74, s74, s19
    s_lshl_b32 s75, s74, 12
    s_add_u32 s75, s75, s77
    s_lshl_b32 s74, s74, 17
    s_add_u32 s74, s74, s26

    s_mov_b32 m0, 49152
    s_add_u32 s28, s75, 0
    buffer_load_dwordx4 v8, s[12:15], s28 offen lds
    buffer_load_dwordx4 v8, s[12:15], s28 offen offset:1024 lds
    s_mov_b32 m0, 51200
    s_add_u32 s28, s75, 2048
    buffer_load_dwordx4 v8, s[12:15], s28 offen lds
    buffer_load_dwordx4 v8, s[12:15], s28 offen offset:1024 lds
    s_mov_b32 m0, 53248
    s_add_u32 s28, s75, 65536
    buffer_load_dwordx4 v8, s[12:15], s28 offen lds
    buffer_load_dwordx4 v8, s[12:15], s28 offen offset:1024 lds
    s_mov_b32 m0, 55296
    s_add_u32 s28, s75, 67584
    buffer_load_dwordx4 v8, s[12:15], s28 offen lds
    buffer_load_dwordx4 v8, s[12:15], s28 offen offset:1024 lds
    s_mov_b32 m0, 57344
    s_add_u32 s28, s74, 0
    buffer_load_dwordx4 v31, s[8:11], s28 offen lds
    s_mov_b32 m0, 58368
    s_add_u32 s28, s74, 8192
    buffer_load_dwordx4 v31, s[8:11], s28 offen lds
    s_mov_b32 m0, 59392
    s_add_u32 s28, s74, 16384
    buffer_load_dwordx4 v31, s[8:11], s28 offen lds
    s_mov_b32 m0, 60416
    s_add_u32 s28, s74, 24576
    buffer_load_dwordx4 v31, s[8:11], s28 offen lds
    s_mov_b32 m0, 61440
    s_add_u32 s28, s74, 32768
    buffer_load_dwordx4 v31, s[8:11], s28 offen lds
    s_mov_b32 m0, 62464
    s_add_u32 s28, s74, 40960
    buffer_load_dwordx4 v31, s[8:11], s28 offen lds
    s_mov_b32 m0, 63488
    s_add_u32 s28, s74, 49152
    buffer_load_dwordx4 v31, s[8:11], s28 offen lds
    s_mov_b32 m0, 64512
    s_add_u32 s28, s74, 57344
    buffer_load_dwordx4 v31, s[8:11], s28 offen lds
    s_mov_b32 m0, 65536
    s_add_u32 s28, s74, 65536
    buffer_load_dwordx4 v31, s[8:11], s28 offen lds
    s_mov_b32 m0, 66560
    s_add_u32 s28, s74, 73728
    buffer_load_dwordx4 v31, s[8:11], s28 offen lds
    s_mov_b32 m0, 67584
    s_add_u32 s28, s74, 81920
    buffer_load_dwordx4 v31, s[8:11], s28 offen lds
    s_mov_b32 m0, 68608
    s_add_u32 s28, s74, 90112
    buffer_load_dwordx4 v31, s[8:11], s28 offen lds
    s_mov_b32 m0, 69632
    s_add_u32 s28, s74, 98304
    buffer_load_dwordx4 v31, s[8:11], s28 offen lds
    s_mov_b32 m0, 70656
    s_add_u32 s28, s74, 106496
    buffer_load_dwordx4 v31, s[8:11], s28 offen lds
    s_mov_b32 m0, 71680
    s_add_u32 s28, s74, 114688
    buffer_load_dwordx4 v31, s[8:11], s28 offen lds
    s_mov_b32 m0, 72704
    s_add_u32 s28, s74, 122880
    buffer_load_dwordx4 v31, s[8:11], s28 offen lds
qkv_kernel_own3:
    s_cmp_lg_u32 s19, 3
    s_cbranch_scc1 qkv_kernel_own4
    tail_pk3:
    s_and_b32 s74, s62, s63
    s_cbranch_scc1 tail_go3
    s_mov_b64 exec, 0xff
    buffer_load_dwordx2 v[32:33], v34, s[12:15], s79 offen sc1
    s_waitcnt vmcnt(0)
    v_xor_b32 v32, s100, v32
    v_xor_b32 v33, s101, v33
    v_or_b32 v32, v32, v33
    v_cmp_eq_u32 vcc, 0, v32
    s_mov_b64 exec, -1
    s_nop 1
    s_lshr_b32 s63, vcc_lo, 1
    s_and_b32 s63, s63, vcc_lo
    s_sub_u32 s70, s70, 1
    s_cselect_b32 s63, -1, s63
    s_branch tail_pk3
    tail_go3:
    s_ff1_i32_b32 s74, s74
    s_bitset0_b32 s62, s74
    s_lshl_b32 s74, s74, 1
    s_add_u32 s74, s74, s19
    s_lshl_b32 s75, s74, 12
    s_add_u32 s75, s75, s77
    s_lshl_b32 s74, s74, 17
    s_add_u32 s74, s74, s26

    s_mov_b32 m0, 73728
    s_add_u32 s28, s75, 0
    buffer_load_dwordx4 v8, s[12:15], s28 offen lds
    buffer_load_dwordx4 v8, s[12:15], s28 offen offset:1024 lds
    s_mov_b32 m0, 75776
    s_add_u32 s28, s75, 2048
    buffer_load_dwordx4 v8, s[12:15], s28 offen lds
    buffer_load_dwordx4 v8, s[12:15], s28 offen offset:1024 lds
    s_mov_b32 m0, 77824
    s_add_u32 s28, s75, 65536
    buffer_load_dwordx4 v8, s[12:15], s28 offen lds
    buffer_load_dwordx4 v8, s[12:15], s28 offen offset:1024 lds
    s_mov_b32 m0, 79872
    s_add_u32 s28, s75, 67584
    buffer_load_dwordx4 v8, s[12:15], s28 offen lds
    buffer_load_dwordx4 v8, s[12:15], s28 offen offset:1024 lds
    s_mov_b32 m0, 81920
    s_add_u32 s28, s74, 0
    buffer_load_dwordx4 v31, s[8:11], s28 offen lds
    s_mov_b32 m0, 82944
    s_add_u32 s28, s74, 8192
    buffer_load_dwordx4 v31, s[8:11], s28 offen lds
    s_mov_b32 m0, 83968
    s_add_u32 s28, s74, 16384
    buffer_load_dwordx4 v31, s[8:11], s28 offen lds
    s_mov_b32 m0, 84992
    s_add_u32 s28, s74, 24576
    buffer_load_dwordx4 v31, s[8:11], s28 offen lds
    s_mov_b32 m0, 86016
    s_add_u32 s28, s74, 32768
    buffer_load_dwordx4 v31, s[8:11], s28 offen lds
    s_mov_b32 m0, 87040
    s_add_u32 s28, s74, 40960
    buffer_load_dwordx4 v31, s[8:11], s28 offen lds
    s_mov_b32 m0, 88064
    s_add_u32 s28, s74, 49152
    buffer_load_dwordx4 v31, s[8:11], s28 offen lds
    s_mov_b32 m0, 89088
    s_add_u32 s28, s74, 57344
    buffer_load_dwordx4 v31, s[8:11], s28 offen lds
    s_mov_b32 m0, 90112
    s_add_u32 s28, s74, 65536
    buffer_load_dwordx4 v31, s[8:11], s28 offen lds
    s_mov_b32 m0, 91136
    s_add_u32 s28, s74, 73728
    buffer_load_dwordx4 v31, s[8:11], s28 offen lds
    s_mov_b32 m0, 92160
    s_add_u32 s28, s74, 81920
    buffer_load_dwordx4 v31, s[8:11], s28 offen lds
    s_mov_b32 m0, 93184
    s_add_u32 s28, s74, 90112
    buffer_load_dwordx4 v31, s[8:11], s28 offen lds
    s_mov_b32 m0, 94208
    s_add_u32 s28, s74, 98304
    buffer_load_dwordx4 v31, s[8:11], s28 offen lds
    s_mov_b32 m0, 95232
    s_add_u32 s28, s74, 106496
    buffer_load_dwordx4 v31, s[8:11], s28 offen lds
    s_mov_b32 m0, 96256
    s_add_u32 s28, s74, 114688
    buffer_load_dwordx4 v31, s[8:11], s28 offen lds
    s_mov_b32 m0, 97280
    s_add_u32 s28, s74, 122880
    buffer_load_dwordx4 v31, s[8:11], s28 offen lds
qkv_kernel_own4:
    s_mov_b32 s56, s6
    s_and_b32 s57, s7, 0xffff
    s_mov_b32 s58, 268435456
    s_mov_b32 s59, 0x00020000
    s_cmp_eq_u32 s65, 0
    s_cselect_b32 s58, s58, 0
    s_lshl_b32 s30, s64, 15
    s_lshl_b32 s31, s19, 13
    s_add_u32 s30, s30, s31
    s_add_u32 s30, s30, 50331648
    s_mul_i32 s31, s19, 6144
    v_lshlrev_b32 v10, 2, v2
    s_lshl_b32 s32, s17, 8
    s_add_u32 s33, s32, 6144
    s_add_u32 s34, s32, 10240
    v_lshlrev_b32 v11, 5, v2

    s_cmp_lg_u32 s19, 0
    s_cbranch_scc1 qkv_kernel_own5
    s_waitcnt vmcnt(0)
qkv_kernel_own5:
    s_barrier
    s_cmp_lg_u32 s19, 0
    s_cbranch_scc1 qkv_kernel_own6
    tail_pk4:
    s_and_b32 s74, s62, s63
    s_cbranch_scc1 tail_go4
    s_mov_b64 exec, 0xff
    buffer_load_dwordx2 v[32:33], v34, s[12:15], s79 offen sc1
    s_waitcnt vmcnt(0)
    v_xor_b32 v32, s100, v32
    v_xor_b32 v33, s101, v33
    v_or_b32 v32, v32, v33
    v_cmp_eq_u32 vcc, 0, v32
    s_mov_b64 exec, -1
    s_nop 1
    s_lshr_b32 s63, vcc_lo, 1
    s_and_b32 s63, s63, vcc_lo
    s_sub_u32 s70, s70, 1
    s_cselect_b32 s63, -1, s63
    s_branch tail_pk4
    tail_go4:
    s_ff1_i32_b32 s74, s74
    s_bitset0_b32 s62, s74
    s_lshl_b32 s74, s74, 1
    s_add_u32 s74, s74, s19
    s_lshl_b32 s75, s74, 12
    s_add_u32 s75, s75, s77
    s_lshl_b32 s74, s74, 17
    s_add_u32 s74, s74, s26

    s_mov_b32 m0, 98304
    s_add_u32 s28, s75, 0
    buffer_load_dwordx4 v8, s[12:15], s28 offen lds
    buffer_load_dwordx4 v8, s[12:15], s28 offen offset:1024 lds
    s_mov_b32 m0, 100352
    s_add_u32 s28, s75, 2048
    buffer_load_dwordx4 v8, s[12:15], s28 offen lds
    buffer_load_dwordx4 v8, s[12:15], s28 offen offset:1024 lds
    s_mov_b32 m0, 102400
    s_add_u32 s28, s75, 65536
    buffer_load_dwordx4 v8, s[12:15], s28 offen lds
    buffer_load_dwordx4 v8, s[12:15], s28 offen offset:1024 lds
    s_mov_b32 m0, 104448
    s_add_u32 s28, s75, 67584
    buffer_load_dwordx4 v8, s[12:15], s28 offen lds
    buffer_load_dwordx4 v8, s[12:15], s28 offen offset:1024 lds
    s_mov_b32 m0, 106496
    s_add_u32 s28, s74, 0
    buffer_load_dwordx4 v31, s[8:11], s28 offen lds
    s_mov_b32 m0, 107520
    s_add_u32 s28, s74, 8192
    buffer_load_dwordx4 v31, s[8:11], s28 offen lds
    s_mov_b32 m0, 108544
    s_add_u32 s28, s74, 16384
    buffer_load_dwordx4 v31, s[8:11], s28 offen lds
    s_mov_b32 m0, 109568
    s_add_u32 s28, s74, 24576
    buffer_load_dwordx4 v31, s[8:11], s28 offen lds
    s_mov_b32 m0, 110592
    s_add_u32 s28, s74, 32768
    buffer_load_dwordx4 v31, s[8:11], s28 offen lds
    s_mov_b32 m0, 111616
    s_add_u32 s28, s74, 40960
    buffer_load_dwordx4 v31, s[8:11], s28 offen lds
    s_mov_b32 m0, 112640
    s_add_u32 s28, s74, 49152
    buffer_load_dwordx4 v31, s[8:11], s28 offen lds
    s_mov_b32 m0, 113664
    s_add_u32 s28, s74, 57344
    buffer_load_dwordx4 v31, s[8:11], s28 offen lds
    s_mov_b32 m0, 114688
    s_add_u32 s28, s74, 65536
    buffer_load_dwordx4 v31, s[8:11], s28 offen lds
    s_mov_b32 m0, 115712
    s_add_u32 s28, s74, 73728
    buffer_load_dwordx4 v31, s[8:11], s28 offen lds
    s_mov_b32 m0, 116736
    s_add_u32 s28, s74, 81920
    buffer_load_dwordx4 v31, s[8:11], s28 offen lds
    s_mov_b32 m0, 117760
    s_add_u32 s28, s74, 90112
    buffer_load_dwordx4 v31, s[8:11], s28 offen lds
    s_mov_b32 m0, 118784
    s_add_u32 s28, s74, 98304
    buffer_load_dwordx4 v31, s[8:11], s28 offen lds
    s_mov_b32 m0, 119808
    s_add_u32 s28, s74, 106496
    buffer_load_dwordx4 v31, s[8:11], s28 offen lds
    s_mov_b32 m0, 120832
    s_add_u32 s28, s74, 114688
    buffer_load_dwordx4 v31, s[8:11], s28 offen lds
    s_mov_b32 m0, 121856
    s_add_u32 s28, s74, 122880
    buffer_load_dwordx4 v31, s[8:11], s28 offen lds
qkv_kernel_own6:
    s_cmp_lg_u32 s19, 1
    s_cbranch_scc1 qkv_kernel_own7
    s_waitcnt vmcnt(0)
qkv_kernel_own7:
    s_barrier
    s_cmp_lg_u32 s19, 1
    s_cbranch_scc1 qkv_kernel_own8
    tail_pk5:
    s_and_b32 s74, s62, s63
    s_cbranch_scc1 tail_go5
    s_mov_b64 exec, 0xff
    buffer_load_dwordx2 v[32:33], v34, s[12:15], s79 offen sc1
    s_waitcnt vmcnt(0)
    v_xor_b32 v32, s100, v32
    v_xor_b32 v33, s101, v33
    v_or_b32 v32, v32, v33
    v_cmp_eq_u32 vcc, 0, v32
    s_mov_b64 exec, -1
    s_nop 1
    s_lshr_b32 s63, vcc_lo, 1
    s_and_b32 s63, s63, vcc_lo
    s_sub_u32 s70, s70, 1
    s_cselect_b32 s63, -1, s63
    s_branch tail_pk5
    tail_go5:
    s_ff1_i32_b32 s74, s74
    s_bitset0_b32 s62, s74
    s_lshl_b32 s74, s74, 1
    s_add_u32 s74, s74, s19
    s_lshl_b32 s75, s74, 12
    s_add_u32 s75, s75, s77
    s_lshl_b32 s74, s74, 17
    s_add_u32 s74, s74, s26

    s_mov_b32 m0, 122880
    s_add_u32 s28, s75, 0
    buffer_load_dwordx4 v8, s[12:15], s28 offen lds
    buffer_load_dwordx4 v8, s[12:15], s28 offen offset:1024 lds
    s_mov_b32 m0, 124928
    s_add_u32 s28, s75, 2048
    buffer_load_dwordx4 v8, s[12:15], s28 offen lds
    buffer_load_dwordx4 v8, s[12:15], s28 offen offset:1024 lds
    s_mov_b32 m0, 126976
    s_add_u32 s28, s75, 65536
    buffer_load_dwordx4 v8, s[12:15], s28 offen lds
    buffer_load_dwordx4 v8, s[12:15], s28 offen offset:1024 lds
    s_mov_b32 m0, 129024
    s_add_u32 s28, s75, 67584
    buffer_load_dwordx4 v8, s[12:15], s28 offen lds
    buffer_load_dwordx4 v8, s[12:15], s28 offen offset:1024 lds
    s_mov_b32 m0, 131072
    s_add_u32 s28, s74, 0
    buffer_load_dwordx4 v31, s[8:11], s28 offen lds
    s_mov_b32 m0, 132096
    s_add_u32 s28, s74, 8192
    buffer_load_dwordx4 v31, s[8:11], s28 offen lds
    s_mov_b32 m0, 133120
    s_add_u32 s28, s74, 16384
    buffer_load_dwordx4 v31, s[8:11], s28 offen lds
    s_mov_b32 m0, 134144
    s_add_u32 s28, s74, 24576
    buffer_load_dwordx4 v31, s[8:11], s28 offen lds
    s_mov_b32 m0, 135168
    s_add_u32 s28, s74, 32768
    buffer_load_dwordx4 v31, s[8:11], s28 offen lds
    s_mov_b32 m0, 136192
    s_add_u32 s28, s74, 40960
    buffer_load_dwordx4 v31, s[8:11], s28 offen lds
    s_mov_b32 m0, 137216
    s_add_u32 s28, s74, 49152
    buffer_load_dwordx4 v31, s[8:11], s28 offen lds
    s_mov_b32 m0, 138240
    s_add_u32 s28, s74, 57344
    buffer_load_dwordx4 v31, s[8:11], s28 offen lds
    s_mov_b32 m0, 139264
    s_add_u32 s28, s74, 65536
    buffer_load_dwordx4 v31, s[8:11], s28 offen lds
    s_mov_b32 m0, 140288
    s_add_u32 s28, s74, 73728
    buffer_load_dwordx4 v31, s[8:11], s28 offen lds
    s_mov_b32 m0, 141312
    s_add_u32 s28, s74, 81920
    buffer_load_dwordx4 v31, s[8:11], s28 offen lds
    s_mov_b32 m0, 142336
    s_add_u32 s28, s74, 90112
    buffer_load_dwordx4 v31, s[8:11], s28 offen lds
    s_mov_b32 m0, 143360
    s_add_u32 s28, s74, 98304
    buffer_load_dwordx4 v31, s[8:11], s28 offen lds
    s_mov_b32 m0, 144384
    s_add_u32 s28, s74, 106496
    buffer_load_dwordx4 v31, s[8:11], s28 offen lds
    s_mov_b32 m0, 145408
    s_add_u32 s28, s74, 114688
    buffer_load_dwordx4 v31, s[8:11], s28 offen lds
    s_mov_b32 m0, 146432
    s_add_u32 s28, s74, 122880
    buffer_load_dwordx4 v31, s[8:11], s28 offen lds
qkv_kernel_own8:
    s_cmp_lg_u32 s19, 2
    s_cbranch_scc1 qkv_kernel_own9
    s_waitcnt vmcnt(0)
qkv_kernel_own9:
    s_barrier
    s_cmp_lg_u32 s19, 2
    s_cbranch_scc1 qkv_kernel_own10
    tail_pk6:
    s_and_b32 s74, s62, s63
    s_cbranch_scc1 tail_go6
    s_mov_b64 exec, 0xff
    buffer_load_dwordx2 v[32:33], v34, s[12:15], s79 offen sc1
    s_waitcnt vmcnt(0)
    v_xor_b32 v32, s100, v32
    v_xor_b32 v33, s101, v33
    v_or_b32 v32, v32, v33
    v_cmp_eq_u32 vcc, 0, v32
    s_mov_b64 exec, -1
    s_nop 1
    s_lshr_b32 s63, vcc_lo, 1
    s_and_b32 s63, s63, vcc_lo
    s_sub_u32 s70, s70, 1
    s_cselect_b32 s63, -1, s63
    s_branch tail_pk6
    tail_go6:
    s_ff1_i32_b32 s74, s74
    s_bitset0_b32 s62, s74
    s_lshl_b32 s74, s74, 1
    s_add_u32 s74, s74, s19
    s_lshl_b32 s75, s74, 12
    s_add_u32 s75, s75, s77
    s_lshl_b32 s74, s74, 17
    s_add_u32 s74, s74, s26

    s_mov_b32 m0, 0
    s_add_u32 s28, s75, 0
    buffer_load_dwordx4 v8, s[12:15], s28 offen lds
    buffer_load_dwordx4 v8, s[12:15], s28 offen offset:1024 lds
    s_mov_b32 m0, 2048
    s_add_u32 s28, s75, 2048
    buffer_load_dwordx4 v8, s[12:15], s28 offen lds
    buffer_load_dwordx4 v8, s[12:15], s28 offen offset:1024 lds
    s_mov_b32 m0, 4096
    s_add_u32 s28, s75, 65536
    buffer_load_dwordx4 v8, s[12:15], s28 offen lds
    buffer_load_dwordx4 v8, s[12:15], s28 offen offset:1024 lds
    s_mov_b32 m0, 6144
    s_add_u32 s28, s75, 67584
    buffer_load_dwordx4 v8, s[12:15], s28 offen lds
    buffer_load_dwordx4 v8, s[12:15], s28 offen offset:1024 lds
    s_mov_b32 m0, 8192
    s_add_u32 s28, s74, 0
    buffer_load_dwordx4 v31, s[8:11], s28 offen lds
    s_mov_b32 m0, 9216
    s_add_u32 s28, s74, 8192
    buffer_load_dwordx4 v31, s[8:11], s28 offen lds
    s_mov_b32 m0, 10240
    s_add_u32 s28, s74, 16384
    buffer_load_dwordx4 v31, s[8:11], s28 offen lds
    s_mov_b32 m0, 11264
    s_add_u32 s28, s74, 24576
    buffer_load_dwordx4 v31, s[8:11], s28 offen lds
    s_mov_b32 m0, 12288
    s_add_u32 s28, s74, 32768
    buffer_load_dwordx4 v31, s[8:11], s28 offen lds
    s_mov_b32 m0, 13312
    s_add_u32 s28, s74, 40960
    buffer_load_dwordx4 v31, s[8:11], s28 offen lds
    s_mov_b32 m0, 14336
    s_add_u32 s28, s74, 49152
    buffer_load_dwordx4 v31, s[8:11], s28 offen lds
    s_mov_b32 m0, 15360
    s_add_u32 s28, s74, 57344
    buffer_load_dwordx4 v31, s[8:11], s28 offen lds
    s_mov_b32 m0, 16384
    s_add_u32 s28, s74, 65536
    buffer_load_dwordx4 v31, s[8:11], s28 offen lds
    s_mov_b32 m0, 17408
    s_add_u32 s28, s74, 73728
    buffer_load_dwordx4 v31, s[8:11], s28 offen lds
    s_mov_b32 m0, 18432
    s_add_u32 s28, s74, 81920
    buffer_load_dwordx4 v31, s[8:11], s28 offen lds
    s_mov_b32 m0, 19456
    s_add_u32 s28, s74, 90112
    buffer_load_dwordx4 v31, s[8:11], s28 offen lds
    s_mov_b32 m0, 20480
    s_add_u32 s28, s74, 98304
    buffer_load_dwordx4 v31, s[8:11], s28 offen lds
    s_mov_b32 m0, 21504
    s_add_u32 s28, s74, 106496
    buffer_load_dwordx4 v31, s[8:11], s28 offen lds
    s_mov_b32 m0, 22528
    s_add_u32 s28, s74, 114688
    buffer_load_dwordx4 v31, s[8:11], s28 offen lds
    s_mov_b32 m0, 23552
    s_add_u32 s28, s74, 122880
    buffer_load_dwordx4 v31, s[8:11], s28 offen lds
qkv_kernel_own10:
    s_cmp_lg_u32 s19, 3
    s_cbranch_scc1 qkv_kernel_own11
    s_waitcnt vmcnt(0)
qkv_kernel_own11:
    s_barrier
    s_cmp_lg_u32 s19, 3
    s_cbranch_scc1 qkv_kernel_own12
    tail_pk7:
    s_and_b32 s74, s62, s63
    s_cbranch_scc1 tail_go7
    s_mov_b64 exec, 0xff
    buffer_load_dwordx2 v[32:33], v34, s[12:15], s79 offen sc1
    s_waitcnt vmcnt(0)
    v_xor_b32 v32, s100, v32
    v_xor_b32 v33, s101, v33
    v_or_b32 v32, v32, v33
    v_cmp_eq_u32 vcc, 0, v32
    s_mov_b64 exec, -1
    s_nop 1
    s_lshr_b32 s63, vcc_lo, 1
    s_and_b32 s63, s63, vcc_lo
    s_sub_u32 s70, s70, 1
    s_cselect_b32 s63, -1, s63
    s_branch tail_pk7
    tail_go7:
    s_ff1_i32_b32 s74, s74
    s_bitset0_b32 s62, s74
    s_lshl_b32 s74, s74, 1
    s_add_u32 s74, s74, s19
    s_lshl_b32 s75, s74, 12
    s_add_u32 s75, s75, s77
    s_lshl_b32 s74, s74, 17
    s_add_u32 s74, s74, s26

    s_mov_b32 m0, 24576
    s_add_u32 s28, s75, 0
    buffer_load_dwordx4 v8, s[12:15], s28 offen lds
    buffer_load_dwordx4 v8, s[12:15], s28 offen offset:1024 lds
    s_mov_b32 m0, 26624
    s_add_u32 s28, s75, 2048
    buffer_load_dwordx4 v8, s[12:15], s28 offen lds
    buffer_load_dwordx4 v8, s[12:15], s28 offen offset:1024 lds
    s_mov_b32 m0, 28672
    s_add_u32 s28, s75, 65536
    buffer_load_dwordx4 v8, s[12:15], s28 offen lds
    buffer_load_dwordx4 v8, s[12:15], s28 offen offset:1024 lds
    s_mov_b32 m0, 30720
    s_add_u32 s28, s75, 67584
    buffer_load_dwordx4 v8, s[12:15], s28 offen lds
    buffer_load_dwordx4 v8, s[12:15], s28 offen offset:1024 lds
    s_mov_b32 m0, 32768
    s_add_u32 s28, s74, 0
    buffer_load_dwordx4 v31, s[8:11], s28 offen lds
    s_mov_b32 m0, 33792
    s_add_u32 s28, s74, 8192
    buffer_load_dwordx4 v31, s[8:11], s28 offen lds
    s_mov_b32 m0, 34816
    s_add_u32 s28, s74, 16384
    buffer_load_dwordx4 v31, s[8:11], s28 offen lds
    s_mov_b32 m0, 35840
    s_add_u32 s28, s74, 24576
    buffer_load_dwordx4 v31, s[8:11], s28 offen lds
    s_mov_b32 m0, 36864
    s_add_u32 s28, s74, 32768
    buffer_load_dwordx4 v31, s[8:11], s28 offen lds
    s_mov_b32 m0, 37888
    s_add_u32 s28, s74, 40960
    buffer_load_dwordx4 v31, s[8:11], s28 offen lds
    s_mov_b32 m0, 38912
    s_add_u32 s28, s74, 49152
    buffer_load_dwordx4 v31, s[8:11], s28 offen lds
    s_mov_b32 m0, 39936
    s_add_u32 s28, s74, 57344
    buffer_load_dwordx4 v31, s[8:11], s28 offen lds
    s_mov_b32 m0, 40960
    s_add_u32 s28, s74, 65536
    buffer_load_dwordx4 v31, s[8:11], s28 offen lds
    s_mov_b32 m0, 41984
    s_add_u32 s28, s74, 73728
    buffer_load_dwordx4 v31, s[8:11], s28 offen lds
    s_mov_b32 m0, 43008
    s_add_u32 s28, s74, 81920
    buffer_load_dwordx4 v31, s[8:11], s28 offen lds
    s_mov_b32 m0, 44032
    s_add_u32 s28, s74, 90112
    buffer_load_dwordx4 v31, s[8:11], s28 offen lds
    s_mov_b32 m0, 45056
    s_add_u32 s28, s74, 98304
    buffer_load_dwordx4 v31, s[8:11], s28 offen lds
    s_mov_b32 m0, 46080
    s_add_u32 s28, s74, 106496
    buffer_load_dwordx4 v31, s[8:11], s28 offen lds
    s_mov_b32 m0, 47104
    s_add_u32 s28, s74, 114688
    buffer_load_dwordx4 v31, s[8:11], s28 offen lds
    s_mov_b32 m0, 48128
    s_add_u32 s28, s74, 122880
    buffer_load_dwordx4 v31, s[8:11], s28 offen lds
qkv_kernel_own12:
    s_cmp_lg_u32 s19, 0
    s_cbranch_scc1 qkv_kernel_own13
    s_waitcnt vmcnt(0)
qkv_kernel_own13:
    s_barrier
    s_cmp_lg_u32 s19, 0
    s_cbranch_scc1 qkv_kernel_own14
    tail_pk8:
    s_and_b32 s74, s62, s63
    s_cbranch_scc1 tail_go8
    s_mov_b64 exec, 0xff
    buffer_load_dwordx2 v[32:33], v34, s[12:15], s79 offen sc1
    s_waitcnt vmcnt(0)
    v_xor_b32 v32, s100, v32
    v_xor_b32 v33, s101, v33
    v_or_b32 v32, v32, v33
    v_cmp_eq_u32 vcc, 0, v32
    s_mov_b64 exec, -1
    s_nop 1
    s_lshr_b32 s63, vcc_lo, 1
    s_and_b32 s63, s63, vcc_lo
    s_sub_u32 s70, s70, 1
    s_cselect_b32 s63, -1, s63
    s_branch tail_pk8
    tail_go8:
    s_ff1_i32_b32 s74, s74
    s_bitset0_b32 s62, s74
    s_lshl_b32 s74, s74, 1
    s_add_u32 s74, s74, s19
    s_lshl_b32 s75, s74, 12
    s_add_u32 s75, s75, s77
    s_lshl_b32 s74, s74, 17
    s_add_u32 s74, s74, s26

    s_mov_b32 m0, 49152
    s_add_u32 s28, s75, 0
    buffer_load_dwordx4 v8, s[12:15], s28 offen lds
    buffer_load_dwordx4 v8, s[12:15], s28 offen offset:1024 lds
    s_mov_b32 m0, 51200
    s_add_u32 s28, s75, 2048
    buffer_load_dwordx4 v8, s[12:15], s28 offen lds
    buffer_load_dwordx4 v8, s[12:15], s28 offen offset:1024 lds
    s_mov_b32 m0, 53248
    s_add_u32 s28, s75, 65536
    buffer_load_dwordx4 v8, s[12:15], s28 offen lds
    buffer_load_dwordx4 v8, s[12:15], s28 offen offset:1024 lds
    s_mov_b32 m0, 55296
    s_add_u32 s28, s75, 67584
    buffer_load_dwordx4 v8, s[12:15], s28 offen lds
    buffer_load_dwordx4 v8, s[12:15], s28 offen offset:1024 lds
    s_mov_b32 m0, 57344
    s_add_u32 s28, s74, 0
    buffer_load_dwordx4 v31, s[8:11], s28 offen lds
    s_mov_b32 m0, 58368
    s_add_u32 s28, s74, 8192
    buffer_load_dwordx4 v31, s[8:11], s28 offen lds
    s_mov_b32 m0, 59392
    s_add_u32 s28, s74, 16384
    buffer_load_dwordx4 v31, s[8:11], s28 offen lds
    s_mov_b32 m0, 60416
    s_add_u32 s28, s74, 24576
    buffer_load_dwordx4 v31, s[8:11], s28 offen lds
    s_mov_b32 m0, 61440
    s_add_u32 s28, s74, 32768
    buffer_load_dwordx4 v31, s[8:11], s28 offen lds
    s_mov_b32 m0, 62464
    s_add_u32 s28, s74, 40960
    buffer_load_dwordx4 v31, s[8:11], s28 offen lds
    s_mov_b32 m0, 63488
    s_add_u32 s28, s74, 49152
    buffer_load_dwordx4 v31, s[8:11], s28 offen lds
    s_mov_b32 m0, 64512
    s_add_u32 s28, s74, 57344
    buffer_load_dwordx4 v31, s[8:11], s28 offen lds
    s_mov_b32 m0, 65536
    s_add_u32 s28, s74, 65536
    buffer_load_dwordx4 v31, s[8:11], s28 offen lds
    s_mov_b32 m0, 66560
    s_add_u32 s28, s74, 73728
    buffer_load_dwordx4 v31, s[8:11], s28 offen lds
    s_mov_b32 m0, 67584
    s_add_u32 s28, s74, 81920
    buffer_load_dwordx4 v31, s[8:11], s28 offen lds
    s_mov_b32 m0, 68608
    s_add_u32 s28, s74, 90112
    buffer_load_dwordx4 v31, s[8:11], s28 offen lds
    s_mov_b32 m0, 69632
    s_add_u32 s28, s74, 98304
    buffer_load_dwordx4 v31, s[8:11], s28 offen lds
    s_mov_b32 m0, 70656
    s_add_u32 s28, s74, 106496
    buffer_load_dwordx4 v31, s[8:11], s28 offen lds
    s_mov_b32 m0, 71680
    s_add_u32 s28, s74, 114688
    buffer_load_dwordx4 v31, s[8:11], s28 offen lds
    s_mov_b32 m0, 72704
    s_add_u32 s28, s74, 122880
    buffer_load_dwordx4 v31, s[8:11], s28 offen lds
qkv_kernel_own14:
    s_cmp_lg_u32 s19, 1
    s_cbranch_scc1 qkv_kernel_own15
    s_waitcnt vmcnt(0)
qkv_kernel_own15:
    tail_ps:
    buffer_load_dwordx2 v[32:33], v35, s[12:15], s78 offen sc1
    s_waitcnt vmcnt(0)
    v_xor_b32 v32, s100, v32
    v_xor_b32 v33, s101, v33
    v_or_b32 v32, v32, v33
    v_cmp_ne_u32 vcc, 0, v32
    s_sub_u32 s70, s70, 1
    s_cbranch_scc1 tail_ps_ok
    s_cbranch_vccnz tail_ps
    tail_ps_ok:

    s_barrier
    s_mov_b32 m0, 147456
    s_add_u32 s28, s26, 4096
    buffer_load_dwordx4 v30, s[12:15], s28 offen lds
    s_mov_b32 m0, 148480
    s_mov_b64 exec, 0xffff
    buffer_load_dwordx4 v29, s[44:47], s26 offen lds
    s_mov_b64 exec, -1

    s_cmp_lg_u32 s19, 1
    s_cbranch_scc1 qkv_kernel_own16
    tail_pk9:
    s_and_b32 s74, s62, s63
    s_cbranch_scc1 tail_go9
    s_mov_b64 exec, 0xff
    buffer_load_dwordx2 v[32:33], v34, s[12:15], s79 offen sc1
    s_waitcnt vmcnt(0)
    v_xor_b32 v32, s100, v32
    v_xor_b32 v33, s101, v33
    v_or_b32 v32, v32, v33
    v_cmp_eq_u32 vcc, 0, v32
    s_mov_b64 exec, -1
    s_nop 1
    s_lshr_b32 s63, vcc_lo, 1
    s_and_b32 s63, s63, vcc_lo
    s_sub_u32 s70, s70, 1
    s_cselect_b32 s63, -1, s63
    s_branch tail_pk9
    tail_go9:
    s_ff1_i32_b32 s74, s74
    s_bitset0_b32 s62, s74
    s_lshl_b32 s74, s74, 1
    s_add_u32 s74, s74, s19
    s_lshl_b32 s75, s74, 12
    s_add_u32 s75, s75, s77
    s_lshl_b32 s74, s74, 17
    s_add_u32 s74, s74, s26

    s_mov_b32 m0, 73728
    s_add_u32 s28, s75, 0
    buffer_load_dwordx4 v8, s[12:15], s28 offen lds
    buffer_load_dwordx4 v8, s[12:15], s28 offen offset:1024 lds
    s_mov_b32 m0, 75776
    s_add_u32 s28, s75, 2048
    buffer_load_dwordx4 v8, s[12:15], s28 offen lds
    buffer_load_dwordx4 v8, s[12:15], s28 offen offset:1024 lds
    s_mov_b32 m0, 77824
    s_add_u32 s28, s75, 65536
    buffer_load_dwordx4 v8, s[12:15], s28 offen lds
    buffer_load_dwordx4 v8, s[12:15], s28 offen offset:1024 lds
    s_mov_b32 m0, 79872
    s_add_u32 s28, s75, 67584
    buffer_load_dwordx4 v8, s[12:15], s28 offen lds
    buffer_load_dwordx4 v8, s[12:15], s28 offen offset:1024 lds
    s_mov_b32 m0, 81920
    s_add_u32 s28, s74, 0
    buffer_load_dwordx4 v31, s[8:11], s28 offen lds
    s_mov_b32 m0, 82944
    s_add_u32 s28, s74, 8192
    buffer_load_dwordx4 v31, s[8:11], s28 offen lds
    s_mov_b32 m0, 83968
    s_add_u32 s28, s74, 16384
    buffer_load_dwordx4 v31, s[8:11], s28 offen lds
    s_mov_b32 m0, 84992
    s_add_u32 s28, s74, 24576
    buffer_load_dwordx4 v31, s[8:11], s28 offen lds
    s_mov_b32 m0, 86016
    s_add_u32 s28, s74, 32768
    buffer_load_dwordx4 v31, s[8:11], s28 offen lds
    s_mov_b32 m0, 87040
    s_add_u32 s28, s74, 40960
    buffer_load_dwordx4 v31, s[8:11], s28 offen lds
    s_mov_b32 m0, 88064
    s_add_u32 s28, s74, 49152
    buffer_load_dwordx4 v31, s[8:11], s28 offen lds
    s_mov_b32 m0, 89088
    s_add_u32 s28, s74, 57344
    buffer_load_dwordx4 v31, s[8:11], s28 offen lds
    s_mov_b32 m0, 90112
    s_add_u32 s28, s74, 65536
    buffer_load_dwordx4 v31, s[8:11], s28 offen lds
    s_mov_b32 m0, 91136
    s_add_u32 s28, s74, 73728
    buffer_load_dwordx4 v31, s[8:11], s28 offen lds
    s_mov_b32 m0, 92160
    s_add_u32 s28, s74, 81920
    buffer_load_dwordx4 v31, s[8:11], s28 offen lds
    s_mov_b32 m0, 93184
    s_add_u32 s28, s74, 90112
    buffer_load_dwordx4 v31, s[8:11], s28 offen lds
    s_mov_b32 m0, 94208
    s_add_u32 s28, s74, 98304
    buffer_load_dwordx4 v31, s[8:11], s28 offen lds
    s_mov_b32 m0, 95232
    s_add_u32 s28, s74, 106496
    buffer_load_dwordx4 v31, s[8:11], s28 offen lds
    s_mov_b32 m0, 96256
    s_add_u32 s28, s74, 114688
    buffer_load_dwordx4 v31, s[8:11], s28 offen lds
    s_mov_b32 m0, 97280
    s_add_u32 s28, s74, 122880
    buffer_load_dwordx4 v31, s[8:11], s28 offen lds
qkv_kernel_own16:
    s_cmp_lg_u32 s19, 2
    s_cbranch_scc1 qkv_kernel_own17
    s_waitcnt vmcnt(2)
qkv_kernel_own17:
    s_barrier
    s_cmp_lg_u32 s19, 2
    s_cbranch_scc1 qkv_kernel_own18
    tail_pk10:
    s_and_b32 s74, s62, s63
    s_cbranch_scc1 tail_go10
    s_mov_b64 exec, 0xff
    buffer_load_dwordx2 v[32:33], v34, s[12:15], s79 offen sc1
    s_waitcnt vmcnt(0)
    v_xor_b32 v32, s100, v32
    v_xor_b32 v33, s101, v33
    v_or_b32 v32, v32, v33
    v_cmp_eq_u32 vcc, 0, v32
    s_mov_b64 exec, -1
    s_nop 1
    s_lshr_b32 s63, vcc_lo, 1
    s_and_b32 s63, s63, vcc_lo
    s_sub_u32 s70, s70, 1
    s_cselect_b32 s63, -1, s63
    s_branch tail_pk10
    tail_go10:
    s_ff1_i32_b32 s74, s74
    s_bitset0_b32 s62, s74
    s_lshl_b32 s74, s74, 1
    s_add_u32 s74, s74, s19
    s_lshl_b32 s75, s74, 12
    s_add_u32 s75, s75, s77
    s_lshl_b32 s74, s74, 17
    s_add_u32 s74, s74, s26

    s_mov_b32 m0, 98304
    s_add_u32 s28, s75, 0
    buffer_load_dwordx4 v8, s[12:15], s28 offen lds
    buffer_load_dwordx4 v8, s[12:15], s28 offen offset:1024 lds
    s_mov_b32 m0, 100352
    s_add_u32 s28, s75, 2048
    buffer_load_dwordx4 v8, s[12:15], s28 offen lds
    buffer_load_dwordx4 v8, s[12:15], s28 offen offset:1024 lds
    s_mov_b32 m0, 102400
    s_add_u32 s28, s75, 65536
    buffer_load_dwordx4 v8, s[12:15], s28 offen lds
    buffer_load_dwordx4 v8, s[12:15], s28 offen offset:1024 lds
    s_mov_b32 m0, 104448
    s_add_u32 s28, s75, 67584
    buffer_load_dwordx4 v8, s[12:15], s28 offen lds
    buffer_load_dwordx4 v8, s[12:15], s28 offen offset:1024 lds
    s_mov_b32 m0, 106496
    s_add_u32 s28, s74, 0
    buffer_load_dwordx4 v31, s[8:11], s28 offen lds
    s_mov_b32 m0, 107520
    s_add_u32 s28, s74, 8192
    buffer_load_dwordx4 v31, s[8:11], s28 offen lds
    s_mov_b32 m0, 108544
    s_add_u32 s28, s74, 16384
    buffer_load_dwordx4 v31, s[8:11], s28 offen lds
    s_mov_b32 m0, 109568
    s_add_u32 s28, s74, 24576
    buffer_load_dwordx4 v31, s[8:11], s28 offen lds
    s_mov_b32 m0, 110592
    s_add_u32 s28, s74, 32768
    buffer_load_dwordx4 v31, s[8:11], s28 offen lds
    s_mov_b32 m0, 111616
    s_add_u32 s28, s74, 40960
    buffer_load_dwordx4 v31, s[8:11], s28 offen lds
    s_mov_b32 m0, 112640
    s_add_u32 s28, s74, 49152
    buffer_load_dwordx4 v31, s[8:11], s28 offen lds
    s_mov_b32 m0, 113664
    s_add_u32 s28, s74, 57344
    buffer_load_dwordx4 v31, s[8:11], s28 offen lds
    s_mov_b32 m0, 114688
    s_add_u32 s28, s74, 65536
    buffer_load_dwordx4 v31, s[8:11], s28 offen lds
    s_mov_b32 m0, 115712
    s_add_u32 s28, s74, 73728
    buffer_load_dwordx4 v31, s[8:11], s28 offen lds
    s_mov_b32 m0, 116736
    s_add_u32 s28, s74, 81920
    buffer_load_dwordx4 v31, s[8:11], s28 offen lds
    s_mov_b32 m0, 117760
    s_add_u32 s28, s74, 90112
    buffer_load_dwordx4 v31, s[8:11], s28 offen lds
    s_mov_b32 m0, 118784
    s_add_u32 s28, s74, 98304
    buffer_load_dwordx4 v31, s[8:11], s28 offen lds
    s_mov_b32 m0, 119808
    s_add_u32 s28, s74, 106496
    buffer_load_dwordx4 v31, s[8:11], s28 offen lds
    s_mov_b32 m0, 120832
    s_add_u32 s28, s74, 114688
    buffer_load_dwordx4 v31, s[8:11], s28 offen lds
    s_mov_b32 m0, 121856
    s_add_u32 s28, s74, 122880
    buffer_load_dwordx4 v31, s[8:11], s28 offen lds
qkv_kernel_own18:
    buffer_load_dwordx4 v[232:235], v15, s[52:55], s66 offen
    buffer_load_dwordx4 v[236:239], v15, s[52:55], s67 offen
    buffer_load_dwordx4 v[240:243], v15, s[52:55], s68 offen
    buffer_load_dwordx4 v[244:247], v15, s[52:55], s69 offen
    buffer_load_dword v16, v10, s[12:15], s33 offen
    buffer_load_dword v17, v10, s[12:15], s33 offen offset:2048
    buffer_load_dword v18, v10, s[12:15], s34 offen
    buffer_load_dwordx4 v[20:23], v11, s[44:47], 0 offen
    buffer_load_dwordx4 v[24:27], v11, s[44:47], 0 offen offset:16
    s_cmp_lg_u32 s19, 3
    s_cbranch_scc1 qkv_kernel_own19
    s_waitcnt vmcnt(11)
qkv_kernel_own19:
    s_barrier
    s_cmp_lg_u32 s19, 3
    s_cbranch_scc1 qkv_kernel_own20
    tail_pk11:
    s_and_b32 s74, s62, s63
    s_cbranch_scc1 tail_go11
    s_mov_b64 exec, 0xff
    buffer_load_dwordx2 v[32:33], v34, s[12:15], s79 offen sc1
    s_waitcnt vmcnt(0)
    v_xor_b32 v32, s100, v32
    v_xor_b32 v33, s101, v33
    v_or_b32 v32, v32, v33
    v_cmp_eq_u32 vcc, 0, v32
    s_mov_b64 exec, -1
    s_nop 1
    s_lshr_b32 s63, vcc_lo, 1
    s_and_b32 s63, s63, vcc_lo
    s_sub_u32 s70, s70, 1
    s_cselect_b32 s63, -1, s63
    s_branch tail_pk11
    tail_go11:
    s_ff1_i32_b32 s74, s74
    s_bitset0_b32 s62, s74
    s_lshl_b32 s74, s74, 1
    s_add_u32 s74, s74, s19
    s_lshl_b32 s75, s74, 12
    s_add_u32 s75, s75, s77
    s_lshl_b32 s74, s74, 17
    s_add_u32 s74, s74, s26

    s_mov_b32 m0, 122880
    s_add_u32 s28, s75, 0
    buffer_load_dwordx4 v8, s[12:15], s28 offen lds
    buffer_load_dwordx4 v8, s[12:15], s28 offen offset:1024 lds
    s_mov_b32 m0, 124928
    s_add_u32 s28, s75, 2048
    buffer_load_dwordx4 v8, s[12:15], s28 offen lds
    buffer_load_dwordx4 v8, s[12:15], s28 offen offset:1024 lds
    s_mov_b32 m0, 126976
    s_add_u32 s28, s75, 65536
    buffer_load_dwordx4 v8, s[12:15], s28 offen lds
    buffer_load_dwordx4 v8, s[12:15], s28 offen offset:1024 lds
    s_mov_b32 m0, 129024
    s_add_u32 s28, s75, 67584
    buffer_load_dwordx4 v8, s[12:15], s28 offen lds
    buffer_load_dwordx4 v8, s[12:15], s28 offen offset:1024 lds
    s_mov_b32 m0, 131072
    s_add_u32 s28, s74, 0
    buffer_load_dwordx4 v31, s[8:11], s28 offen lds
    s_mov_b32 m0, 132096
    s_add_u32 s28, s74, 8192
    buffer_load_dwordx4 v31, s[8:11], s28 offen lds
    s_mov_b32 m0, 133120
    s_add_u32 s28, s74, 16384
    buffer_load_dwordx4 v31, s[8:11], s28 offen lds
    s_mov_b32 m0, 134144
    s_add_u32 s28, s74, 24576
    buffer_load_dwordx4 v31, s[8:11], s28 offen lds
    s_mov_b32 m0, 135168
    s_add_u32 s28, s74, 32768
    buffer_load_dwordx4 v31, s[8:11], s28 offen lds
    s_mov_b32 m0, 136192
    s_add_u32 s28, s74, 40960
    buffer_load_dwordx4 v31, s[8:11], s28 offen lds
    s_mov_b32 m0, 137216
    s_add_u32 s28, s74, 49152
    buffer_load_dwordx4 v31, s[8:11], s28 offen lds
    s_mov_b32 m0, 138240
    s_add_u32 s28, s74, 57344
    buffer_load_dwordx4 v31, s[8:11], s28 offen lds
    s_mov_b32 m0, 139264
    s_add_u32 s28, s74, 65536
    buffer_load_dwordx4 v31, s[8:11], s28 offen lds
    s_mov_b32 m0, 140288
    s_add_u32 s28, s74, 73728
    buffer_load_dwordx4 v31, s[8:11], s28 offen lds
    s_mov_b32 m0, 141312
    s_add_u32 s28, s74, 81920
    buffer_load_dwordx4 v31, s[8:11], s28 offen lds
    s_mov_b32 m0, 142336
    s_add_u32 s28, s74, 90112
    buffer_load_dwordx4 v31, s[8:11], s28 offen lds
    s_mov_b32 m0, 143360
    s_add_u32 s28, s74, 98304
    buffer_load_dwordx4 v31, s[8:11], s28 offen lds
    s_mov_b32 m0, 144384
    s_add_u32 s28, s74, 106496
    buffer_load_dwordx4 v31, s[8:11], s28 offen lds
    s_mov_b32 m0, 145408
    s_add_u32 s28, s74, 114688
    buffer_load_dwordx4 v31, s[8:11], s28 offen lds
    s_mov_b32 m0, 146432
    s_add_u32 s28, s74, 122880
    buffer_load_dwordx4 v31, s[8:11], s28 offen lds
qkv_kernel_own20:
    s_cmp_lg_u32 s19, 0
    s_cbranch_scc1 qkv_kernel_own21
    s_waitcnt vmcnt(11)
qkv_kernel_own21:
    s_barrier
    s_cmp_lg_u32 s19, 0
    s_cbranch_scc1 qkv_kernel_own22
    tail_pk12:
    s_and_b32 s74, s62, s63
    s_cbranch_scc1 tail_go12
    s_mov_b64 exec, 0xff
    buffer_load_dwordx2 v[32:33], v34, s[12:15], s79 offen sc1
    s_waitcnt vmcnt(0)
    v_xor_b32 v32, s100, v32
    v_xor_b32 v33, s101, v33
    v_or_b32 v32, v32, v33
    v_cmp_eq_u32 vcc, 0, v32
    s_mov_b64 exec, -1
    s_nop 1
    s_lshr_b32 s63, vcc_lo, 1
    s_and_b32 s63, s63, vcc_lo
    s_sub_u32 s70, s70, 1
    s_cselect_b32 s63, -1, s63
    s_branch tail_pk12
    tail_go12:
    s_ff1_i32_b32 s74, s74
    s_bitset0_b32 s62, s74
    s_lshl_b32 s74, s74, 1
    s_add_u32 s74, s74, s19
    s_lshl_b32 s75, s74, 12
    s_add_u32 s75, s75, s77
    s_lshl_b32 s74, s74, 17
    s_add_u32 s74, s74, s26

    s_mov_b32 m0, 0
    s_add_u32 s28, s75, 0
    buffer_load_dwordx4 v8, s[12:15], s28 offen lds
    buffer_load_dwordx4 v8, s[12:15], s28 offen offset:1024 lds
    s_mov_b32 m0, 2048
    s_add_u32 s28, s75, 2048
    buffer_load_dwordx4 v8, s[12:15], s28 offen lds
    buffer_load_dwordx4 v8, s[12:15], s28 offen offset:1024 lds
    s_mov_b32 m0, 4096
    s_add_u32 s28, s75, 65536
    buffer_load_dwordx4 v8, s[12:15], s28 offen lds
    buffer_load_dwordx4 v8, s[12:15], s28 offen offset:1024 lds
    s_mov_b32 m0, 6144
    s_add_u32 s28, s75, 67584
    buffer_load_dwordx4 v8, s[12:15], s28 offen lds
    buffer_load_dwordx4 v8, s[12:15], s28 offen offset:1024 lds
    s_mov_b32 m0, 8192
    s_add_u32 s28, s74, 0
    buffer_load_dwordx4 v31, s[8:11], s28 offen lds
    s_mov_b32 m0, 9216
    s_add_u32 s28, s74, 8192
    buffer_load_dwordx4 v31, s[8:11], s28 offen lds
    s_mov_b32 m0, 10240
    s_add_u32 s28, s74, 16384
    buffer_load_dwordx4 v31, s[8:11], s28 offen lds
    s_mov_b32 m0, 11264
    s_add_u32 s28, s74, 24576
    buffer_load_dwordx4 v31, s[8:11], s28 offen lds
    s_mov_b32 m0, 12288
    s_add_u32 s28, s74, 32768
    buffer_load_dwordx4 v31, s[8:11], s28 offen lds
    s_mov_b32 m0, 13312
    s_add_u32 s28, s74, 40960
    buffer_load_dwordx4 v31, s[8:11], s28 offen lds
    s_mov_b32 m0, 14336
    s_add_u32 s28, s74, 49152
    buffer_load_dwordx4 v31, s[8:11], s28 offen lds
    s_mov_b32 m0, 15360
    s_add_u32 s28, s74, 57344
    buffer_load_dwordx4 v31, s[8:11], s28 offen lds
    s_mov_b32 m0, 16384
    s_add_u32 s28, s74, 65536
    buffer_load_dwordx4 v31, s[8:11], s28 offen lds
    s_mov_b32 m0, 17408
    s_add_u32 s28, s74, 73728
    buffer_load_dwordx4 v31, s[8:11], s28 offen lds
    s_mov_b32 m0, 18432
    s_add_u32 s28, s74, 81920
    buffer_load_dwordx4 v31, s[8:11], s28 offen lds
    s_mov_b32 m0, 19456
    s_add_u32 s28, s74, 90112
    buffer_load_dwordx4 v31, s[8:11], s28 offen lds
    s_mov_b32 m0, 20480
    s_add_u32 s28, s74, 98304
    buffer_load_dwordx4 v31, s[8:11], s28 offen lds
    s_mov_b32 m0, 21504
    s_add_u32 s28, s74, 106496
    buffer_load_dwordx4 v31, s[8:11], s28 offen lds
    s_mov_b32 m0, 22528
    s_add_u32 s28, s74, 114688
    buffer_load_dwordx4 v31, s[8:11], s28 offen lds
    s_mov_b32 m0, 23552
    s_add_u32 s28, s74, 122880
    buffer_load_dwordx4 v31, s[8:11], s28 offen lds
qkv_kernel_own22:
    s_cmp_lg_u32 s19, 1
    s_cbranch_scc1 qkv_kernel_own23
    s_waitcnt vmcnt(9)
qkv_kernel_own23:
    s_barrier
    s_cmp_lg_u32 s19, 1
    s_cbranch_scc1 qkv_kernel_own24
    tail_pk13:
    s_and_b32 s74, s62, s63
    s_cbranch_scc1 tail_go13
    s_mov_b64 exec, 0xff
    buffer_load_dwordx2 v[32:33], v34, s[12:15], s79 offen sc1
    s_waitcnt vmcnt(0)
    v_xor_b32 v32, s100, v32
    v_xor_b32 v33, s101, v33
    v_or_b32 v32, v32, v33
    v_cmp_eq_u32 vcc, 0, v32
    s_mov_b64 exec, -1
    s_nop 1
    s_lshr_b32 s63, vcc_lo, 1
    s_and_b32 s63, s63, vcc_lo
    s_sub_u32 s70, s70, 1
    s_cselect_b32 s63, -1, s63
    s_branch tail_pk13
    tail_go13:
    s_ff1_i32_b32 s74, s74
    s_bitset0_b32 s62, s74
    s_lshl_b32 s74, s74, 1
    s_add_u32 s74, s74, s19
    s_lshl_b32 s75, s74, 12
    s_add_u32 s75, s75, s77
    s_lshl_b32 s74, s74, 17
    s_add_u32 s74, s74, s26

    s_mov_b32 m0, 24576
    s_add_u32 s28, s75, 0
    buffer_load_dwordx4 v8, s[12:15], s28 offen lds
    buffer_load_dwordx4 v8, s[12:15], s28 offen offset:1024 lds
    s_mov_b32 m0, 26624
    s_add_u32 s28, s75, 2048
    buffer_load_dwordx4 v8, s[12:15], s28 offen lds
    buffer_load_dwordx4 v8, s[12:15], s28 offen offset:1024 lds
    s_mov_b32 m0, 28672
    s_add_u32 s28, s75, 65536
    buffer_load_dwordx4 v8, s[12:15], s28 offen lds
    buffer_load_dwordx4 v8, s[12:15], s28 offen offset:1024 lds
    s_mov_b32 m0, 30720
    s_add_u32 s28, s75, 67584
    buffer_load_dwordx4 v8, s[12:15], s28 offen lds
    buffer_load_dwordx4 v8, s[12:15], s28 offen offset:1024 lds
    s_mov_b32 m0, 32768
    s_add_u32 s28, s74, 0
    buffer_load_dwordx4 v31, s[8:11], s28 offen lds
    s_mov_b32 m0, 33792
    s_add_u32 s28, s74, 8192
    buffer_load_dwordx4 v31, s[8:11], s28 offen lds
    s_mov_b32 m0, 34816
    s_add_u32 s28, s74, 16384
    buffer_load_dwordx4 v31, s[8:11], s28 offen lds
    s_mov_b32 m0, 35840
    s_add_u32 s28, s74, 24576
    buffer_load_dwordx4 v31, s[8:11], s28 offen lds
    s_mov_b32 m0, 36864
    s_add_u32 s28, s74, 32768
    buffer_load_dwordx4 v31, s[8:11], s28 offen lds
    s_mov_b32 m0, 37888
    s_add_u32 s28, s74, 40960
    buffer_load_dwordx4 v31, s[8:11], s28 offen lds
    s_mov_b32 m0, 38912
    s_add_u32 s28, s74, 49152
    buffer_load_dwordx4 v31, s[8:11], s28 offen lds
    s_mov_b32 m0, 39936
    s_add_u32 s28, s74, 57344
    buffer_load_dwordx4 v31, s[8:11], s28 offen lds
    s_mov_b32 m0, 40960
    s_add_u32 s28, s74, 65536
    buffer_load_dwordx4 v31, s[8:11], s28 offen lds
    s_mov_b32 m0, 41984
    s_add_u32 s28, s74, 73728
    buffer_load_dwordx4 v31, s[8:11], s28 offen lds
    s_mov_b32 m0, 43008
    s_add_u32 s28, s74, 81920
    buffer_load_dwordx4 v31, s[8:11], s28 offen lds
    s_mov_b32 m0, 44032
    s_add_u32 s28, s74, 90112
    buffer_load_dwordx4 v31, s[8:11], s28 offen lds
    s_mov_b32 m0, 45056
    s_add_u32 s28, s74, 98304
    buffer_load_dwordx4 v31, s[8:11], s28 offen lds
    s_mov_b32 m0, 46080
    s_add_u32 s28, s74, 106496
    buffer_load_dwordx4 v31, s[8:11], s28 offen lds
    s_mov_b32 m0, 47104
    s_add_u32 s28, s74, 114688
    buffer_load_dwordx4 v31, s[8:11], s28 offen lds
    s_mov_b32 m0, 48128
    s_add_u32 s28, s74, 122880
    buffer_load_dwordx4 v31, s[8:11], s28 offen lds
qkv_kernel_own24:
    s_cmp_lg_u32 s19, 2
    s_cbranch_scc1 qkv_kernel_own25
    s_waitcnt vmcnt(9)
qkv_kernel_own25:
    s_barrier
    s_cmp_lg_u32 s19, 2
    s_cbranch_scc1 qkv_kernel_own26
    tail_pk14:
    s_and_b32 s74, s62, s63
    s_cbranch_scc1 tail_go14
    s_mov_b64 exec, 0xff
    buffer_load_dwordx2 v[32:33], v34, s[12:15], s79 offen sc1
    s_waitcnt vmcnt(0)
    v_xor_b32 v32, s100, v32
    v_xor_b32 v33, s101, v33
    v_or_b32 v32, v32, v33
    v_cmp_eq_u32 vcc, 0, v32
    s_mov_b64 exec, -1
    s_nop 1
    s_lshr_b32 s63, vcc_lo, 1
    s_and_b32 s63, s63, vcc_lo
    s_sub_u32 s70, s70, 1
    s_cselect_b32 s63, -1, s63
    s_branch tail_pk14
    tail_go14:
    s_ff1_i32_b32 s74, s74
    s_bitset0_b32 s62, s74
    s_lshl_b32 s74, s74, 1
    s_add_u32 s74, s74, s19
    s_lshl_b32 s75, s74, 12
    s_add_u32 s75, s75, s77
    s_lshl_b32 s74, s74, 17
    s_add_u32 s74, s74, s26

    s_mov_b32 m0, 49152
    s_add_u32 s28, s75, 0
    buffer_load_dwordx4 v8, s[12:15], s28 offen lds
    buffer_load_dwordx4 v8, s[12:15], s28 offen offset:1024 lds
    s_mov_b32 m0, 51200
    s_add_u32 s28, s75, 2048
    buffer_load_dwordx4 v8, s[12:15], s28 offen lds
    buffer_load_dwordx4 v8, s[12:15], s28 offen offset:1024 lds
    s_mov_b32 m0, 53248
    s_add_u32 s28, s75, 65536
    buffer_load_dwordx4 v8, s[12:15], s28 offen lds
    buffer_load_dwordx4 v8, s[12:15], s28 offen offset:1024 lds
    s_mov_b32 m0, 55296
    s_add_u32 s28, s75, 67584
    buffer_load_dwordx4 v8, s[12:15], s28 offen lds
    buffer_load_dwordx4 v8, s[12:15], s28 offen offset:1024 lds
    s_mov_b32 m0, 57344
    s_add_u32 s28, s74, 0
    buffer_load_dwordx4 v31, s[8:11], s28 offen lds
    s_mov_b32 m0, 58368
    s_add_u32 s28, s74, 8192
    buffer_load_dwordx4 v31, s[8:11], s28 offen lds
    s_mov_b32 m0, 59392
    s_add_u32 s28, s74, 16384
    buffer_load_dwordx4 v31, s[8:11], s28 offen lds
    s_mov_b32 m0, 60416
    s_add_u32 s28, s74, 24576
    buffer_load_dwordx4 v31, s[8:11], s28 offen lds
    s_mov_b32 m0, 61440
    s_add_u32 s28, s74, 32768
    buffer_load_dwordx4 v31, s[8:11], s28 offen lds
    s_mov_b32 m0, 62464
    s_add_u32 s28, s74, 40960
    buffer_load_dwordx4 v31, s[8:11], s28 offen lds
    s_mov_b32 m0, 63488
    s_add_u32 s28, s74, 49152
    buffer_load_dwordx4 v31, s[8:11], s28 offen lds
    s_mov_b32 m0, 64512
    s_add_u32 s28, s74, 57344
    buffer_load_dwordx4 v31, s[8:11], s28 offen lds
    s_mov_b32 m0, 65536
    s_add_u32 s28, s74, 65536
    buffer_load_dwordx4 v31, s[8:11], s28 offen lds
    s_mov_b32 m0, 66560
    s_add_u32 s28, s74, 73728
    buffer_load_dwordx4 v31, s[8:11], s28 offen lds
    s_mov_b32 m0, 67584
    s_add_u32 s28, s74, 81920
    buffer_load_dwordx4 v31, s[8:11], s28 offen lds
    s_mov_b32 m0, 68608
    s_add_u32 s28, s74, 90112
    buffer_load_dwordx4 v31, s[8:11], s28 offen lds
    s_mov_b32 m0, 69632
    s_add_u32 s28, s74, 98304
    buffer_load_dwordx4 v31, s[8:11], s28 offen lds
    s_mov_b32 m0, 70656
    s_add_u32 s28, s74, 106496
    buffer_load_dwordx4 v31, s[8:11], s28 offen lds
    s_mov_b32 m0, 71680
    s_add_u32 s28, s74, 114688
    buffer_load_dwordx4 v31, s[8:11], s28 offen lds
    s_mov_b32 m0, 72704
    s_add_u32 s28, s74, 122880
    buffer_load_dwordx4 v31, s[8:11], s28 offen lds
qkv_kernel_own26:
    s_cmp_lg_u32 s19, 3
    s_cbranch_scc1 qkv_kernel_own27
    s_waitcnt vmcnt(0)
qkv_kernel_own27:
    s_barrier
    s_cmp_lg_u32 s19, 3
    s_cbranch_scc1 qkv_kernel_own28
    tail_pk15:
    s_and_b32 s74, s62, s63
    s_cbranch_scc1 tail_go15
    s_mov_b64 exec, 0xff
    buffer_load_dwordx2 v[32:33], v34, s[12:15], s79 offen sc1
    s_waitcnt vmcnt(0)
    v_xor_b32 v32, s100, v32
    v_xor_b32 v33, s101, v33
    v_or_b32 v32, v32, v33
    v_cmp_eq_u32 vcc, 0, v32
    s_mov_b64 exec, -1
    s_nop 1
    s_lshr_b32 s63, vcc_lo, 1
    s_and_b32 s63, s63, vcc_lo
    s_sub_u32 s70, s70, 1
    s_cselect_b32 s63, -1, s63
    s_branch tail_pk15
    tail_go15:
    s_ff1_i32_b32 s74, s74
    s_bitset0_b32 s62, s74
    s_lshl_b32 s74, s74, 1
    s_add_u32 s74, s74, s19
    s_lshl_b32 s75, s74, 12
    s_add_u32 s75, s75, s77
    s_lshl_b32 s74, s74, 17
    s_add_u32 s74, s74, s26

    s_mov_b32 m0, 73728
    s_add_u32 s28, s75, 0
    buffer_load_dwordx4 v8, s[12:15], s28 offen lds
    buffer_load_dwordx4 v8, s[12:15], s28 offen offset:1024 lds
    s_mov_b32 m0, 75776
    s_add_u32 s28, s75, 2048
    buffer_load_dwordx4 v8, s[12:15], s28 offen lds
    buffer_load_dwordx4 v8, s[12:15], s28 offen offset:1024 lds
    s_mov_b32 m0, 77824
    s_add_u32 s28, s75, 65536
    buffer_load_dwordx4 v8, s[12:15], s28 offen lds
    buffer_load_dwordx4 v8, s[12:15], s28 offen offset:1024 lds
    s_mov_b32 m0, 79872
    s_add_u32 s28, s75, 67584
    buffer_load_dwordx4 v8, s[12:15], s28 offen lds
    buffer_load_dwordx4 v8, s[12:15], s28 offen offset:1024 lds
    s_mov_b32 m0, 81920
    s_add_u32 s28, s74, 0
    buffer_load_dwordx4 v31, s[8:11], s28 offen lds
    s_mov_b32 m0, 82944
    s_add_u32 s28, s74, 8192
    buffer_load_dwordx4 v31, s[8:11], s28 offen lds
    s_mov_b32 m0, 83968
    s_add_u32 s28, s74, 16384
    buffer_load_dwordx4 v31, s[8:11], s28 offen lds
    s_mov_b32 m0, 84992
    s_add_u32 s28, s74, 24576
    buffer_load_dwordx4 v31, s[8:11], s28 offen lds
    s_mov_b32 m0, 86016
    s_add_u32 s28, s74, 32768
    buffer_load_dwordx4 v31, s[8:11], s28 offen lds
    s_mov_b32 m0, 87040
    s_add_u32 s28, s74, 40960
    buffer_load_dwordx4 v31, s[8:11], s28 offen lds
    s_mov_b32 m0, 88064
    s_add_u32 s28, s74, 49152
    buffer_load_dwordx4 v31, s[8:11], s28 offen lds
    s_mov_b32 m0, 89088
    s_add_u32 s28, s74, 57344
    buffer_load_dwordx4 v31, s[8:11], s28 offen lds
    s_mov_b32 m0, 90112
    s_add_u32 s28, s74, 65536
    buffer_load_dwordx4 v31, s[8:11], s28 offen lds
    s_mov_b32 m0, 91136
    s_add_u32 s28, s74, 73728
    buffer_load_dwordx4 v31, s[8:11], s28 offen lds
    s_mov_b32 m0, 92160
    s_add_u32 s28, s74, 81920
    buffer_load_dwordx4 v31, s[8:11], s28 offen lds
    s_mov_b32 m0, 93184
    s_add_u32 s28, s74, 90112
    buffer_load_dwordx4 v31, s[8:11], s28 offen lds
    s_mov_b32 m0, 94208
    s_add_u32 s28, s74, 98304
    buffer_load_dwordx4 v31, s[8:11], s28 offen lds
    s_mov_b32 m0, 95232
    s_add_u32 s28, s74, 106496
    buffer_load_dwordx4 v31, s[8:11], s28 offen lds
    s_mov_b32 m0, 96256
    s_add_u32 s28, s74, 114688
    buffer_load_dwordx4 v31, s[8:11], s28 offen lds
    s_mov_b32 m0, 97280
    s_add_u32 s28, s74, 122880
    buffer_load_dwordx4 v31, s[8:11], s28 offen lds
qkv_kernel_own28:
    s_add_u32 m0, s31, 98304
    s_add_u32 s28, s30, 0
    buffer_load_dwordx4 v8, s[56:59], s28 offen lds
    s_add_u32 m0, s31, 99328
    s_add_u32 s28, s30, 1024
    buffer_load_dwordx4 v8, s[56:59], s28 offen lds
    s_add_u32 m0, s31, 100352
    s_add_u32 s28, s30, 2048
    buffer_load_dwordx4 v8, s[56:59], s28 offen lds
    s_add_u32 m0, s31, 101376
    s_add_u32 s28, s30, 3072
    buffer_load_dwordx4 v8, s[56:59], s28 offen lds
    s_add_u32 m0, s31, 102400
    s_add_u32 s28, s30, 4096
    buffer_load_dwordx4 v8, s[56:59], s28 offen lds
    s_add_u32 m0, s31, 103424
    s_add_u32 s28, s30, 5120
    buffer_load_dwordx4 v8, s[56:59], s28 offen lds
    s_cmp_lg_u32 s19, 0
    s_cbranch_scc1 qkv_kernel_own29
    s_waitcnt vmcnt(6)
qkv_kernel_own29:
    s_barrier
    s_add_u32 m0, s31, 122880
    s_add_u32 s28, s30, 6144
    buffer_load_dwordx4 v8, s[56:59], s28 offen lds
    s_add_u32 m0, s31, 123904
    s_add_u32 s28, s30, 7168
    buffer_load_dwordx4 v8, s[56:59], s28 offen lds
    s_add_u32 m0, s31, 124928
    s_add_u32 s28, s30, 8388608
    buffer_load_dwordx4 v8, s[56:59], s28 offen lds
    s_add_u32 m0, s31, 125952
    s_add_u32 s28, s30, 8389632
    buffer_load_dwordx4 v8, s[56:59], s28 offen lds
    s_add_u32 m0, s31, 126976
    s_add_u32 s28, s30, 8390656
    buffer_load_dwordx4 v8, s[56:59], s28 offen lds
    s_add_u32 m0, s31, 128000
    s_add_u32 s28, s30, 8391680
    buffer_load_dwordx4 v8, s[56:59], s28 offen lds
    s_cmp_lg_u32 s19, 1
    s_cbranch_scc1 qkv_kernel_own30
    s_waitcnt vmcnt(12)
qkv_kernel_own30:
    s_barrier
    s_add_u32 m0, s31, 0
    s_add_u32 s28, s30, 8392704
    buffer_load_dwordx4 v8, s[56:59], s28 offen lds
    s_add_u32 m0, s31, 1024
    s_add_u32 s28, s30, 8393728
    buffer_load_dwordx4 v8, s[56:59], s28 offen lds
    s_add_u32 m0, s31, 2048
    s_add_u32 s28, s30, 8394752
    buffer_load_dwordx4 v8, s[56:59], s28 offen lds
    s_add_u32 m0, s31, 3072
    s_add_u32 s28, s30, 8395776
    buffer_load_dwordx4 v8, s[56:59], s28 offen lds
    s_cmp_lg_u32 s19, 2
    s_cbranch_scc1 qkv_kernel_own31
    s_waitcnt vmcnt(16)
qkv_kernel_own31:
    s_barrier
    s_cmp_lg_u32 s19, 3
    s_cbranch_scc1 qkv_kernel_own32
    s_waitcnt vmcnt(16)
qkv_kernel_own32:
    s_barrier
    v_lshrrev_b32 v4, 2, v2
    v_and_b32 v4, 3, v4
    v_lshlrev_b32 v4, 5, v4
    v_lshl_add_u32 v4, v3, 8, v4
    v_and_b32 v5, 3, v2
    v_lshl_add_u32 v4, v5, 3, v4
    v_add_u32 v4, s31, v4
    v_add_u32 v5, 98304, v4
    s_lshl_b32 s35, s19, 9
    v_lshl_add_u32 v12, v3, 4, s35

    s_barrier
    s_cmp_eq_u32 s18, 4
    s_cbranch_scc1 tail_lead
    s_waitcnt vmcnt(0)

    ds_read_b64_tr_b16 v[96:97], v5 offset:0
    ds_read_b64_tr_b16 v[98:99], v5 offset:128
    ds_read_b64_tr_b16 v[100:101], v5 offset:1024
    ds_read_b64_tr_b16 v[102:103], v5 offset:1152
    ds_read_b64_tr_b16 v[104:105], v5 offset:2048
    ds_read_b64_tr_b16 v[106:107], v5 offset:2176
    ds_read_b64_tr_b16 v[108:109], v5 offset:3072
    ds_read_b64_tr_b16 v[110:111], v5 offset:3200
    ds_read_b64_tr_b16 v[112:113], v5 offset:4096
    ds_read_b64_tr_b16 v[114:115], v5 offset:4224
    ds_read_b64_tr_b16 v[116:117], v5 offset:5120
    ds_read_b64_tr_b16 v[118:119], v5 offset:5248
    ds_read_b64_tr_b16 v[120:121], v5 offset:24576
    ds_read_b64_tr_b16 v[122:123], v5 offset:24704
    ds_read_b64_tr_b16 v[124:125], v5 offset:25600
    ds_read_b64_tr_b16 v[126:127], v5 offset:25728
    ds_read_b64_tr_b16 v[128:129], v5 offset:26624
    ds_read_b64_tr_b16 v[130:131], v5 offset:26752
    ds_read_b64_tr_b16 v[132:133], v5 offset:27648
    ds_read_b64_tr_b16 v[134:135], v5 offset:27776
    ds_read_b64_tr_b16 v[136:137], v5 offset:28672
    ds_read_b64_tr_b16 v[138:139], v5 offset:28800
    ds_read_b64_tr_b16 v[140:141], v5 offset:29696
    ds_read_b64_tr_b16 v[142:143], v5 offset:29824
    ds_read_b64_tr_b16 v[144:145], v4 offset:0
    ds_read_b64_tr_b16 v[146:147], v4 offset:128
    ds_read_b64_tr_b16 v[148:149], v4 offset:1024
    ds_read_b64_tr_b16 v[150:151], v4 offset:1152
    ds_read_b64_tr_b16 v[152:153], v4 offset:2048
    ds_read_b64_tr_b16 v[154:155], v4 offset:2176
    ds_read_b64_tr_b16 v[156:157], v4 offset:3072
    ds_read_b64_tr_b16 v[158:159], v4 offset:3200
    s_barrier
    s_sub_u32 s19, s18, 1
    s_cmp_lg_u32 s65, 0
    s_cbranch_scc1 tail_red
    s_sub_u32 s19, s18, 4
    s_branch tail_gemv

tail_lead:
    ds_read_b128 v[32:35], v8 offset:49152
    ds_read_b128 v[36:39], v8 offset:50176
    ds_read_b128 v[40:43], v8 offset:51200
    ds_read_b128 v[44:47], v8 offset:52224
    ds_read_b128 v[48:51], v8 offset:53248
    ds_read_b128 v[52:55], v8 offset:54272
    ds_read_b128 v[56:59], v8 offset:55296
    ds_read_b128 v[60:63], v8 offset:56320
    s_lshl_b32 s36, s16, 13
    s_add_u32 s36, s36, 27131904
    s_lshl_b32 s37, s17, 10
    s_add_u32 s37, s37, s36
    s_add_u32 s38, s36, 4096
    s_mov_b32 s39, -2
    s_waitcnt lgkmcnt(0)

    v_add_f32 v64, v32, v36
    v_add_f32 v65, v33, v37
    v_add_f32 v66, v34, v38
    v_add_f32 v67, v35, v39
    v_add_f32 v64, v64, v40
    v_add_f32 v65, v65, v41
    v_add_f32 v66, v66, v42
    v_add_f32 v67, v67, v43
    v_add_f32 v64, v64, v44
    v_add_f32 v65, v65, v45
    v_add_f32 v66, v66, v46
    v_add_f32 v67, v67, v47
    v_add_f32 v64, v64, v48
    v_add_f32 v65, v65, v49
    v_add_f32 v66, v66, v50
    v_add_f32 v67, v67, v51
    v_add_f32 v64, v64, v52
    v_add_f32 v65, v65, v53
    v_add_f32 v66, v66, v54
    v_add_f32 v67, v67, v55
    v_add_f32 v64, v64, v56
    v_add_f32 v65, v65, v57
    v_add_f32 v66, v66, v58
    v_add_f32 v67, v67, v59
    v_add_f32 v64, v64, v60
    v_add_f32 v65, v65, v61
    v_add_f32 v66, v66, v62
    v_add_f32 v67, v67, v63
    v_mul_f32 v68, 1006632960, v64
    s_mov_b32 s35, 1031798784
    v_fma_f32 v32, v32, s35, -v68
    v_fma_f32 v36, v36, s35, -v68
    v_fma_f32 v40, v40, s35, -v68
    v_fma_f32 v44, v44, s35, -v68
    v_fma_f32 v48, v48, s35, -v68
    v_fma_f32 v52, v52, s35, -v68
    v_fma_f32 v56, v56, s35, -v68
    v_fma_f32 v60, v60, s35, -v68
    v_mul_f32 v69, v32, v32
    v_mul_f32 v70, v36, v36
    v_fmac_f32 v69, v40, v40
    v_fmac_f32 v70, v44, v44
    v_fmac_f32 v69, v48, v48
    v_fmac_f32 v70, v52, v52
    v_fmac_f32 v69, v56, v56
    v_fmac_f32 v70, v60, v60
    v_add_f32 v69, v69, v70
    v_fmac_f32 v65, 1098907648, v69
    v_min_u32 v64, s39, v64
    v_min_u32 v65, s39, v65
    v_min_u32 v66, s39, v66
    v_min_u32 v67, s39, v67
    buffer_store_dwordx4 v[64:67], v8, s[12:15], s37 offen sc1
tail_poll1:
    buffer_load_dwordx4 v[32:35], v8, s[12:15], s36 offen offset:0 sc1
    buffer_load_dwordx4 v[36:39], v8, s[12:15], s36 offen offset:1024 sc1
    buffer_load_dwordx4 v[40:43], v8, s[12:15], s36 offen offset:2048 sc1
    buffer_load_dwordx4 v[44:47], v8, s[12:15], s36 offen offset:3072 sc1
    buffer_load_dwordx4 v[48:51], v8, s[12:15], s38 offen offset:0 sc1
    buffer_load_dwordx4 v[52:55], v8, s[12:15], s38 offen offset:1024 sc1
    buffer_load_dwordx4 v[56:59], v8, s[12:15], s38 offen offset:2048 sc1
    buffer_load_dwordx4 v[60:63], v8, s[12:15], s38 offen offset:3072 sc1
    s_waitcnt vmcnt(0)
    v_max3_u32 v64, v32, v33, v34
    v_max3_u32 v65, v35, v36, v37
    v_max3_u32 v64, v64, v38, v39
    v_max3_u32 v65, v65, v40, v41
    v_max3_u32 v64, v64, v42, v43
    v_max3_u32 v65, v65, v44, v45
    v_max3_u32 v64, v64, v46, v47
    v_max3_u32 v65, v65, v48, v49
    v_max3_u32 v64, v64, v50, v51
    v_max3_u32 v65, v65, v52, v53
    v_max3_u32 v64, v64, v54, v55
    v_max3_u32 v65, v65, v56, v57
    v_max3_u32 v64, v64, v58, v59
    v_max3_u32 v65, v65, v60, v61
    v_max3_u32 v64, v64, v62, v63
    v_max_u32 v64, v64, v65
    v_cmp_eq_u32 vcc, -1, v64
    s_sub_u32 s70, s70, 1
    s_cbranch_scc1 tail_poll1x
    s_cbranch_vccnz tail_poll1
    tail_poll1x:

    v_add_f32 v64, v32, v36
    v_add_f32 v65, v33, v37
    v_add_f32 v66, v34, v38
    v_add_f32 v67, v35, v39
    v_add_f32 v64, v64, v40
    v_add_f32 v65, v65, v41
    v_add_f32 v66, v66, v42
    v_add_f32 v67, v67, v43
    v_add_f32 v64, v64, v44
    v_add_f32 v65, v65, v45
    v_add_f32 v66, v66, v46
    v_add_f32 v67, v67, v47
    v_add_f32 v64, v64, v48
    v_add_f32 v65, v65, v49
    v_add_f32 v66, v66, v50
    v_add_f32 v67, v67, v51
    v_add_f32 v64, v64, v52
    v_add_f32 v65, v65, v53
    v_add_f32 v66, v66, v54
    v_add_f32 v67, v67, v55
    v_add_f32 v64, v64, v56
    v_add_f32 v65, v65, v57
    v_add_f32 v66, v66, v58
    v_add_f32 v67, v67, v59
    v_add_f32 v64, v64, v60
    v_add_f32 v65, v65, v61
    v_add_f32 v66, v66, v62
    v_add_f32 v67, v67, v63
    v_mul_f32 v68, 981467136, v64
    s_mov_b32 s35, 1006632960
    v_fma_f32 v32, v32, s35, -v68
    v_fma_f32 v36, v36, s35, -v68
    v_fma_f32 v40, v40, s35, -v68
    v_fma_f32 v44, v44, s35, -v68
    v_fma_f32 v48, v48, s35, -v68
    v_fma_f32 v52, v52, s35, -v68
    v_fma_f32 v56, v56, s35, -v68
    v_fma_f32 v60, v60, s35, -v68
    v_mul_f32 v69, v32, v32
    v_mul_f32 v70, v36, v36
    v_fmac_f32 v69, v40, v40
    v_fmac_f32 v70, v44, v44
    v_fmac_f32 v69, v48, v48
    v_fmac_f32 v70, v52, v52
    v_fmac_f32 v69, v56, v56
    v_fmac_f32 v70, v60, v60
    v_add_f32 v69, v69, v70
    v_fmac_f32 v65, 1124073472, v69
    v_mul_f32 v69, 0x3a800000, v65
    v_cvt_pk_bf16_f32 v70, v68, v69
    v_lshlrev_b32 v68, 16, v70
    v_and_b32 v69, 0xffff0000, v70
    v_add_f32 v69, 0x3727c5ac, v69
    v_cvt_pk_bf16_f32 v69, v69, v69
    v_lshlrev_b32 v69, 16, v69
    v_sqrt_f32 v69, v69
    v_fma_f32 v66, -v68, v67, v66
    v_cvt_pk_bf16_f32 v69, v69, v69
    v_lshlrev_b32 v69, 16, v69
    v_rcp_f32 v69, v69
    s_lshl_b32 s35, s16, 6
    s_sub_u32 s35, 2047, s35
    v_sub_u32 v71, s35, v2
    v_mul_f32 v66, v66, v69
    v_lshlrev_b32 v72, 3, v2
    v_ashrrev_i32 v70, 31, v66
    v_or_b32 v70, 0x80000000, v70
    v_xor_b32 v66, v66, v70
    v_and_b32 v66, 0xfffff000, v66
    v_or_b32 v66, v66, v71
    ds_write_b64 v72, v[68:69] offset:57344

    s_nop 1
    v_max_u32_dpp v70, v66, v66 quad_perm:[1,0,3,2] row_mask:0xf bank_mask:0xf
    s_nop 1
    v_max_u32_dpp v66, v70, v70 quad_perm:[2,3,0,1] row_mask:0xf bank_mask:0xf
    s_nop 1
    v_max_u32_dpp v70, v66, v66 row_half_mirror row_mask:0xf bank_mask:0xf
    s_nop 1
    v_max_u32_dpp v66, v70, v70 row_mirror row_mask:0xf bank_mask:0xf
    s_nop 0
    v_mov_b32 v70, v66
    s_nop 1
    v_permlane16_swap_b32 v66, v70
    s_nop 0
    v_max_u32 v66, v66, v70
    v_mov_b32 v70, v66
    s_nop 1
    v_permlane32_swap_b32 v66, v70
    s_nop 0
    v_max_u32 v66, v66, v70

    s_lshl_b32 s35, s17, 9
    s_lshl_b32 s36, s16, 2
    s_add_u32 s35, s35, s36
    s_add_u32 s35, s35, 27525120
    v_lshlrev_b32 v70, 7, v2
    v_readfirstlane_b32 s40, v66
    s_mov_b64 exec, 15
    buffer_store_dword v66, v70, s[12:15], s35 offen sc1
    s_mov_b64 exec, -1
    s_not_b32 s41, s40
    s_and_b32 s41, s41, 63
    v_mov_b32 v70, 57856
    v_mov_b32 v71, s41
    ds_write_b32 v70, v71
    s_lshl_b32 s42, s41, 3
    v_add_u32 v70, s42, v10
    v_and_b32 v70, 255, v70
    s_lshl_b32 s42, s41, 8
    v_add_u32 v70, s42, v70
    ds_read_b32 v72, v70 offset:24576
    v_readlane_b32 s42, v68, s41
    v_readlane_b32 s43, v69, s41
    s_waitcnt lgkmcnt(1)
    s_barrier

    v_lshlrev_b32 v78, 16, v17
    v_and_b32 v79, 0xffff0000, v17
    v_add_f32 v78, 1.0, v78
    v_add_f32 v79, 1.0, v79
    v_cvt_pk_bf16_f32 v70, v78, v79
    v_lshlrev_b32 v78, 16, v70
    v_and_b32 v79, 0xffff0000, v70
    s_lshl_b32 s35, s16, 12
    s_add_u32 s35, s35, s32
    s_add_u32 s35, s35, 27394048
    s_waitcnt lgkmcnt(0)

    v_lshlrev_b32 v74, 16, v72
    v_and_b32 v75, 0xffff0000, v72
    v_subrev_f32 v76, s42, v74
    v_subrev_f32 v77, s42, v75
    v_cvt_pk_bf16_f32 v70, v76, v77
    v_lshlrev_b32 v76, 16, v70
    v_and_b32 v77, 0xffff0000, v70
    v_mul_f32 v76, s43, v76
    v_mul_f32 v77, s43, v77
    v_cvt_pk_bf16_f32 v70, v76, v77
    v_lshlrev_b32 v76, 16, v70
    v_and_b32 v77, 0xffff0000, v70
    v_mul_f32 v76, v76, v78
    v_mul_f32 v77, v77, v79
    v_cvt_pk_bf16_f32 v70, v76, v77
    v_lshlrev_b32 v76, 16, v70
    v_and_b32 v77, 0xffff0000, v70
    v_lshlrev_b32 v78, 16, v16
    v_and_b32 v79, 0xffff0000, v16
    v_add_f32 v76, v76, v78
    v_add_f32 v77, v77, v79
    v_cvt_pk_bf16_f32 v73, v76, v77
    v_min_u32 v70, s39, v73
    v_min_u32 v71, s39, v72
    buffer_store_dword v70, v10, s[12:15], s35 offen sc1
    buffer_store_dword v71, v10, s[12:15], s35 offen offset:2048 sc1

    v_lshlrev_b32 v76, 16, v73
    v_and_b32 v77, 0xffff0000, v73
    v_lshlrev_b32 v78, 16, v18
    v_and_b32 v79, 0xffff0000, v18
    v_mul_f32 v76, v76, v78
    v_mul_f32 v77, v77, v79
    v_cvt_pk_bf16_f32 v70, v76, v77
    v_lshlrev_b32 v76, 16, v70
    v_and_b32 v77, 0xffff0000, v70
    v_add_f32 v76, v76, v74
    v_add_f32 v77, v77, v75
    v_cvt_pk_bf16_f32 v73, v76, v77
    ds_read_b64_tr_b16 v[96:97], v5 offset:0
    ds_read_b64_tr_b16 v[98:99], v5 offset:128
    ds_read_b64_tr_b16 v[100:101], v5 offset:1024
    ds_read_b64_tr_b16 v[102:103], v5 offset:1152
    ds_read_b64_tr_b16 v[104:105], v5 offset:2048
    ds_read_b64_tr_b16 v[106:107], v5 offset:2176
    ds_read_b64_tr_b16 v[108:109], v5 offset:3072
    ds_read_b64_tr_b16 v[110:111], v5 offset:3200
    ds_read_b64_tr_b16 v[112:113], v5 offset:4096
    ds_read_b64_tr_b16 v[114:115], v5 offset:4224
    ds_read_b64_tr_b16 v[116:117], v5 offset:5120
    ds_read_b64_tr_b16 v[118:119], v5 offset:5248
    ds_read_b64_tr_b16 v[120:121], v5 offset:24576
    ds_read_b64_tr_b16 v[122:123], v5 offset:24704
    ds_read_b64_tr_b16 v[124:125], v5 offset:25600
    ds_read_b64_tr_b16 v[126:127], v5 offset:25728
    ds_read_b64_tr_b16 v[128:129], v5 offset:26624
    ds_read_b64_tr_b16 v[130:131], v5 offset:26752
    ds_read_b64_tr_b16 v[132:133], v5 offset:27648
    ds_read_b64_tr_b16 v[134:135], v5 offset:27776
    ds_read_b64_tr_b16 v[136:137], v5 offset:28672
    ds_read_b64_tr_b16 v[138:139], v5 offset:28800
    ds_read_b64_tr_b16 v[140:141], v5 offset:29696
    ds_read_b64_tr_b16 v[142:143], v5 offset:29824
    ds_read_b64_tr_b16 v[144:145], v4 offset:0
    ds_read_b64_tr_b16 v[146:147], v4 offset:128
    ds_read_b64_tr_b16 v[148:149], v4 offset:1024
    ds_read_b64_tr_b16 v[150:151], v4 offset:1152
    ds_read_b64_tr_b16 v[152:153], v4 offset:2048
    ds_read_b64_tr_b16 v[154:155], v4 offset:2176
    ds_read_b64_tr_b16 v[156:157], v4 offset:3072
    ds_read_b64_tr_b16 v[158:159], v4 offset:3200
    s_and_b32 s35, s2, 31
    s_lshl_b32 s35, s35, 7
    s_add_u32 s35, s35, 27525120
    v_and_b32 v70, 127, v10

tail_poll2:
    buffer_load_dword v66, v70, s[12:15], s35 offen sc1
    s_waitcnt vmcnt(0)
    v_cmp_eq_u32 vcc, -1, v66
    s_sub_u32 s70, s70, 1
    s_cbranch_scc1 tail_poll2x
    s_cbranch_vccnz tail_poll2
    tail_poll2x:

    s_nop 1
    v_max_u32_dpp v71, v66, v66 quad_perm:[1,0,3,2] row_mask:0xf bank_mask:0xf
    s_nop 1
    v_max_u32_dpp v66, v71, v71 quad_perm:[2,3,0,1] row_mask:0xf bank_mask:0xf
    s_nop 1
    v_max_u32_dpp v71, v66, v66 row_half_mirror row_mask:0xf bank_mask:0xf
    s_nop 1
    v_max_u32_dpp v66, v71, v71 row_mirror row_mask:0xf bank_mask:0xf
    s_nop 0
    v_mov_b32 v71, v66
    s_nop 1
    v_permlane16_swap_b32 v66, v71
    s_nop 0
    v_max_u32 v66, v66, v71
    v_mov_b32 v71, v66
    s_nop 1
    v_permlane32_swap_b32 v66, v71
    s_nop 0
    v_max_u32 v66, v66, v71

    s_nop 0
    v_readfirstlane_b32 s41, v66
    s_not_b32 s42, s41
    s_and_b32 s42, s42, 0x7ff
    s_lshr_b32 s43, s42, 6
    s_lshl_b32 s43, s43, 12
    s_add_u32 s43, s43, 27394048

tail_poll3:
    buffer_load_dwordx4 v[32:35], v11, s[12:15], s43 offen sc1
    buffer_load_dwordx4 v[36:39], v11, s[12:15], s43 offen offset:16 sc1
    s_waitcnt vmcnt(0)
    v_max3_u32 v70, v32, v33, v34
    v_max3_u32 v71, v35, v36, v37
    v_max3_u32 v70, v70, v38, v39
    v_max_u32 v70, v70, v71
    v_cmp_eq_u32 vcc, -1, v70
    s_sub_u32 s70, s70, 1
    s_cbranch_scc1 tail_poll3x
    s_cbranch_vccnz tail_poll3
    tail_poll3x:
    ds_write_b128 v11, v[32:35] offset:58368
    ds_write_b128 v11, v[36:39] offset:58384
    s_not_b32 s35, s40
    s_and_b32 s35, s35, 0x7ff
    s_lshl_b32 s35, s35, 11
    s_add_u32 s35, s35, s32
    s_cmp_eq_u32 s40, s41
    s_cbranch_scc1 tail_nost
    buffer_store_dword v73, v10, s[48:51], s35 offen

tail_nost:
    s_cmp_lg_u32 s65, 0
    s_cbranch_scc1 tail_redlead
    s_waitcnt lgkmcnt(0)

tail_gemv:
    s_barrier
    ds_read_b128 v[160:163], v12 offset:58368
    ds_read_b128 v[164:167], v12 offset:58432
    ds_read_b128 v[168:171], v12 offset:58496
    ds_read_b128 v[172:175], v12 offset:58560
    ds_read_b128 v[176:179], v12 offset:58624
    ds_read_b128 v[180:183], v12 offset:58688
    ds_read_b128 v[184:187], v12 offset:58752
    ds_read_b128 v[188:191], v12 offset:58816
    s_waitcnt lgkmcnt(7)
    v_mfma_f32_16x16x32_bf16 v[192:195], v[160:163], v[96:99], 0
    v_mfma_f32_16x16x32_bf16 v[196:199], v[160:163], v[128:131], 0
    s_waitcnt lgkmcnt(6)
    v_mfma_f32_16x16x32_bf16 v[192:195], v[164:167], v[100:103], v[192:195]
    v_mfma_f32_16x16x32_bf16 v[196:199], v[164:167], v[132:135], v[196:199]
    s_waitcnt lgkmcnt(5)
    v_mfma_f32_16x16x32_bf16 v[192:195], v[168:171], v[104:107], v[192:195]
    v_mfma_f32_16x16x32_bf16 v[196:199], v[168:171], v[136:139], v[196:199]
    s_waitcnt lgkmcnt(4)
    v_mfma_f32_16x16x32_bf16 v[192:195], v[172:175], v[108:111], v[192:195]
    v_mfma_f32_16x16x32_bf16 v[196:199], v[172:175], v[140:143], v[196:199]
    s_waitcnt lgkmcnt(3)
    v_mfma_f32_16x16x32_bf16 v[192:195], v[176:179], v[112:115], v[192:195]
    v_mfma_f32_16x16x32_bf16 v[196:199], v[176:179], v[144:147], v[196:199]
    s_waitcnt lgkmcnt(2)
    v_mfma_f32_16x16x32_bf16 v[192:195], v[180:183], v[116:119], v[192:195]
    v_mfma_f32_16x16x32_bf16 v[196:199], v[180:183], v[148:151], v[196:199]
    s_waitcnt lgkmcnt(1)
    v_mfma_f32_16x16x32_bf16 v[192:195], v[184:187], v[120:123], v[192:195]
    v_mfma_f32_16x16x32_bf16 v[196:199], v[184:187], v[152:155], v[196:199]
    s_waitcnt lgkmcnt(0)
    v_mfma_f32_16x16x32_bf16 v[192:195], v[188:191], v[124:127], v[192:195]
    v_mfma_f32_16x16x32_bf16 v[196:199], v[188:191], v[156:159], v[196:199]
    s_lshl_b32 s35, s19, 7
    v_lshl_add_u32 v4, v2, 3, s35
    s_nop 7
    v_mov_b32 v193, v196
    s_mov_b64 exec, 0xffff
    ds_write_b64 v4, v[192:193] offset:60416
    s_mov_b64 exec, -1
    s_waitcnt lgkmcnt(0)

tail_down:
    v_and_b32 v4, 3, v2
    v_lshrrev_b32 v5, 4, v2
    v_lshl_add_u32 v4, v4, 2, v5
    v_lshlrev_b32 v4, 3, v4
    v_and_b32 v5, 15, v2
    v_and_b32 v6, 1, v2
    v_cmp_eq_u32 vcc, 0, v6
    v_mov_b32 v6, 0xffff0000
    v_mov_b32 v7, 0xffff
    v_cndmask_b32 v6, v6, v7, vcc
    v_lshrrev_b32 v5, 1, v5

    v_cmp_eq_u32 vcc, 0, v5
    s_nop 1
    v_cndmask_b32 v200, 0, v6, vcc
    v_cmp_eq_u32 vcc, 1, v5
    s_nop 1
    v_cndmask_b32 v201, 0, v6, vcc
    v_cmp_eq_u32 vcc, 2, v5
    s_nop 1
    v_cndmask_b32 v202, 0, v6, vcc
    v_cmp_eq_u32 vcc, 3, v5
    s_nop 1
    v_cndmask_b32 v203, 0, v6, vcc
    s_lshl_b32 s35, s64, 12
    s_lshl_b32 s36, s18, 9
    s_add_u32 s35, s35, s36
    s_add_u32 s35, s35, 26214400
    v_and_b32 v5, 15, v2
    v_lshrrev_b32 v6, 4, v2
    v_lshlrev_b32 v5, 5, v5
    v_lshl_add_u32 v5, v6, 4, v5
    s_mov_b32 s39, -2
    s_barrier

    ds_read_b64 v[64:65], v4 offset:60416
    ds_read_b64 v[66:67], v4 offset:60544
    ds_read_b64 v[68:69], v4 offset:60672
    ds_read_b64 v[70:71], v4 offset:60800
    s_waitcnt lgkmcnt(0)
    v_pk_add_f32 v[64:65], v[64:65], v[66:67]
    v_pk_add_f32 v[68:69], v[68:69], v[70:71]
    v_pk_add_f32 v[64:65], v[64:65], v[68:69]

    v_cvt_pk_bf16_f32 v66, v64, v65
    v_lshlrev_b32 v64, 16, v66
    v_and_b32 v65, 0xffff0000, v66
    v_mul_f32 v66, 0xbfb8aa3b, v64
    v_exp_f32 v66, v66
    s_nop 0
    v_add_f32 v66, 1.0, v66
    v_rcp_f32 v66, v66
    s_nop 0
    v_mul_f32 v64, v64, v66

    v_cvt_pk_bf16_f32 v64, v64, v64
    v_lshlrev_b32 v64, 16, v64
    v_mul_f32 v64, v64, v65
    v_cvt_pk_bf16_f32 v64, v64, v64
    s_nop 1

    v_and_b32_dpp v208, v64, v200 quad_perm:[0,0,0,0] row_mask:0xf bank_mask:0xf
    v_and_b32_dpp v209, v64, v201 quad_perm:[0,0,0,0] row_mask:0xf bank_mask:0xf
    v_and_b32_dpp v210, v64, v202 quad_perm:[0,0,0,0] row_mask:0xf bank_mask:0xf
    v_and_b32_dpp v211, v64, v203 quad_perm:[0,0,0,0] row_mask:0xf bank_mask:0xf
    v_and_b32_dpp v212, v64, v200 quad_perm:[1,1,1,1] row_mask:0xf bank_mask:0xf
    v_and_b32_dpp v213, v64, v201 quad_perm:[1,1,1,1] row_mask:0xf bank_mask:0xf
    v_and_b32_dpp v214, v64, v202 quad_perm:[1,1,1,1] row_mask:0xf bank_mask:0xf
    v_and_b32_dpp v215, v64, v203 quad_perm:[1,1,1,1] row_mask:0xf bank_mask:0xf
    v_and_b32_dpp v216, v64, v200 quad_perm:[2,2,2,2] row_mask:0xf bank_mask:0xf
    v_and_b32_dpp v217, v64, v201 quad_perm:[2,2,2,2] row_mask:0xf bank_mask:0xf
    v_and_b32_dpp v218, v64, v202 quad_perm:[2,2,2,2] row_mask:0xf bank_mask:0xf
    v_and_b32_dpp v219, v64, v203 quad_perm:[2,2,2,2] row_mask:0xf bank_mask:0xf
    v_and_b32_dpp v220, v64, v200 quad_perm:[3,3,3,3] row_mask:0xf bank_mask:0xf
    v_and_b32_dpp v221, v64, v201 quad_perm:[3,3,3,3] row_mask:0xf bank_mask:0xf
    v_and_b32_dpp v222, v64, v202 quad_perm:[3,3,3,3] row_mask:0xf bank_mask:0xf
    v_and_b32_dpp v223, v64, v203 quad_perm:[3,3,3,3] row_mask:0xf bank_mask:0xf
    s_nop 1
    v_mfma_f32_16x16x32_bf16 v[204:207], v[208:211], v[232:235], 0
    v_mfma_f32_16x16x32_bf16 v[204:207], v[212:215], v[236:239], v[204:207]
    v_mfma_f32_16x16x32_bf16 v[204:207], v[216:219], v[240:243], v[204:207]
    v_mfma_f32_16x16x32_bf16 v[204:207], v[220:223], v[244:247], v[204:207]
    s_mov_b32 exec_hi, 0
    s_nop 7
    s_nop 1
    v_min_u32 v204, s39, v204
    v_min_u32 v205, s39, v205
    v_min_u32 v206, s39, v206
    v_min_u32 v207, s39, v207
    buffer_store_dwordx4 v[204:207], v5, s[12:15], s35 offen sc1
    s_endpgm
tail_red:
    s_sub_u32 s35, s21, 28
    s_lshl_b32 s35, s35, 3
    s_add_u32 s35, s35, s20
    s_lshl_b32 s35, s35, 7
    s_lshl_b32 s36, s19, 17
    s_add_u32 s35, s35, s36
    s_add_u32 s35, s35, 26214400
    s_add_u32 s36, s35, 32768
    s_add_u32 s37, s35, 65536
    s_add_u32 s38, s35, 98304
    v_lshrrev_b32 v4, 3, v2
    v_and_b32 v5, 7, v2
    v_lshlrev_b32 v5, 4, v5
    v_lshl_add_u32 v4, v4, 12, v5
    s_lshl_b32 s39, s19, 7
    v_add_u32 v5, s39, v5

tail_poll4:
    buffer_load_dwordx4 v[64:67], v4, s[12:15], s35 offen sc1
    buffer_load_dwordx4 v[68:71], v4, s[12:15], s36 offen sc1
    buffer_load_dwordx4 v[72:75], v4, s[12:15], s37 offen sc1
    buffer_load_dwordx4 v[76:79], v4, s[12:15], s38 offen sc1
    s_waitcnt vmcnt(0)
    v_max3_u32 v6, v64, v65, v66
    v_max3_u32 v7, v67, v68, v69
    v_max3_u32 v6, v6, v70, v71
    v_max3_u32 v7, v7, v72, v73
    v_max3_u32 v6, v6, v74, v75
    v_max3_u32 v7, v7, v76, v77
    v_max3_u32 v6, v6, v78, v79
    v_max_u32 v6, v6, v7
    v_cmp_eq_u32 vcc, -1, v6
    s_sub_u32 s70, s70, 1
    s_cbranch_scc1 tail_poll4x
    s_cbranch_vccnz tail_poll4
    tail_poll4x:

    v_pk_add_f32 v[64:65], v[64:65], v[68:69]
    v_pk_add_f32 v[66:67], v[66:67], v[70:71]
    v_pk_add_f32 v[72:73], v[72:73], v[76:77]
    v_pk_add_f32 v[74:75], v[74:75], v[78:79]
    v_pk_add_f32 v[64:65], v[64:65], v[72:73]
    v_pk_add_f32 v[66:67], v[66:67], v[74:75]
    s_nop 1
    v_add_f32_dpp v68, v64, v64 row_ror:8 row_mask:0xf bank_mask:0xf
    v_add_f32_dpp v69, v65, v65 row_ror:8 row_mask:0xf bank_mask:0xf
    v_add_f32_dpp v70, v66, v66 row_ror:8 row_mask:0xf bank_mask:0xf
    v_add_f32_dpp v71, v67, v67 row_ror:8 row_mask:0xf bank_mask:0xf
    v_mov_b32 v64, v68
    v_mov_b32 v65, v69
    v_mov_b32 v66, v70
    v_mov_b32 v67, v71
    s_nop 1
    v_permlane16_swap_b32 v64, v68
    v_permlane16_swap_b32 v65, v69
    v_permlane16_swap_b32 v66, v70
    v_permlane16_swap_b32 v67, v71
    v_add_f32 v64, v64, v68
    v_add_f32 v65, v65, v69
    v_add_f32 v66, v66, v70
    v_add_f32 v67, v67, v71
    v_mov_b32 v68, v64
    v_mov_b32 v69, v65
    v_mov_b32 v70, v66
    v_mov_b32 v71, v67
    s_nop 1
    v_permlane32_swap_b32 v64, v68
    v_permlane32_swap_b32 v65, v69
    v_permlane32_swap_b32 v66, v70
    v_permlane32_swap_b32 v67, v71
    v_add_f32 v64, v64, v68
    v_add_f32 v65, v65, v69
    v_add_f32 v66, v66, v70
    v_add_f32 v67, v67, v71
    s_mov_b64 exec, 0xff
    ds_write_b128 v5, v[64:67] offset:60928
    s_mov_b64 exec, -1
    s_waitcnt lgkmcnt(0)
    s_barrier

    s_endpgm
tail_redlead:
    s_sub_u32 s35, s21, 28
    s_lshl_b32 s35, s35, 3
    s_add_u32 s35, s35, s20
    s_lshl_b32 s35, s35, 6
    s_add_u32 s36, s35, s43
    s_add_u32 s37, s35, 10240
    v_and_b32 v4, 63, v10
    buffer_load_dword v76, v4, s[12:15], s37 offen

tail_poll5:
    buffer_load_dword v74, v4, s[12:15], s36 offen sc1
    buffer_load_dword v75, v4, s[12:15], s36 offen offset:2048 sc1
    s_waitcnt vmcnt(0)
    v_max_u32 v5, v74, v75
    v_cmp_eq_u32 vcc, -1, v5
    s_sub_u32 s70, s70, 1
    s_cbranch_scc1 tail_poll5x
    s_cbranch_vccnz tail_poll5
    tail_poll5x:

    v_lshlrev_b32 v64, 16, v32
    v_and_b32 v65, 0xffff0000, v32
    v_lshlrev_b32 v66, 16, v20
    v_and_b32 v67, 0xffff0000, v20
    v_mul_f32 v6, v64, v66
    v_fmac_f32 v6, v65, v67
    v_lshlrev_b32 v64, 16, v33
    v_and_b32 v65, 0xffff0000, v33
    v_lshlrev_b32 v66, 16, v21
    v_and_b32 v67, 0xffff0000, v21
    v_fmac_f32 v6, v64, v66
    v_fmac_f32 v6, v65, v67
    v_lshlrev_b32 v64, 16, v34
    v_and_b32 v65, 0xffff0000, v34
    v_lshlrev_b32 v66, 16, v22
    v_and_b32 v67, 0xffff0000, v22
    v_fmac_f32 v6, v64, v66
    v_fmac_f32 v6, v65, v67
    v_lshlrev_b32 v64, 16, v35
    v_and_b32 v65, 0xffff0000, v35
    v_lshlrev_b32 v66, 16, v23
    v_and_b32 v67, 0xffff0000, v23
    v_fmac_f32 v6, v64, v66
    v_fmac_f32 v6, v65, v67
    v_lshlrev_b32 v64, 16, v36
    v_and_b32 v65, 0xffff0000, v36
    v_lshlrev_b32 v66, 16, v24
    v_and_b32 v67, 0xffff0000, v24
    v_fmac_f32 v6, v64, v66
    v_fmac_f32 v6, v65, v67
    v_lshlrev_b32 v64, 16, v37
    v_and_b32 v65, 0xffff0000, v37
    v_lshlrev_b32 v66, 16, v25
    v_and_b32 v67, 0xffff0000, v25
    v_fmac_f32 v6, v64, v66
    v_fmac_f32 v6, v65, v67
    v_lshlrev_b32 v64, 16, v38
    v_and_b32 v65, 0xffff0000, v38
    v_lshlrev_b32 v66, 16, v26
    v_and_b32 v67, 0xffff0000, v26
    v_fmac_f32 v6, v64, v66
    v_fmac_f32 v6, v65, v67
    v_lshlrev_b32 v64, 16, v39
    v_and_b32 v65, 0xffff0000, v39
    v_lshlrev_b32 v66, 16, v27
    v_and_b32 v67, 0xffff0000, v27
    v_fmac_f32 v6, v64, v66
    v_fmac_f32 v6, v65, v67
    s_nop 1
    v_add_f32_dpp v7, v6, v6 quad_perm:[1,0,3,2] row_mask:0xf bank_mask:0xf
    s_nop 1
    v_add_f32_dpp v6, v7, v7 quad_perm:[2,3,0,1] row_mask:0xf bank_mask:0xf
    s_nop 1
    v_add_f32_dpp v7, v6, v6 row_half_mirror row_mask:0xf bank_mask:0xf
    s_nop 1
    v_add_f32_dpp v6, v7, v7 row_mirror row_mask:0xf bank_mask:0xf
    s_nop 0
    v_mov_b32 v7, v6
    s_nop 1
    v_permlane16_swap_b32 v6, v7
    s_nop 0
    v_add_f32 v6, v6, v7
    v_mov_b32 v7, v6
    s_nop 1
    v_permlane32_swap_b32 v6, v7
    s_nop 0
    v_add_f32 v6, v6, v7

    v_cvt_pk_bf16_f32 v6, v6, v6
    v_lshlrev_b32 v6, 16, v6
    v_mul_f32 v7, 0xbfb8aa3b, v6
    v_exp_f32 v7, v7
    s_nop 0
    v_add_f32 v7, 1.0, v7
    v_rcp_f32 v7, v7
    s_nop 0

    v_cvt_pk_bf16_f32 v7, v7, v7
    v_lshlrev_b32 v7, 16, v7
    v_lshlrev_b32 v64, 16, v74
    v_and_b32 v65, 0xffff0000, v74
    v_lshlrev_b32 v66, 16, v75
    v_and_b32 v67, 0xffff0000, v75
    v_lshlrev_b32 v68, 16, v76
    v_and_b32 v69, 0xffff0000, v76
    v_lshlrev_b32 v5, 1, v4
    s_lshl_b32 s36, s42, 11
    s_add_u32 s36, s36, s35
    s_barrier

    ds_read_b64 v[32:33], v5 offset:60928
    ds_read_b64 v[34:35], v5 offset:61056
    ds_read_b64 v[36:37], v5 offset:61184
    ds_read_b64 v[38:39], v5 offset:61312
    ds_read_b64 v[40:41], v5 offset:61440
    ds_read_b64 v[42:43], v5 offset:61568
    ds_read_b64 v[44:45], v5 offset:61696
    s_waitcnt lgkmcnt(0)
    v_pk_add_f32 v[32:33], v[32:33], v[34:35]
    v_pk_add_f32 v[36:37], v[36:37], v[38:39]
    v_pk_add_f32 v[40:41], v[40:41], v[42:43]
    v_pk_add_f32 v[32:33], v[32:33], v[36:37]
    v_pk_add_f32 v[40:41], v[40:41], v[44:45]
    v_pk_add_f32 v[32:33], v[32:33], v[40:41]
    v_cvt_pk_bf16_f32 v34, v32, v33
    v_lshlrev_b32 v32, 16, v34
    v_and_b32 v33, 0xffff0000, v34
    v_mul_f32 v32, v32, v7
    v_mul_f32 v33, v33, v7
    v_cvt_pk_bf16_f32 v34, v32, v33
    v_lshlrev_b32 v32, 16, v34
    v_and_b32 v33, 0xffff0000, v34
    v_pk_add_f32 v[32:33], v[32:33], v[64:65]
    v_cvt_pk_bf16_f32 v34, v32, v33
    v_lshlrev_b32 v32, 16, v34
    v_and_b32 v33, 0xffff0000, v34
    v_pk_mul_f32 v[32:33], v[32:33], v[68:69]
    v_cvt_pk_bf16_f32 v34, v32, v33
    v_lshlrev_b32 v32, 16, v34
    v_and_b32 v33, 0xffff0000, v34
    v_pk_add_f32 v[32:33], v[32:33], v[66:67]
    v_cvt_pk_bf16_f32 v32, v32, v33
    s_mov_b64 exec, 0xffff
    buffer_store_dword v32, v4, s[48:51], s36 offen

tail_kernel_end:
    s_endpgm
    s_endpgm
fa_safe:
    s_add_u32 s27, s23, 13631488
    s_add_u32 s28, s23, 9437184
    s_mov_b32 s33, 0
    v_mov_b32 v96, 0xff7fffff
    v_mov_b32 v97, 0xff7fffff

    v_mov_b32 v104, 0
    v_mov_b32 v105, 0
    v_mov_b32 v106, 0
    v_mov_b32 v107, 0
    v_mov_b32 v108, 0
    v_mov_b32 v109, 0
    v_mov_b32 v110, 0
    v_mov_b32 v111, 0
    v_mov_b32 v112, 0
    v_mov_b32 v113, 0
    v_mov_b32 v114, 0
    v_mov_b32 v115, 0
    v_mov_b32 v116, 0
    v_mov_b32 v117, 0
    v_mov_b32 v118, 0
    v_mov_b32 v119, 0
    v_mov_b32 v136, 0
    v_mov_b32 v137, 0
    v_mov_b32 v138, 0
    v_mov_b32 v139, 0
    v_mov_b32 v120, 0
    v_mov_b32 v121, 0
    v_mov_b32 v122, 0
    v_mov_b32 v123, 0
    v_mov_b32 v124, 0
    v_mov_b32 v125, 0
    v_mov_b32 v126, 0
    v_mov_b32 v127, 0
    v_mov_b32 v128, 0
    v_mov_b32 v129, 0
    v_mov_b32 v130, 0
    v_mov_b32 v131, 0
    v_mov_b32 v132, 0
    v_mov_b32 v133, 0
    v_mov_b32 v134, 0
    v_mov_b32 v135, 0
    v_mov_b32 v140, 0
    v_mov_b32 v141, 0
    v_mov_b32 v142, 0
    v_mov_b32 v143, 0
fa_safe_loop:
    buffer_load_dwordx4 v[148:151], v5, s[12:15], s28 offen sc1
    buffer_load_dwordx4 v[152:155], v5, s[12:15], s28 offen offset:1024 sc1
    buffer_load_dwordx4 v[164:167], v5, s[12:15], s27 offen sc1
    buffer_load_dwordx4 v[168:171], v5, s[12:15], s27 offen offset:1024 sc1
    s_add_u32 s28, s28, 2048
    s_add_u32 s27, s27, 2048
    s_waitcnt vmcnt(0)

    v_mfma_f32_32x32x16_bf16 v[56:71], v[148:151], v[8:11], 0
    v_mfma_f32_32x32x16_bf16 v[56:71], v[152:155], v[12:15], v[56:71]
    s_nop 15
    s_nop 3

    v_max3_f32 v99, v56, v57, v58
    v_max3_f32 v99, v99, v59, v60
    v_max3_f32 v99, v99, v61, v62
    v_max3_f32 v99, v99, v63, v64
    v_max3_f32 v99, v99, v65, v66
    v_max3_f32 v99, v99, v67, v68
    v_max3_f32 v99, v99, v69, v70
    v_max_f32 v99, v99, v71
    v_mov_b32 v100, v99
    s_nop 1
    v_permlane32_swap_b32 v99, v100
    s_nop 0
    v_max_f32 v99, v99, v100
    v_max_f32 v99, v99, v96
    v_sub_f32 v98, v96, v99
    v_exp_f32 v98, v98
    v_mov_b32 v96, v99

    v_sub_f32 v56, v56, v99
    v_sub_f32 v57, v57, v99
    v_sub_f32 v58, v58, v99
    v_sub_f32 v59, v59, v99
    v_sub_f32 v60, v60, v99
    v_sub_f32 v61, v61, v99
    v_sub_f32 v62, v62, v99
    v_sub_f32 v63, v63, v99
    v_sub_f32 v64, v64, v99
    v_sub_f32 v65, v65, v99
    v_sub_f32 v66, v66, v99
    v_sub_f32 v67, v67, v99
    v_sub_f32 v68, v68, v99
    v_sub_f32 v69, v69, v99
    v_sub_f32 v70, v70, v99
    v_sub_f32 v71, v71, v99
    v_exp_f32 v56, v56
    v_exp_f32 v57, v57
    v_exp_f32 v58, v58
    v_exp_f32 v59, v59
    v_exp_f32 v60, v60
    v_exp_f32 v61, v61
    v_exp_f32 v62, v62
    v_exp_f32 v63, v63
    v_exp_f32 v64, v64
    v_exp_f32 v65, v65
    v_exp_f32 v66, v66
    v_exp_f32 v67, v67
    v_exp_f32 v68, v68
    v_exp_f32 v69, v69
    v_exp_f32 v70, v70
    v_exp_f32 v71, v71
    v_mul_f32 v104, v104, v98
    v_mul_f32 v105, v105, v98
    v_mul_f32 v106, v106, v98
    v_mul_f32 v107, v107, v98
    v_mul_f32 v108, v108, v98
    v_mul_f32 v109, v109, v98
    v_mul_f32 v110, v110, v98
    v_mul_f32 v111, v111, v98
    v_mul_f32 v112, v112, v98
    v_mul_f32 v113, v113, v98
    v_mul_f32 v114, v114, v98
    v_mul_f32 v115, v115, v98
    v_mul_f32 v116, v116, v98
    v_mul_f32 v117, v117, v98
    v_mul_f32 v118, v118, v98
    v_mul_f32 v119, v119, v98
    v_mul_f32 v136, v136, v98
    v_mul_f32 v137, v137, v98
    v_mul_f32 v138, v138, v98
    v_mul_f32 v139, v139, v98
    v_cvt_pk_bf16_f32 v88, v56, v57
    v_cvt_pk_bf16_f32 v89, v58, v59
    v_cvt_pk_bf16_f32 v90, v60, v61
    v_cvt_pk_bf16_f32 v91, v62, v63
    v_cvt_pk_bf16_f32 v92, v64, v65
    v_cvt_pk_bf16_f32 v93, v66, v67
    v_cvt_pk_bf16_f32 v94, v68, v69
    v_cvt_pk_bf16_f32 v95, v70, v71
    s_nop 1
    v_mfma_f32_32x32x16_bf16 v[104:119], v[164:167], v[88:91], v[104:119]
    v_mfma_f32_32x32x16_bf16 v[104:119], v[168:171], v[92:95], v[104:119]
    v_smfmac_f32_16x16x64_bf16 v[136:139], v[144:147], v[88:95], v7
    s_nop 15
    s_nop 3
    v_mfma_f32_32x32x16_bf16 v[56:71], v[148:151], v[16:19], 0
    v_mfma_f32_32x32x16_bf16 v[56:71], v[152:155], v[20:23], v[56:71]
    s_nop 15
    s_nop 3

    v_max3_f32 v99, v56, v57, v58
    v_max3_f32 v99, v99, v59, v60
    v_max3_f32 v99, v99, v61, v62
    v_max3_f32 v99, v99, v63, v64
    v_max3_f32 v99, v99, v65, v66
    v_max3_f32 v99, v99, v67, v68
    v_max3_f32 v99, v99, v69, v70
    v_max_f32 v99, v99, v71
    v_mov_b32 v100, v99
    s_nop 1
    v_permlane32_swap_b32 v99, v100
    s_nop 0
    v_max_f32 v99, v99, v100
    v_max_f32 v99, v99, v97
    v_sub_f32 v98, v97, v99
    v_exp_f32 v98, v98
    v_mov_b32 v97, v99

    v_sub_f32 v56, v56, v99
    v_sub_f32 v57, v57, v99
    v_sub_f32 v58, v58, v99
    v_sub_f32 v59, v59, v99
    v_sub_f32 v60, v60, v99
    v_sub_f32 v61, v61, v99
    v_sub_f32 v62, v62, v99
    v_sub_f32 v63, v63, v99
    v_sub_f32 v64, v64, v99
    v_sub_f32 v65, v65, v99
    v_sub_f32 v66, v66, v99
    v_sub_f32 v67, v67, v99
    v_sub_f32 v68, v68, v99
    v_sub_f32 v69, v69, v99
    v_sub_f32 v70, v70, v99
    v_sub_f32 v71, v71, v99
    v_exp_f32 v56, v56
    v_exp_f32 v57, v57
    v_exp_f32 v58, v58
    v_exp_f32 v59, v59
    v_exp_f32 v60, v60
    v_exp_f32 v61, v61
    v_exp_f32 v62, v62
    v_exp_f32 v63, v63
    v_exp_f32 v64, v64
    v_exp_f32 v65, v65
    v_exp_f32 v66, v66
    v_exp_f32 v67, v67
    v_exp_f32 v68, v68
    v_exp_f32 v69, v69
    v_exp_f32 v70, v70
    v_exp_f32 v71, v71
    v_mul_f32 v120, v120, v98
    v_mul_f32 v121, v121, v98
    v_mul_f32 v122, v122, v98
    v_mul_f32 v123, v123, v98
    v_mul_f32 v124, v124, v98
    v_mul_f32 v125, v125, v98
    v_mul_f32 v126, v126, v98
    v_mul_f32 v127, v127, v98
    v_mul_f32 v128, v128, v98
    v_mul_f32 v129, v129, v98
    v_mul_f32 v130, v130, v98
    v_mul_f32 v131, v131, v98
    v_mul_f32 v132, v132, v98
    v_mul_f32 v133, v133, v98
    v_mul_f32 v134, v134, v98
    v_mul_f32 v135, v135, v98
    v_mul_f32 v140, v140, v98
    v_mul_f32 v141, v141, v98
    v_mul_f32 v142, v142, v98
    v_mul_f32 v143, v143, v98
    v_cvt_pk_bf16_f32 v88, v56, v57
    v_cvt_pk_bf16_f32 v89, v58, v59
    v_cvt_pk_bf16_f32 v90, v60, v61
    v_cvt_pk_bf16_f32 v91, v62, v63
    v_cvt_pk_bf16_f32 v92, v64, v65
    v_cvt_pk_bf16_f32 v93, v66, v67
    v_cvt_pk_bf16_f32 v94, v68, v69
    v_cvt_pk_bf16_f32 v95, v70, v71
    s_nop 1
    v_mfma_f32_32x32x16_bf16 v[120:135], v[164:167], v[88:91], v[120:135]
    v_mfma_f32_32x32x16_bf16 v[120:135], v[168:171], v[92:95], v[120:135]
    v_smfmac_f32_16x16x64_bf16 v[140:143], v[144:147], v[88:95], v7
    s_nop 15
    s_nop 3
    s_add_u32 s33, s33, 1
    s_cmp_lt_u32 s33, 64
    s_cbranch_scc1 fa_safe_loop
    v_add_f32 v136, v136, v138
    v_add_f32 v140, v140, v142
    s_branch fa_fin

fr_helper:
    s_mov_b32 s48, s36
    s_and_b32 s49, s37, 0xffff
    s_mov_b32 s50, 4194304
    s_mov_b32 s51, 0x00020000
    s_sub_u32 s19, s18, 4
    s_cmp_eq_u32 s19, 0
    s_cbranch_scc1 fr_hn
    s_add_u32 s32, s19, 2

    s_cmp_ge_u32 s32, 3
    s_cselect_b32 s34, 1, 0
    s_mul_i32 s33, s34, 3
    s_sub_u32 s32, s32, s33
    s_mul_i32 s33, s21, 196608
    s_lshl_b32 s35, s32, 11
    s_add_u32 s33, s33, s35
    s_lshl_b32 s35, s20, 8
    s_add_u32 s33, s33, s35
    s_lshl_b32 s35, s34, 7
    s_add_u32 s33, s33, s35
    v_lshrrev_b32 v60, 3, v2
    s_mov_b32 s35, 6144
    v_mul_lo_u32 v62, v60, s35
    v_and_b32 v61, 7, v2
    v_lshl_add_u32 v62, v61, 4, v62

    buffer_load_dwordx4 v[64:67], v62, s[52:55], s33 offen
    s_add_u32 s33, s33, 49152
    buffer_load_dwordx4 v[68:71], v62, s[52:55], s33 offen
    s_add_u32 s33, s33, 49152
    buffer_load_dwordx4 v[72:75], v62, s[52:55], s33 offen
    s_add_u32 s33, s33, 49152
    buffer_load_dwordx4 v[76:79], v62, s[52:55], s33 offen
    s_branch fr_h0
fr_hn:
    s_mov_b32 s28, s8
    s_and_b32 s29, s9, 0xffff
    s_mov_b32 s30, 256
    s_mov_b32 s31, 0x00020000
    s_cmp_lg_u32 s2, 0
    s_cbranch_scc1 fr_nq
    s_or_b32 s56, s56, 1
    v_mov_b32 v8, s56
    v_mov_b32 v9, s57
    v_lshlrev_b32 v12, 6, v2
    s_mov_b64 exec, 15
    buffer_store_dwordx2 v[8:9], v12, s[28:31], 0 offen sc1
    fr_nq:
    s_mov_b64 exec, 1
    s_lshr_b32 s23, s2, 3
    s_and_b32 s23, s23, 3
    s_lshl_b32 s23, s23, 6
    s_sleep 8
    fr_np:
    s_sleep 4
    buffer_load_dwordx2 v[12:13], v10, s[28:31], s23 offen sc1
    s_lshl_b32 s25, s20, 12
    s_lshl_b32 s27, s21, 7
    s_add_u32 s27, s27, s25
    s_add_u32 s27, s27, 2818048
    s_waitcnt vmcnt(0)
    v_readfirstlane_b32 s22, v12
    s_cmp_lg_u32 s22, 0
    s_cbranch_scc1 fr_npx
    s_sub_u32 s70, s70, 1
    s_cbranch_scc0 fr_np
    fr_npx:
    ds_write_b64 v19, v[12:13] offset:8
    v_mov_b32 v8, v12
    v_xor_b32 v9, s71, v13
    buffer_store_dwordx2 v[8:9], v10, s[12:15], s27 offen sc1
    s_mov_b64 exec, -1
    s_waitcnt lgkmcnt(0)
    s_nop 0
    fr_h0:
    v_lshrrev_b32 v3, 3, v2
    v_lshrrev_b32 v4, 4, v2
    v_and_b32 v6, 7, v2
    v_xor_b32 v7, v6, v4
    v_lshlrev_b32 v7, 4, v7
    v_lshl_add_u32 v8, v3, 11, v7
    v_xor_b32 v9, 64, v8
    s_lshl_b32 s25, s17, 19
    s_lshl_b32 s26, s19, 17
    s_add_u32 s25, s25, s26
    s_lshl_b32 s27, s19, 13

    s_lshl_b32 s28, s16, 2
    s_add_u32 s28, s28, s19
    s_lshl_b32 s28, s28, 3
    s_add_u32 s28, s28, s17
    s_lshl_b32 s28, s28, 7
    s_add_u32 s28, s28, 3145728
    v_lshlrev_b32 v6, 3, v2
    s_mov_b64 exec, 0xffff
    buffer_store_dwordx2 v[10:11], v6, s[12:15], s28 offen

    s_mov_b64 exec, -1
    v_add_u32 v200, 0, v8
    v_add_u32 v201, 31744, v9
    v_add_u32 v202, 14336, v8
    v_add_u32 v203, 46080, v9
    v_add_u32 v204, 65536, v8
    v_add_u32 v205, 97280, v9
    v_add_u32 v206, 79872, v8
    v_add_u32 v207, 111616, v9
    s_lshl_b32 s40, s2, 3
    s_lshl_b32 s41, s19, 1
    s_add_u32 s40, s40, s41
    s_lshl_b32 s39, s40, 11

    s_add_u32 s28, s25, 0
    s_add_u32 m0, s27, 0
    s_nop 0
    buffer_load_dwordx4 v200, s[48:51], s28 offen offset:0 lds
    buffer_load_dwordx4 v201, s[48:51], s28 offen offset:1024 lds
    buffer_load_dwordx4 v202, s[48:51], s28 offen offset:2048 lds
    buffer_load_dwordx4 v203, s[48:51], s28 offen offset:3072 lds
    s_add_u32 m0, s27, 4096
    s_nop 0
    buffer_load_dwordx4 v204, s[48:51], s28 offen offset:0 lds
    buffer_load_dwordx4 v205, s[48:51], s28 offen offset:1024 lds
    buffer_load_dwordx4 v206, s[48:51], s28 offen offset:2048 lds
    buffer_load_dwordx4 v207, s[48:51], s28 offen offset:3072 lds
    s_add_u32 s28, s25, 128
    s_add_u32 m0, s27, 32768
    s_nop 0
    buffer_load_dwordx4 v200, s[48:51], s28 offen offset:0 lds
    buffer_load_dwordx4 v201, s[48:51], s28 offen offset:1024 lds
    buffer_load_dwordx4 v202, s[48:51], s28 offen offset:2048 lds
    buffer_load_dwordx4 v203, s[48:51], s28 offen offset:3072 lds
    s_add_u32 m0, s27, 36864
    s_nop 0
    buffer_load_dwordx4 v204, s[48:51], s28 offen offset:0 lds
    buffer_load_dwordx4 v205, s[48:51], s28 offen offset:1024 lds
    buffer_load_dwordx4 v206, s[48:51], s28 offen offset:2048 lds
    buffer_load_dwordx4 v207, s[48:51], s28 offen offset:3072 lds
    s_add_u32 s28, s25, 256
    s_add_u32 m0, s27, 65536
    s_nop 0
    buffer_load_dwordx4 v200, s[48:51], s28 offen offset:0 lds
    buffer_load_dwordx4 v201, s[48:51], s28 offen offset:1024 lds
    buffer_load_dwordx4 v202, s[48:51], s28 offen offset:2048 lds
    buffer_load_dwordx4 v203, s[48:51], s28 offen offset:3072 lds
    s_add_u32 m0, s27, 69632
    s_nop 0
    buffer_load_dwordx4 v204, s[48:51], s28 offen offset:0 lds
    buffer_load_dwordx4 v205, s[48:51], s28 offen offset:1024 lds
    buffer_load_dwordx4 v206, s[48:51], s28 offen offset:2048 lds
    buffer_load_dwordx4 v207, s[48:51], s28 offen offset:3072 lds
    buffer_load_dwordx4 v[208:211], v5, s[48:51], s39 offen offset:0
    buffer_load_dwordx4 v[212:215], v5, s[48:51], s39 offen offset:1024
    buffer_load_dwordx4 v[216:219], v5, s[48:51], s39 offen offset:2048
    buffer_load_dwordx4 v[220:223], v5, s[48:51], s39 offen offset:3072
    s_lshl_b32 s40, s40, 4
    s_add_u32 s40, s40, 2621440
    s_lshr_b32 s41, s25, 7
    s_add_u32 s41, s41, 2621440
    s_mul_i32 s22, s17, 12
    s_mul_i32 s23, s19, 3
    s_add_u32 s22, s22, s23
    v_and_b32 v6, 3, v2
    v_min_u32 v6, 2, v6
    v_add_u32 v6, s22, v6
    v_lshrrev_b32 v16, 5, v6
    v_lshlrev_b32 v16, 14, v16
    v_and_b32 v7, 31, v6
    v_lshl_add_u32 v16, v7, 4, v16
    v_lshrrev_b32 v7, 2, v2
    s_mov_b32 s23, 49152
    v_mul_lo_u32 v7, v7, s23
    v_add_u32 v16, v16, v7
    v_lshlrev_b32 v13, 4, v6
    s_lshl_b32 s42, s16, 9
    s_add_u32 s42, s42, 1048576
    s_add_u32 s43, s42, 786432
    s_mul_i32 s44, s16, 1536
    s_add_u32 s44, s44, 2883584
    s_mul_i32 s22, s19, 24
    v_min_u32 v12, 23, v2
    v_add_u32 v12, s22, v12
    v_lshlrev_b32 v18, 2, v12
    v_add_u32 v18, 150656, v18
    v_lshlrev_b32 v12, 4, v12
    v_and_b32 v17, 0x27, v2
    v_and_b32 v6, 8, v2
    v_lshl_or_b32 v17, v6, 1, v17
    v_and_b32 v6, 16, v2
    v_lshrrev_b32 v6, 1, v6
    v_or_b32 v17, v17, v6
    v_lshlrev_b32 v17, 4, v17
    s_mul_i32 s45, s19, 3072
    s_mul_i32 s26, s16, 196608
    s_add_u32 s26, s26, s45
    s_add_u32 s26, s26, 67108864
    s_add_u32 s45, s45, 98304
    s_lshl_b32 s22, s19, 10
    v_add_u32 v6, s22, v5
    v_add_u32 v6, 151552, v6
    s_lshl_b32 s22, s19, 8
    v_lshl_add_u32 v7, v2, 2, s22
    v_add_u32 v7, 147456, v7
    s_barrier
    s_waitcnt vmcnt(0)

    s_cmp_eq_u32 s19, 0
    s_cbranch_scc1 fr_hln

    s_lshl_b32 s33, s20, 1
    s_add_u32 s33, s33, s34
    s_lshl_b32 s66, s20, 12
    s_lshl_b32 s35, s21, 7
    s_add_u32 s66, s66, s35
    s_add_u32 s66, s66, 2752512
    s_lshl_b32 s67, s33, 10
    s_mul_i32 s35, s21, 49152
    s_add_u32 s67, s67, s35
    s_lshl_b32 s35, s32, 14
    s_add_u32 s67, s67, s35
    s_add_u32 s67, s67, 1048576
    s_mul_i32 s33, s33, 393216
    s_lshr_b32 s35, s21, 1
    s_mul_i32 s35, s35, 12288
    s_add_u32 s33, s33, s35
    s_lshl_b32 s35, s32, 12
    s_add_u32 s33, s33, s35
    s_and_b32 s35, s21, 1
    s_lshl_b32 s35, s35, 11
    s_add_u32 s33, s33, s35
    s_add_u32 s33, s33, 67108864
    v_lshrrev_b32 v62, 2, v61
    s_mov_b32 s35, 196608
    v_mul_lo_u32 v62, v62, s35
    v_lshl_add_u32 v62, v60, 6, v62
    v_and_b32 v63, 3, v61
    v_lshl_add_u32 v62, v63, 4, v62
    v_xor_b32 v63, 32, v62
    v_lshlrev_b32 v59, 7, v61
    v_lshl_add_u32 v59, v60, 4, v59
    v_lshlrev_b32 v58, 4, v60
    v_add_u32 v58, 149504, v58
    v_mov_b32 v57, 0
    v_and_b32 v56, 8, v2
    v_cmp_ne_u32 s[60:61], 0, v56

    v_lshlrev_b32 v80, 16, v64
    v_and_b32 v81, 0xffff0000, v64
    v_lshlrev_b32 v82, 16, v65
    v_and_b32 v83, 0xffff0000, v65
    v_lshlrev_b32 v84, 16, v66
    v_and_b32 v85, 0xffff0000, v66
    v_lshlrev_b32 v86, 16, v67
    v_and_b32 v87, 0xffff0000, v67
    v_lshlrev_b32 v88, 16, v68
    v_and_b32 v89, 0xffff0000, v68
    v_lshlrev_b32 v90, 16, v69
    v_and_b32 v91, 0xffff0000, v69
    v_lshlrev_b32 v92, 16, v70
    v_and_b32 v93, 0xffff0000, v70
    v_lshlrev_b32 v94, 16, v71
    v_and_b32 v95, 0xffff0000, v71
    v_lshlrev_b32 v96, 16, v72
    v_and_b32 v97, 0xffff0000, v72
    v_lshlrev_b32 v98, 16, v73
    v_and_b32 v99, 0xffff0000, v73
    v_lshlrev_b32 v100, 16, v74
    v_and_b32 v101, 0xffff0000, v74
    v_lshlrev_b32 v102, 16, v75
    v_and_b32 v103, 0xffff0000, v75
    v_lshlrev_b32 v104, 16, v76
    v_and_b32 v105, 0xffff0000, v76
    v_lshlrev_b32 v106, 16, v77
    v_and_b32 v107, 0xffff0000, v77
    v_lshlrev_b32 v108, 16, v78
    v_and_b32 v109, 0xffff0000, v78
    v_lshlrev_b32 v110, 16, v79
    v_and_b32 v111, 0xffff0000, v79
fr_h_w1:
    ds_read_b32 v56, v19 offset:0
    s_waitcnt lgkmcnt(0)
    v_readfirstlane_b32 s22, v56
    s_cmp_lg_u32 s22, 0
    s_cbranch_scc1 fr_h_w1_go
    s_sleep 1
    s_branch fr_h_w1

fr_h_w1_go:
    ds_read_b128 v[112:115], v58 offset:128
    ds_read_b128 v[116:119], v58
    ds_read_b64 v[146:147], v19 offset:8
    s_waitcnt lgkmcnt(2)

    s_cmp_eq_u32 s22, 2
    v_mul_f32 v136, v112, v80
    v_mul_f32 v137, v112, v81
    v_mul_f32 v138, v112, v82
    v_mul_f32 v139, v112, v83
    v_mul_f32 v140, v112, v84
    v_mul_f32 v141, v112, v85
    v_mul_f32 v142, v112, v86
    v_mul_f32 v143, v112, v87
    v_cvt_pk_bf16_f32 v64, v136, v137
    v_cvt_pk_bf16_f32 v65, v138, v139
    v_cvt_pk_bf16_f32 v66, v140, v141
    v_cvt_pk_bf16_f32 v67, v142, v143
    s_cbranch_scc1 fr_h_sa0
    buffer_store_dwordx4 v[64:67], v62, s[12:15], s33 offen offset:0
    fr_h_sa0:
    s_cbranch_scc0 fr_h_sb0
    buffer_store_dwordx4 v[64:67], v62, s[12:15], s33 offen offset:0 sc1
    fr_h_sb0:

    v_mul_f32 v136, v113, v88
    v_mul_f32 v137, v113, v89
    v_mul_f32 v138, v113, v90
    v_mul_f32 v139, v113, v91
    v_mul_f32 v140, v113, v92
    v_mul_f32 v141, v113, v93
    v_mul_f32 v142, v113, v94
    v_mul_f32 v143, v113, v95
    v_cvt_pk_bf16_f32 v68, v136, v137
    v_cvt_pk_bf16_f32 v69, v138, v139
    v_cvt_pk_bf16_f32 v70, v140, v141
    v_cvt_pk_bf16_f32 v71, v142, v143
    s_cbranch_scc1 fr_h_sa1
    buffer_store_dwordx4 v[68:71], v63, s[12:15], s33 offen offset:512
    fr_h_sa1:
    s_cbranch_scc0 fr_h_sb1
    buffer_store_dwordx4 v[68:71], v63, s[12:15], s33 offen offset:512 sc1
    fr_h_sb1:

    v_mul_f32 v136, v114, v96
    v_mul_f32 v137, v114, v97
    v_mul_f32 v138, v114, v98
    v_mul_f32 v139, v114, v99
    v_mul_f32 v140, v114, v100
    v_mul_f32 v141, v114, v101
    v_mul_f32 v142, v114, v102
    v_mul_f32 v143, v114, v103
    v_cvt_pk_bf16_f32 v72, v136, v137
    v_cvt_pk_bf16_f32 v73, v138, v139
    v_cvt_pk_bf16_f32 v74, v140, v141
    v_cvt_pk_bf16_f32 v75, v142, v143
    s_cbranch_scc1 fr_h_sa2
    buffer_store_dwordx4 v[72:75], v62, s[12:15], s33 offen offset:1024
    fr_h_sa2:
    s_cbranch_scc0 fr_h_sb2
    buffer_store_dwordx4 v[72:75], v62, s[12:15], s33 offen offset:1024 sc1
    fr_h_sb2:

    v_mul_f32 v136, v115, v104
    v_mul_f32 v137, v115, v105
    v_mul_f32 v138, v115, v106
    v_mul_f32 v139, v115, v107
    v_mul_f32 v140, v115, v108
    v_mul_f32 v141, v115, v109
    v_mul_f32 v142, v115, v110
    v_mul_f32 v143, v115, v111
    v_cvt_pk_bf16_f32 v76, v136, v137
    v_cvt_pk_bf16_f32 v77, v138, v139
    v_cvt_pk_bf16_f32 v78, v140, v141
    v_cvt_pk_bf16_f32 v79, v142, v143
    s_cbranch_scc1 fr_h_sa3
    buffer_store_dwordx4 v[76:79], v63, s[12:15], s33 offen offset:1536
    fr_h_sa3:
    s_cbranch_scc0 fr_h_sb3
    buffer_store_dwordx4 v[76:79], v63, s[12:15], s33 offen offset:1536 sc1
    fr_h_sb3:

    s_waitcnt lgkmcnt(0)

    v_mul_f32 v120, v116, v80
    v_mul_f32 v121, v116, v81
    v_mul_f32 v122, v116, v82
    v_mul_f32 v123, v116, v83
    v_mul_f32 v124, v116, v84
    v_mul_f32 v125, v116, v85
    v_mul_f32 v126, v116, v86
    v_mul_f32 v127, v116, v87
    v_fmac_f32 v120, v117, v88
    v_fmac_f32 v121, v117, v89
    v_fmac_f32 v122, v117, v90
    v_fmac_f32 v123, v117, v91
    v_fmac_f32 v124, v117, v92
    v_fmac_f32 v125, v117, v93
    v_fmac_f32 v126, v117, v94
    v_fmac_f32 v127, v117, v95
    v_fmac_f32 v120, v118, v96
    v_fmac_f32 v121, v118, v97
    v_fmac_f32 v122, v118, v98
    v_fmac_f32 v123, v118, v99
    v_fmac_f32 v124, v118, v100
    v_fmac_f32 v125, v118, v101
    v_fmac_f32 v126, v118, v102
    v_fmac_f32 v127, v118, v103
    v_fmac_f32 v120, v119, v104
    v_fmac_f32 v121, v119, v105
    v_fmac_f32 v122, v119, v106
    v_fmac_f32 v123, v119, v107
    v_fmac_f32 v124, v119, v108
    v_fmac_f32 v125, v119, v109
    v_fmac_f32 v126, v119, v110
    v_fmac_f32 v127, v119, v111
    v_mov_b32 v56, 1
    s_mov_b64 exec, 1
    s_waitcnt vmcnt(0)
    ds_add_rtn_u32 v58, v19, v56 offset:16
    s_waitcnt lgkmcnt(0)
    v_readfirstlane_b32 s23, v58
    s_cmp_lg_u32 s23, 5
    s_cbranch_scc1 fr_h_nf
    s_cmp_eq_u32 s22, 2
    s_cbranch_scc1 fr_h_fs
    buffer_store_dwordx2 v[146:147], v57, s[12:15], s66 offen
    s_branch fr_h_nf
    fr_h_fs:
    buffer_store_dwordx2 v[146:147], v57, s[12:15], s66 offen sc1
    fr_h_nf:
    s_mov_b64 exec, -1

    v_lshlrev_b32 v128, 16, v64
    v_and_b32 v129, 0xffff0000, v64
    v_lshlrev_b32 v130, 16, v65
    v_and_b32 v131, 0xffff0000, v65
    v_lshlrev_b32 v132, 16, v66
    v_and_b32 v133, 0xffff0000, v66
    v_lshlrev_b32 v134, 16, v67
    v_and_b32 v135, 0xffff0000, v67
    v_lshlrev_b32 v136, 16, v68
    v_and_b32 v137, 0xffff0000, v68
    v_lshlrev_b32 v138, 16, v69
    v_and_b32 v139, 0xffff0000, v69
    v_lshlrev_b32 v140, 16, v70
    v_and_b32 v141, 0xffff0000, v70
    v_lshlrev_b32 v142, 16, v71
    v_and_b32 v143, 0xffff0000, v71
    v_add_f32 v128, v128, v136
    v_add_f32 v129, v129, v137
    v_add_f32 v130, v130, v138
    v_add_f32 v131, v131, v139
    v_add_f32 v132, v132, v140
    v_add_f32 v133, v133, v141
    v_add_f32 v134, v134, v142
    v_add_f32 v135, v135, v143
    v_lshlrev_b32 v136, 16, v72
    v_and_b32 v137, 0xffff0000, v72
    v_lshlrev_b32 v138, 16, v73
    v_and_b32 v139, 0xffff0000, v73
    v_lshlrev_b32 v140, 16, v74
    v_and_b32 v141, 0xffff0000, v74
    v_lshlrev_b32 v142, 16, v75
    v_and_b32 v143, 0xffff0000, v75
    v_add_f32 v128, v128, v136
    v_add_f32 v129, v129, v137
    v_add_f32 v130, v130, v138
    v_add_f32 v131, v131, v139
    v_add_f32 v132, v132, v140
    v_add_f32 v133, v133, v141
    v_add_f32 v134, v134, v142
    v_add_f32 v135, v135, v143
    v_lshlrev_b32 v136, 16, v76
    v_and_b32 v137, 0xffff0000, v76
    v_lshlrev_b32 v138, 16, v77
    v_and_b32 v139, 0xffff0000, v77
    v_lshlrev_b32 v140, 16, v78
    v_and_b32 v141, 0xffff0000, v78
    v_lshlrev_b32 v142, 16, v79
    v_and_b32 v143, 0xffff0000, v79
    v_add_f32 v128, v128, v136
    v_add_f32 v129, v129, v137
    v_add_f32 v130, v130, v138
    v_add_f32 v131, v131, v139
    v_add_f32 v132, v132, v140
    v_add_f32 v133, v133, v141
    v_add_f32 v134, v134, v142
    v_add_f32 v135, v135, v143
    s_nop 0
    v_permlane32_swap_b32 v120, v124
    v_permlane32_swap_b32 v121, v125
    v_permlane32_swap_b32 v122, v126
    v_permlane32_swap_b32 v123, v127
    v_permlane32_swap_b32 v128, v132
    v_permlane32_swap_b32 v129, v133
    v_permlane32_swap_b32 v130, v134
    v_permlane32_swap_b32 v131, v135
    v_add_f32 v120, v120, v124
    v_add_f32 v121, v121, v125
    v_add_f32 v122, v122, v126
    v_add_f32 v123, v123, v127
    v_add_f32 v128, v128, v132
    v_add_f32 v129, v129, v133
    v_add_f32 v130, v130, v134
    v_add_f32 v131, v131, v135
    s_nop 0
    v_permlane16_swap_b32 v120, v122
    v_permlane16_swap_b32 v121, v123
    v_permlane16_swap_b32 v128, v130
    v_permlane16_swap_b32 v129, v131
    s_nop 0
    v_add_f32 v120, v120, v122
    v_add_f32 v121, v121, v123
    v_add_f32 v128, v128, v130
    v_add_f32 v129, v129, v131
    s_nop 0
    v_add_f32_dpp v136, v120, v120 row_ror:8 row_mask:0xf bank_mask:0xf
    v_add_f32_dpp v137, v121, v121 row_ror:8 row_mask:0xf bank_mask:0xf
    v_add_f32_dpp v138, v128, v128 row_ror:8 row_mask:0xf bank_mask:0xf
    v_add_f32_dpp v139, v129, v129 row_ror:8 row_mask:0xf bank_mask:0xf
    v_cndmask_b32 v144, v136, v137, s[60:61]
    v_cndmask_b32 v145, v138, v139, s[60:61]
    v_readfirstlane_b32 s72, v146
    v_readfirstlane_b32 s73, v147
    buffer_store_dwordx4 v[144:147], v59, s[12:15], s67 offen sc1

fr_hln:
    v_lshlrev_b32 v160, 16, v208
    v_and_b32 v161, 0xffff0000, v208
    v_lshlrev_b32 v162, 16, v209
    v_and_b32 v163, 0xffff0000, v209
    v_lshlrev_b32 v164, 16, v210
    v_and_b32 v165, 0xffff0000, v210
    v_lshlrev_b32 v166, 16, v211
    v_and_b32 v167, 0xffff0000, v211
    v_lshlrev_b32 v168, 16, v212
    v_and_b32 v169, 0xffff0000, v212
    v_lshlrev_b32 v170, 16, v213
    v_and_b32 v171, 0xffff0000, v213
    v_lshlrev_b32 v172, 16, v214
    v_and_b32 v173, 0xffff0000, v214
    v_lshlrev_b32 v174, 16, v215
    v_and_b32 v175, 0xffff0000, v215
    v_lshlrev_b32 v176, 16, v216
    v_and_b32 v177, 0xffff0000, v216
    v_lshlrev_b32 v178, 16, v217
    v_and_b32 v179, 0xffff0000, v217
    v_lshlrev_b32 v180, 16, v218
    v_and_b32 v181, 0xffff0000, v218
    v_lshlrev_b32 v182, 16, v219
    v_and_b32 v183, 0xffff0000, v219
    v_lshlrev_b32 v184, 16, v220
    v_and_b32 v185, 0xffff0000, v220
    v_lshlrev_b32 v186, 16, v221
    v_and_b32 v187, 0xffff0000, v221
    v_lshlrev_b32 v188, 16, v222
    v_and_b32 v189, 0xffff0000, v222
    v_lshlrev_b32 v190, 16, v223
    v_and_b32 v191, 0xffff0000, v223
    v_add_f32 v192, v160, v161
    v_add_f32 v194, v176, v177
    v_add_f32 v192, v192, v162
    v_add_f32 v194, v194, v178
    v_add_f32 v192, v192, v163
    v_add_f32 v194, v194, v179
    v_add_f32 v192, v192, v164
    v_add_f32 v194, v194, v180
    v_add_f32 v192, v192, v165
    v_add_f32 v194, v194, v181
    v_add_f32 v192, v192, v166
    v_add_f32 v194, v194, v182
    v_add_f32 v192, v192, v167
    v_add_f32 v194, v194, v183
    v_add_f32 v192, v192, v168
    v_add_f32 v194, v194, v184
    v_add_f32 v192, v192, v169
    v_add_f32 v194, v194, v185
    v_add_f32 v192, v192, v170
    v_add_f32 v194, v194, v186
    v_add_f32 v192, v192, v171
    v_add_f32 v194, v194, v187
    v_add_f32 v192, v192, v172
    v_add_f32 v194, v194, v188
    v_add_f32 v192, v192, v173
    v_add_f32 v194, v194, v189
    v_add_f32 v192, v192, v174
    v_add_f32 v194, v194, v190
    v_add_f32 v192, v192, v175
    v_add_f32 v194, v194, v191
    s_nop 0
    s_nop 0
    v_add_f32_dpp v193, v192, v192 quad_perm:[1,0,3,2] row_mask:0xf bank_mask:0xf
    v_add_f32_dpp v195, v194, v194 quad_perm:[1,0,3,2] row_mask:0xf bank_mask:0xf
    s_nop 0
    v_add_f32_dpp v192, v193, v193 quad_perm:[2,3,0,1] row_mask:0xf bank_mask:0xf
    v_add_f32_dpp v194, v195, v195 quad_perm:[2,3,0,1] row_mask:0xf bank_mask:0xf
    s_nop 0
    v_add_f32_dpp v193, v192, v192 row_half_mirror row_mask:0xf bank_mask:0xf
    v_add_f32_dpp v195, v194, v194 row_half_mirror row_mask:0xf bank_mask:0xf
    s_nop 0
    v_add_f32_dpp v192, v193, v193 row_mirror row_mask:0xf bank_mask:0xf
    v_add_f32_dpp v194, v195, v195 row_mirror row_mask:0xf bank_mask:0xf
    v_mov_b32 v193, v192
    v_mov_b32 v195, v194
    s_nop 0
    v_permlane16_swap_b32 v192, v193
    v_permlane16_swap_b32 v194, v195
    s_nop 0
    v_add_f32 v192, v192, v193
    v_add_f32 v194, v194, v195
    v_mov_b32 v193, v192
    v_mov_b32 v195, v194
    s_nop 0
    v_permlane32_swap_b32 v192, v193
    v_permlane32_swap_b32 v194, v195
    s_nop 0
    v_add_f32 v192, v192, v193
    v_add_f32 v194, v194, v195
    v_mul_f32 v196, 0x3a800000, v192
    v_mul_f32 v197, 0x3a800000, v194
    v_sub_f32 v160, v160, v196
    v_sub_f32 v176, v176, v197
    v_sub_f32 v161, v161, v196
    v_sub_f32 v177, v177, v197
    v_sub_f32 v162, v162, v196
    v_sub_f32 v178, v178, v197
    v_sub_f32 v163, v163, v196
    v_sub_f32 v179, v179, v197
    v_sub_f32 v164, v164, v196
    v_sub_f32 v180, v180, v197
    v_sub_f32 v165, v165, v196
    v_sub_f32 v181, v181, v197
    v_sub_f32 v166, v166, v196
    v_sub_f32 v182, v182, v197
    v_sub_f32 v167, v167, v196
    v_sub_f32 v183, v183, v197
    v_sub_f32 v168, v168, v196
    v_sub_f32 v184, v184, v197
    v_sub_f32 v169, v169, v196
    v_sub_f32 v185, v185, v197
    v_sub_f32 v170, v170, v196
    v_sub_f32 v186, v186, v197
    v_sub_f32 v171, v171, v196
    v_sub_f32 v187, v187, v197
    v_sub_f32 v172, v172, v196
    v_sub_f32 v188, v188, v197
    v_sub_f32 v173, v173, v196
    v_sub_f32 v189, v189, v197
    v_sub_f32 v174, v174, v196
    v_sub_f32 v190, v190, v197
    v_sub_f32 v175, v175, v196
    v_sub_f32 v191, v191, v197
    v_mul_f32 v192, v160, v160
    v_mul_f32 v194, v176, v176
    v_fmac_f32 v192, v161, v161
    v_fmac_f32 v194, v177, v177
    v_fmac_f32 v192, v162, v162
    v_fmac_f32 v194, v178, v178
    v_fmac_f32 v192, v163, v163
    v_fmac_f32 v194, v179, v179
    v_fmac_f32 v192, v164, v164
    v_fmac_f32 v194, v180, v180
    v_fmac_f32 v192, v165, v165
    v_fmac_f32 v194, v181, v181
    v_fmac_f32 v192, v166, v166
    v_fmac_f32 v194, v182, v182
    v_fmac_f32 v192, v167, v167
    v_fmac_f32 v194, v183, v183
    v_fmac_f32 v192, v168, v168
    v_fmac_f32 v194, v184, v184
    v_fmac_f32 v192, v169, v169
    v_fmac_f32 v194, v185, v185
    v_fmac_f32 v192, v170, v170
    v_fmac_f32 v194, v186, v186
    v_fmac_f32 v192, v171, v171
    v_fmac_f32 v194, v187, v187
    v_fmac_f32 v192, v172, v172
    v_fmac_f32 v194, v188, v188
    v_fmac_f32 v192, v173, v173
    v_fmac_f32 v194, v189, v189
    v_fmac_f32 v192, v174, v174
    v_fmac_f32 v194, v190, v190
    v_fmac_f32 v192, v175, v175
    v_fmac_f32 v194, v191, v191
    s_nop 0
    s_nop 0
    v_add_f32_dpp v193, v192, v192 quad_perm:[1,0,3,2] row_mask:0xf bank_mask:0xf
    v_add_f32_dpp v195, v194, v194 quad_perm:[1,0,3,2] row_mask:0xf bank_mask:0xf
    s_nop 0
    v_add_f32_dpp v192, v193, v193 quad_perm:[2,3,0,1] row_mask:0xf bank_mask:0xf
    v_add_f32_dpp v194, v195, v195 quad_perm:[2,3,0,1] row_mask:0xf bank_mask:0xf
    s_nop 0
    v_add_f32_dpp v193, v192, v192 row_half_mirror row_mask:0xf bank_mask:0xf
    v_add_f32_dpp v195, v194, v194 row_half_mirror row_mask:0xf bank_mask:0xf
    s_nop 0
    v_add_f32_dpp v192, v193, v193 row_mirror row_mask:0xf bank_mask:0xf
    v_add_f32_dpp v194, v195, v195 row_mirror row_mask:0xf bank_mask:0xf
    v_mov_b32 v193, v192
    v_mov_b32 v195, v194
    s_nop 0
    v_permlane16_swap_b32 v192, v193
    v_permlane16_swap_b32 v194, v195
    s_nop 0
    v_add_f32 v192, v192, v193
    v_add_f32 v194, v194, v195
    v_mov_b32 v193, v192
    v_mov_b32 v195, v194
    s_nop 0
    v_permlane32_swap_b32 v192, v193
    v_permlane32_swap_b32 v194, v195
    s_nop 0
    v_add_f32 v192, v192, v193
    v_add_f32 v194, v194, v195
    v_cmp_eq_u32 vcc, 1, v2
    s_nop 1
    v_cndmask_b32 v20, v196, v197, vcc
    v_cndmask_b32 v21, v192, v194, vcc
    v_mul_f32 v21, 0x3a800000, v21
    v_cvt_pk_bf16_f32 v22, v20, v21
    v_lshlrev_b32 v20, 16, v22
    v_and_b32 v21, 0xffff0000, v22
    v_add_f32 v21, 0x3727c5ac, v21
    v_cvt_pk_bf16_f32 v21, v21, v21
    v_lshlrev_b32 v21, 16, v21
    v_sqrt_f32 v21, v21
    v_xor_b32 v20, 0x80000000, v20
    v_cvt_pk_bf16_f32 v21, v21, v21
    v_lshlrev_b32 v21, 16, v21

fr_h1:
    ds_read_b32 v3, v19 offset:0
    s_waitcnt lgkmcnt(0)
    v_readfirstlane_b32 s22, v3
    s_cmp_lg_u32 s22, 0
    s_cbranch_scc1 fr_h1_go
    s_sleep 1
    s_branch fr_h1

fr_h1_go:
    ds_read_b64 v[14:15], v19 offset:8
    s_waitcnt lgkmcnt(0)
    v_readfirstlane_b32 s72, v14
    v_readfirstlane_b32 s73, v15

    v_mov_b32 v66, 0
    v_mov_b32 v70, 0
    v_mov_b32 v74, 0
    v_mov_b32 v78, 0
    v_mov_b32 v22, v14
    v_mov_b32 v23, v15
    s_mov_b64 exec, 3
    buffer_store_dwordx4 v[20:23], v5, s[12:15], s40 offen sc1
    s_mov_b64 exec, -1

fr_h2:
    ds_read_b32 v3, v19 offset:4
    s_waitcnt lgkmcnt(0)
    v_readfirstlane_b32 s22, v3
    s_cmp_lg_u32 s22, 0
    s_cbranch_scc1 fr_h2_go
    s_sleep 1
    s_branch fr_h2

fr_h2_go:

    s_cmp_lg_u32 s19, 0
    s_cbranch_scc1 fr_hb0
    s_mov_b32 m0, 104448
    s_add_u32 s28, s26, 6144
    s_add_u32 s29, s26, 10240
    buffer_load_dwordx4 v5, s[12:15], s28 offen sc1 lds
    buffer_load_dwordx4 v5, s[12:15], s28 offen offset:1024 sc1 lds
    buffer_load_dwordx4 v5, s[12:15], s28 offen offset:2048 sc1 lds
    buffer_load_dwordx4 v5, s[12:15], s28 offen offset:3072 sc1 lds
    s_mov_b32 m0, 108544
    s_nop 0
    buffer_load_dwordx4 v5, s[12:15], s29 offen sc1 lds
    buffer_load_dwordx4 v5, s[12:15], s29 offen offset:1024 sc1 lds
    fr_hb0:

    s_add_u32 m0, s45, 12288
    s_add_u32 s28, s26, 12288
    buffer_load_dwordx4 v5, s[12:15], s28 offen offset:0 sc1 lds
    buffer_load_dwordx4 v5, s[12:15], s28 offen offset:1024 sc1 lds
    buffer_load_dwordx4 v5, s[12:15], s28 offen offset:2048 sc1 lds
    s_add_u32 m0, s45, 24576
    s_add_u32 s28, s26, 24576
    buffer_load_dwordx4 v5, s[12:15], s28 offen offset:0 sc1 lds
    buffer_load_dwordx4 v5, s[12:15], s28 offen offset:1024 sc1 lds
    buffer_load_dwordx4 v5, s[12:15], s28 offen offset:2048 sc1 lds
    s_add_u32 m0, s45, 36864
    s_add_u32 s28, s26, 36864
    buffer_load_dwordx4 v5, s[12:15], s28 offen offset:0 sc1 lds
    buffer_load_dwordx4 v5, s[12:15], s28 offen offset:1024 sc1 lds
    buffer_load_dwordx4 v5, s[12:15], s28 offen offset:2048 sc1 lds
    s_cmp_lg_u32 s19, 0
    s_cbranch_scc1 fr_hx0
    s_waitcnt vmcnt(9)
fr_hx0:
    s_barrier
    s_waitcnt vmcnt(6)
    s_barrier
    s_add_u32 s28, s25, 384
    s_add_u32 m0, s27, 0
    s_nop 0
    buffer_load_dwordx4 v200, s[48:51], s28 offen offset:0 lds
    buffer_load_dwordx4 v201, s[48:51], s28 offen offset:1024 lds
    buffer_load_dwordx4 v202, s[48:51], s28 offen offset:2048 lds
    buffer_load_dwordx4 v203, s[48:51], s28 offen offset:3072 lds
    s_add_u32 m0, s27, 4096
    s_nop 0
    buffer_load_dwordx4 v204, s[48:51], s28 offen offset:0 lds
    buffer_load_dwordx4 v205, s[48:51], s28 offen offset:1024 lds
    buffer_load_dwordx4 v206, s[48:51], s28 offen offset:2048 lds
    buffer_load_dwordx4 v207, s[48:51], s28 offen offset:3072 lds
    s_add_u32 m0, s45, 0
    s_add_u32 s28, s26, 49152
    buffer_load_dwordx4 v5, s[12:15], s28 offen offset:0 sc1 lds
    buffer_load_dwordx4 v5, s[12:15], s28 offen offset:1024 sc1 lds
    buffer_load_dwordx4 v5, s[12:15], s28 offen offset:2048 sc1 lds
    s_waitcnt vmcnt(14)
    s_barrier
    s_add_u32 s28, s25, 512
    s_add_u32 m0, s27, 32768
    s_nop 0
    buffer_load_dwordx4 v200, s[48:51], s28 offen offset:0 lds
    buffer_load_dwordx4 v201, s[48:51], s28 offen offset:1024 lds
    buffer_load_dwordx4 v202, s[48:51], s28 offen offset:2048 lds
    buffer_load_dwordx4 v203, s[48:51], s28 offen offset:3072 lds
    s_add_u32 m0, s27, 36864
    s_nop 0
    buffer_load_dwordx4 v204, s[48:51], s28 offen offset:0 lds
    buffer_load_dwordx4 v205, s[48:51], s28 offen offset:1024 lds
    buffer_load_dwordx4 v206, s[48:51], s28 offen offset:2048 lds
    buffer_load_dwordx4 v207, s[48:51], s28 offen offset:3072 lds
    s_add_u32 m0, s45, 12288
    s_add_u32 s28, s26, 61440
    buffer_load_dwordx4 v5, s[12:15], s28 offen offset:0 sc1 lds
    buffer_load_dwordx4 v5, s[12:15], s28 offen offset:1024 sc1 lds
    buffer_load_dwordx4 v5, s[12:15], s28 offen offset:2048 sc1 lds
    buffer_load_dwordx4 v[64:67], v16, s[12:15], s42 offen sc1
    buffer_load_dwordx4 v[68:71], v16, s[12:15], s43 offen sc1
    s_waitcnt vmcnt(14)
    s_barrier
    s_add_u32 s28, s25, 640
    s_add_u32 m0, s27, 65536
    s_nop 0
    buffer_load_dwordx4 v200, s[48:51], s28 offen offset:0 lds
    buffer_load_dwordx4 v201, s[48:51], s28 offen offset:1024 lds
    buffer_load_dwordx4 v202, s[48:51], s28 offen offset:2048 lds
    buffer_load_dwordx4 v203, s[48:51], s28 offen offset:3072 lds
    s_add_u32 m0, s27, 69632
    s_nop 0
    buffer_load_dwordx4 v204, s[48:51], s28 offen offset:0 lds
    buffer_load_dwordx4 v205, s[48:51], s28 offen offset:1024 lds
    buffer_load_dwordx4 v206, s[48:51], s28 offen offset:2048 lds
    buffer_load_dwordx4 v207, s[48:51], s28 offen offset:3072 lds
    s_add_u32 m0, s45, 24576
    s_add_u32 s28, s26, 73728
    buffer_load_dwordx4 v5, s[12:15], s28 offen offset:0 sc1 lds
    buffer_load_dwordx4 v5, s[12:15], s28 offen offset:1024 sc1 lds
    buffer_load_dwordx4 v5, s[12:15], s28 offen offset:2048 sc1 lds
    s_waitcnt vmcnt(14)
    s_barrier
    s_add_u32 s28, s25, 768
    s_add_u32 m0, s27, 0
    s_nop 0
    buffer_load_dwordx4 v200, s[48:51], s28 offen offset:0 lds
    buffer_load_dwordx4 v201, s[48:51], s28 offen offset:1024 lds
    buffer_load_dwordx4 v202, s[48:51], s28 offen offset:2048 lds
    buffer_load_dwordx4 v203, s[48:51], s28 offen offset:3072 lds
    s_add_u32 m0, s27, 4096
    s_nop 0
    buffer_load_dwordx4 v204, s[48:51], s28 offen offset:0 lds
    buffer_load_dwordx4 v205, s[48:51], s28 offen offset:1024 lds
    buffer_load_dwordx4 v206, s[48:51], s28 offen offset:2048 lds
    buffer_load_dwordx4 v207, s[48:51], s28 offen offset:3072 lds
    s_add_u32 m0, s45, 36864
    s_add_u32 s28, s26, 86016
    buffer_load_dwordx4 v5, s[12:15], s28 offen offset:0 sc1 lds
    buffer_load_dwordx4 v5, s[12:15], s28 offen offset:1024 sc1 lds
    buffer_load_dwordx4 v5, s[12:15], s28 offen offset:2048 sc1 lds
    s_waitcnt vmcnt(22)
fr_g1:
    v_xor_b32 v24, v66, v14
    v_xor_b32 v25, v67, v15
    v_xor_b32 v26, v70, v14
    v_xor_b32 v27, v71, v15
    v_or3_b32 v24, v24, v25, v26
    v_or_b32 v24, v24, v27
    v_cmp_ne_u32 vcc, 0, v24
    s_sub_u32 s70, s70, 1
    s_cbranch_scc1 fr_g1_ok
    s_cbranch_vccz fr_g1_ok
    s_waitcnt vmcnt(0)

    buffer_load_dwordx4 v[64:67], v16, s[12:15], s42 offen sc1
    buffer_load_dwordx4 v[68:71], v16, s[12:15], s43 offen sc1
    s_waitcnt vmcnt(0)
    s_branch fr_g1
fr_g1_ok:
    v_add_f32 v24, v64, v68
    v_add_f32 v25, v65, v69
    s_nop 0
    v_add_f32_dpp v26, v24, v24 row_ror:4 row_mask:0xf bank_mask:0xf
    v_add_f32_dpp v27, v25, v25 row_ror:4 row_mask:0xf bank_mask:0xf
    s_nop 0
    v_add_f32_dpp v24, v26, v26 row_ror:8 row_mask:0xf bank_mask:0xf
    v_add_f32_dpp v25, v27, v27 row_ror:8 row_mask:0xf bank_mask:0xf

    v_mov_b32 v26, v24
    v_mov_b32 v27, v25
    s_nop 0
    v_permlane16_swap_b32 v24, v26
    v_permlane16_swap_b32 v25, v27
    s_nop 0
    v_add_f32 v24, v24, v26
    v_add_f32 v25, v25, v27

    v_mov_b32 v26, v24
    v_mov_b32 v27, v25
    s_nop 0
    v_permlane32_swap_b32 v24, v26
    v_permlane32_swap_b32 v25, v27
    s_nop 0
    v_add_f32 v24, v24, v26
    v_add_f32 v25, v25, v27

    v_mov_b32 v26, v14
    v_mov_b32 v27, v15
    s_mov_b64 exec, 7
    buffer_store_dwordx4 v[24:27], v13, s[12:15], s44 offen sc1
    s_mov_b64 exec, -1

    s_waitcnt vmcnt(14)
    s_barrier
    s_add_u32 s28, s25, 896
    s_add_u32 m0, s27, 32768
    s_nop 0
    buffer_load_dwordx4 v200, s[48:51], s28 offen offset:0 lds
    buffer_load_dwordx4 v201, s[48:51], s28 offen offset:1024 lds
    buffer_load_dwordx4 v202, s[48:51], s28 offen offset:2048 lds
    buffer_load_dwordx4 v203, s[48:51], s28 offen offset:3072 lds
    s_add_u32 m0, s27, 36864
    s_nop 0
    buffer_load_dwordx4 v204, s[48:51], s28 offen offset:0 lds
    buffer_load_dwordx4 v205, s[48:51], s28 offen offset:1024 lds
    buffer_load_dwordx4 v206, s[48:51], s28 offen offset:2048 lds
    buffer_load_dwordx4 v207, s[48:51], s28 offen offset:3072 lds
    s_add_u32 m0, s45, 0
    s_add_u32 s28, s26, 98304
    buffer_load_dwordx4 v5, s[12:15], s28 offen offset:0 sc1 lds
    buffer_load_dwordx4 v5, s[12:15], s28 offen offset:1024 sc1 lds
    buffer_load_dwordx4 v5, s[12:15], s28 offen offset:2048 sc1 lds
    s_waitcnt vmcnt(14)
    s_barrier
    s_add_u32 s28, s25, 1024
    s_add_u32 m0, s27, 65536
    s_nop 0
    buffer_load_dwordx4 v200, s[48:51], s28 offen offset:0 lds
    buffer_load_dwordx4 v201, s[48:51], s28 offen offset:1024 lds
    buffer_load_dwordx4 v202, s[48:51], s28 offen offset:2048 lds
    buffer_load_dwordx4 v203, s[48:51], s28 offen offset:3072 lds
    s_add_u32 m0, s27, 69632
    s_nop 0
    buffer_load_dwordx4 v204, s[48:51], s28 offen offset:0 lds
    buffer_load_dwordx4 v205, s[48:51], s28 offen offset:1024 lds
    buffer_load_dwordx4 v206, s[48:51], s28 offen offset:2048 lds
    buffer_load_dwordx4 v207, s[48:51], s28 offen offset:3072 lds
    s_add_u32 m0, s45, 12288
    s_add_u32 s28, s26, 110592
    buffer_load_dwordx4 v5, s[12:15], s28 offen offset:0 sc1 lds
    buffer_load_dwordx4 v5, s[12:15], s28 offen offset:1024 sc1 lds
    buffer_load_dwordx4 v5, s[12:15], s28 offen offset:2048 sc1 lds
    s_waitcnt vmcnt(14)
    s_barrier
    s_add_u32 s28, s25, 1152
    s_add_u32 m0, s27, 0
    s_nop 0
    buffer_load_dwordx4 v200, s[48:51], s28 offen offset:0 lds
    buffer_load_dwordx4 v201, s[48:51], s28 offen offset:1024 lds
    buffer_load_dwordx4 v202, s[48:51], s28 offen offset:2048 lds
    buffer_load_dwordx4 v203, s[48:51], s28 offen offset:3072 lds
    s_add_u32 m0, s27, 4096
    s_nop 0
    buffer_load_dwordx4 v204, s[48:51], s28 offen offset:0 lds
    buffer_load_dwordx4 v205, s[48:51], s28 offen offset:1024 lds
    buffer_load_dwordx4 v206, s[48:51], s28 offen offset:2048 lds
    buffer_load_dwordx4 v207, s[48:51], s28 offen offset:3072 lds
    s_add_u32 m0, s45, 24576
    s_add_u32 s28, s26, 122880
    buffer_load_dwordx4 v5, s[12:15], s28 offen offset:0 sc1 lds
    buffer_load_dwordx4 v5, s[12:15], s28 offen offset:1024 sc1 lds
    buffer_load_dwordx4 v5, s[12:15], s28 offen offset:2048 sc1 lds
    s_waitcnt vmcnt(14)
    s_barrier
    s_add_u32 s28, s25, 1280
    s_add_u32 m0, s27, 32768
    s_nop 0
    buffer_load_dwordx4 v200, s[48:51], s28 offen offset:0 lds
    buffer_load_dwordx4 v201, s[48:51], s28 offen offset:1024 lds
    buffer_load_dwordx4 v202, s[48:51], s28 offen offset:2048 lds
    buffer_load_dwordx4 v203, s[48:51], s28 offen offset:3072 lds
    s_add_u32 m0, s27, 36864
    s_nop 0
    buffer_load_dwordx4 v204, s[48:51], s28 offen offset:0 lds
    buffer_load_dwordx4 v205, s[48:51], s28 offen offset:1024 lds
    buffer_load_dwordx4 v206, s[48:51], s28 offen offset:2048 lds
    buffer_load_dwordx4 v207, s[48:51], s28 offen offset:3072 lds
    s_add_u32 m0, s45, 36864
    s_add_u32 s28, s26, 135168
    buffer_load_dwordx4 v5, s[12:15], s28 offen offset:0 sc1 lds
    buffer_load_dwordx4 v5, s[12:15], s28 offen offset:1024 sc1 lds
    buffer_load_dwordx4 v5, s[12:15], s28 offen offset:2048 sc1 lds
    s_waitcnt vmcnt(14)
    s_barrier
    s_add_u32 s28, s25, 1408
    s_add_u32 m0, s27, 65536
    s_nop 0
    buffer_load_dwordx4 v200, s[48:51], s28 offen offset:0 lds
    buffer_load_dwordx4 v201, s[48:51], s28 offen offset:1024 lds
    buffer_load_dwordx4 v202, s[48:51], s28 offen offset:2048 lds
    buffer_load_dwordx4 v203, s[48:51], s28 offen offset:3072 lds
    s_add_u32 m0, s27, 69632
    s_nop 0
    buffer_load_dwordx4 v204, s[48:51], s28 offen offset:0 lds
    buffer_load_dwordx4 v205, s[48:51], s28 offen offset:1024 lds
    buffer_load_dwordx4 v206, s[48:51], s28 offen offset:2048 lds
    buffer_load_dwordx4 v207, s[48:51], s28 offen offset:3072 lds
    s_add_u32 m0, s45, 0
    s_add_u32 s28, s26, 147456
    buffer_load_dwordx4 v5, s[12:15], s28 offen offset:0 sc1 lds
    buffer_load_dwordx4 v5, s[12:15], s28 offen offset:1024 sc1 lds
    buffer_load_dwordx4 v5, s[12:15], s28 offen offset:2048 sc1 lds
    buffer_load_dwordx4 v[72:75], v12, s[12:15], s44 offen sc1
    buffer_load_dwordx4 v[76:79], v17, s[12:15], s41 offen sc1
    s_waitcnt vmcnt(14)
    s_barrier
    s_add_u32 s28, s25, 1536
    s_add_u32 m0, s27, 0
    s_nop 0
    buffer_load_dwordx4 v200, s[48:51], s28 offen offset:0 lds
    buffer_load_dwordx4 v201, s[48:51], s28 offen offset:1024 lds
    buffer_load_dwordx4 v202, s[48:51], s28 offen offset:2048 lds
    buffer_load_dwordx4 v203, s[48:51], s28 offen offset:3072 lds
    s_add_u32 m0, s27, 4096
    s_nop 0
    buffer_load_dwordx4 v204, s[48:51], s28 offen offset:0 lds
    buffer_load_dwordx4 v205, s[48:51], s28 offen offset:1024 lds
    buffer_load_dwordx4 v206, s[48:51], s28 offen offset:2048 lds
    buffer_load_dwordx4 v207, s[48:51], s28 offen offset:3072 lds
    s_add_u32 m0, s45, 12288
    s_add_u32 s28, s26, 159744
    buffer_load_dwordx4 v5, s[12:15], s28 offen offset:0 sc1 lds
    buffer_load_dwordx4 v5, s[12:15], s28 offen offset:1024 sc1 lds
    buffer_load_dwordx4 v5, s[12:15], s28 offen offset:2048 sc1 lds
    s_waitcnt vmcnt(14)
    s_barrier
    s_add_u32 s28, s25, 1664
    s_add_u32 m0, s27, 32768
    s_nop 0
    buffer_load_dwordx4 v200, s[48:51], s28 offen offset:0 lds
    buffer_load_dwordx4 v201, s[48:51], s28 offen offset:1024 lds
    buffer_load_dwordx4 v202, s[48:51], s28 offen offset:2048 lds
    buffer_load_dwordx4 v203, s[48:51], s28 offen offset:3072 lds
    s_add_u32 m0, s27, 36864
    s_nop 0
    buffer_load_dwordx4 v204, s[48:51], s28 offen offset:0 lds
    buffer_load_dwordx4 v205, s[48:51], s28 offen offset:1024 lds
    buffer_load_dwordx4 v206, s[48:51], s28 offen offset:2048 lds
    buffer_load_dwordx4 v207, s[48:51], s28 offen offset:3072 lds
    s_add_u32 m0, s45, 24576
    s_add_u32 s28, s26, 172032
    buffer_load_dwordx4 v5, s[12:15], s28 offen offset:0 sc1 lds
    buffer_load_dwordx4 v5, s[12:15], s28 offen offset:1024 sc1 lds
    buffer_load_dwordx4 v5, s[12:15], s28 offen offset:2048 sc1 lds
    s_waitcnt vmcnt(22)
fr_g2:
    v_xor_b32 v24, v74, v14
    v_xor_b32 v25, v75, v15
    v_xor_b32 v26, v78, v14
    v_xor_b32 v27, v79, v15
    v_or3_b32 v24, v24, v25, v26
    v_or_b32 v24, v24, v27
    v_cmp_ne_u32 vcc, 0, v24
    s_sub_u32 s70, s70, 1
    s_cbranch_scc1 fr_g2_ok
    s_cbranch_vccz fr_g2_ok
    s_waitcnt vmcnt(0)

    buffer_load_dwordx4 v[72:75], v12, s[12:15], s44 offen sc1
    buffer_load_dwordx4 v[76:79], v17, s[12:15], s41 offen sc1
    s_waitcnt vmcnt(0)
    s_branch fr_g2
fr_g2_ok:
    v_rcp_f32 v78, v77
    s_mov_b32 s22, 1048744942
    ds_write_b32 v18, v72
    ds_write_b32 v18, v73 offset:384
    v_mul_f32 v79, s22, v78
    ds_write_b128 v6, v[76:79]
    ds_write_b32 v7, v76
    ds_write_b32 v7, v77 offset:1024
    ds_write_b32 v7, v78 offset:2048

    s_waitcnt vmcnt(14)
    s_waitcnt lgkmcnt(0)
    s_barrier
    s_add_u32 s28, s25, 1792
    s_add_u32 m0, s27, 65536
    s_nop 0
    buffer_load_dwordx4 v200, s[48:51], s28 offen offset:0 lds
    buffer_load_dwordx4 v201, s[48:51], s28 offen offset:1024 lds
    buffer_load_dwordx4 v202, s[48:51], s28 offen offset:2048 lds
    buffer_load_dwordx4 v203, s[48:51], s28 offen offset:3072 lds
    s_add_u32 m0, s27, 69632
    s_nop 0
    buffer_load_dwordx4 v204, s[48:51], s28 offen offset:0 lds
    buffer_load_dwordx4 v205, s[48:51], s28 offen offset:1024 lds
    buffer_load_dwordx4 v206, s[48:51], s28 offen offset:2048 lds
    buffer_load_dwordx4 v207, s[48:51], s28 offen offset:3072 lds
    s_add_u32 m0, s45, 36864
    s_add_u32 s28, s26, 184320
    buffer_load_dwordx4 v5, s[12:15], s28 offen offset:0 sc1 lds
    buffer_load_dwordx4 v5, s[12:15], s28 offen offset:1024 sc1 lds
    buffer_load_dwordx4 v5, s[12:15], s28 offen offset:2048 sc1 lds
    s_mov_b32 s52, s6
    s_and_b32 s53, s7, 0xffff
    s_mov_b32 s54, 12582912
    s_mov_b32 s55, 0x00020000
    s_mov_b32 s60, s4
    s_and_b32 s61, s5, 0xffff
    s_mov_b32 s62, 2048
    s_mov_b32 s63, 0x00020000
    v_and_b32 v3, 15, v2
    v_lshrrev_b32 v4, 4, v2
    s_lshl_b32 s29, s20, 7
    s_lshl_b32 s30, s19, 5
    s_add_u32 s29, s29, s30
    s_lshl_b32 s39, s29, 1
    v_lshlrev_b32 v16, 4, v4
    s_mov_b32 s30, 98304
    v_mul_lo_u32 v17, v4, s30
    v_lshl_add_u32 v17, v3, 4, v17
    s_mul_i32 s29, s29, 12288
    s_lshl_b32 s30, s21, 8
    s_add_u32 s29, s29, s30
    s_add_u32 s29, s29, 4096
    buffer_load_dwordx4 v[128:131], v16, s[60:63], s39 offen

    s_waitcnt vmcnt(14)
    s_barrier
    s_add_u32 s28, s25, 1920
    s_add_u32 m0, s27, 0
    s_nop 0
    buffer_load_dwordx4 v200, s[48:51], s28 offen offset:0 lds
    buffer_load_dwordx4 v201, s[48:51], s28 offen offset:1024 lds
    buffer_load_dwordx4 v202, s[48:51], s28 offen offset:2048 lds
    buffer_load_dwordx4 v203, s[48:51], s28 offen offset:3072 lds
    s_add_u32 m0, s27, 4096
    s_nop 0
    buffer_load_dwordx4 v204, s[48:51], s28 offen offset:0 lds
    buffer_load_dwordx4 v205, s[48:51], s28 offen offset:1024 lds
    buffer_load_dwordx4 v206, s[48:51], s28 offen offset:2048 lds
    buffer_load_dwordx4 v207, s[48:51], s28 offen offset:3072 lds
    s_waitcnt vmcnt(11)
    s_barrier
    s_load_dwordx4 s[36:39], s[0:1], 40
    s_load_dwordx2 s[56:57], s[0:1], 56
    s_load_dwordx2 s[58:59], s[0:1], 16

    s_waitcnt vmcnt(0)
    s_barrier
    s_waitcnt lgkmcnt(0)
    s_cmp_ge_u32 s21, 16
    s_cselect_b32 s36, s38, s36
    s_cselect_b32 s37, s39, s37
    s_cselect_b32 s22, 0x800000, 0

    s_mov_b32 s40, s36
    s_and_b32 s41, s37, 0xffff
    s_mov_b32 s42, 7340032
    s_mov_b32 s43, 0x00020000
    s_mov_b32 s44, s56
    s_and_b32 s45, s57, 0xffff
    s_mov_b32 s46, 7340032
    s_mov_b32 s47, 0x00020000
    s_mov_b32 s48, s58
    s_and_b32 s49, s59, 0xffff
    s_mov_b32 s50, 2097152
    s_mov_b32 s51, 0x00020000
    ds_read_b32 v24, v19
    s_lshl_b32 s23, s21, 3
    s_lshl_b32 s24, s19, 1
    s_add_u32 s23, s23, s24
    s_and_b32 s24, s23, 127
    s_mul_i32 s64, s24, 57344
    s_mul_i32 s25, s20, 896
    s_add_u32 s64, s64, s25
    s_add_u32 s65, s64, 57344
    s_mul_i32 s25, s20, 917504
    s_add_u32 s25, s25, s22
    s_lshl_b32 s24, s24, 8
    s_add_u32 s25, s25, s24
    s_add_u32 s66, s25, 50331648
    s_mul_i32 s67, s20, 917504
    s_mul_i32 s24, s23, 3584
    s_add_u32 s67, s67, s24
    s_and_b32 s68, s20, 1
    s_lshl_b32 s68, s68, 10
    s_lshl_b32 s24, s23, 13
    s_add_u32 s68, s68, s24
    v_lshrrev_b32 v3, 3, v2
    v_and_b32 v4, 7, v2
    s_mov_b32 s24, 7168
    v_mul_lo_u32 v6, v3, s24
    v_lshl_add_u32 v6, v4, 4, v6
    v_lshrrev_b32 v7, 1, v4
    v_lshlrev_b32 v7, 15, v7
    v_lshl_add_u32 v7, v3, 5, v7
    v_and_b32 v4, 1, v2
    v_lshl_add_u32 v7, v4, 4, v7
    v_lshlrev_b32 v8, 6, v2
    v_lshrrev_b32 v9, 4, v2
    v_and_b32 v11, 15, v2
    v_lshlrev_b32 v11, 6, v11
    v_lshl_add_u32 v9, v9, 11, v11
    v_lshlrev_b32 v11, 7, v2
    s_lshl_b32 s27, s19, 13
    v_add_u32 v12, s27, v5
    s_lshl_b32 s28, s16, 17
    s_lshl_b32 s24, s19, 12
    s_add_u32 s28, s28, s24
    s_lshl_b32 s24, s17, 14
    s_add_u32 s24, s24, s28
    s_add_u32 s30, s24, 9437184
    s_add_u32 s31, s24, 13631488
    s_lshl_b32 s32, s16, 2
    s_add_u32 s32, s32, s19
    s_lshl_b32 s32, s32, 10
    s_add_u32 s32, s32, 3145728
    s_lshl_b32 s35, s17, 7
    s_add_u32 s35, s35, s32
    s_mov_b32 s69, 0xff
    s_bitset0_b32 s69, s17
    s_add_u32 s33, s27, 32768
    s_waitcnt vmcnt(0) lgkmcnt(0)
    v_readfirstlane_b32 s22, v24

    v_lshlrev_b32 v140, 16, v128
    v_and_b32 v141, 0xffff0000, v128
    v_lshlrev_b32 v142, 16, v129
    v_and_b32 v143, 0xffff0000, v129
    v_lshlrev_b32 v144, 16, v130
    v_and_b32 v145, 0xffff0000, v130
    v_lshlrev_b32 v146, 16, v131
    v_and_b32 v147, 0xffff0000, v131
    s_mov_b32 s34, 0xbfb8aa3b
    v_mul_f32 v132, s34, v140
    v_mul_f32 v133, s34, v141
    v_mul_f32 v134, s34, v142
    v_mul_f32 v135, s34, v143
    v_mul_f32 v136, s34, v144
    v_mul_f32 v137, s34, v145
    v_mul_f32 v138, s34, v146
    v_mul_f32 v139, s34, v147
    v_exp_f32 v132, v132
    v_exp_f32 v133, v133
    v_exp_f32 v134, v134
    v_exp_f32 v135, v135
    v_exp_f32 v136, v136
    v_exp_f32 v137, v137
    v_exp_f32 v138, v138
    v_exp_f32 v139, v139
    v_add_f32 v132, 1.0, v132
    v_add_f32 v133, 1.0, v133
    v_add_f32 v134, 1.0, v134
    v_add_f32 v135, 1.0, v135
    v_add_f32 v136, 1.0, v136
    v_add_f32 v137, 1.0, v137
    v_add_f32 v138, 1.0, v138
    v_add_f32 v139, 1.0, v139
    v_rcp_f32 v132, v132
    v_rcp_f32 v133, v133
    v_rcp_f32 v134, v134
    v_rcp_f32 v135, v135
    v_rcp_f32 v136, v136
    v_rcp_f32 v137, v137
    v_rcp_f32 v138, v138
    v_rcp_f32 v139, v139
    v_mul_f32 v140, v140, v132
    v_mul_f32 v141, v141, v133
    v_mul_f32 v142, v142, v134
    v_mul_f32 v143, v143, v135
    v_mul_f32 v144, v144, v136
    v_mul_f32 v145, v145, v137
    v_mul_f32 v146, v146, v138
    v_mul_f32 v147, v147, v139
    v_cvt_pk_bf16_f32 v140, v140, v140
    v_cvt_pk_bf16_f32 v141, v141, v141
    v_cvt_pk_bf16_f32 v142, v142, v142
    v_cvt_pk_bf16_f32 v143, v143, v143
    v_cvt_pk_bf16_f32 v144, v144, v144
    v_cvt_pk_bf16_f32 v145, v145, v145
    v_cvt_pk_bf16_f32 v146, v146, v146
    v_cvt_pk_bf16_f32 v147, v147, v147
    v_lshlrev_b32 v140, 16, v140
    v_lshlrev_b32 v141, 16, v141
    v_lshlrev_b32 v142, 16, v142
    v_lshlrev_b32 v143, 16, v143
    v_lshlrev_b32 v144, 16, v144
    v_lshlrev_b32 v145, 16, v145
    v_lshlrev_b32 v146, 16, v146
    v_lshlrev_b32 v147, 16, v147
    s_setprio 3
    s_barrier
    ds_read_b128 v[160:163], v12 offset:0
    ds_read_b128 v[164:167], v12 offset:1024
    ds_read_b128 v[168:171], v12 offset:2048
    ds_read_b128 v[172:175], v12 offset:3072
    ds_read_b128 v[176:179], v12 offset:4096
    ds_read_b128 v[180:183], v12 offset:5120
    ds_read_b128 v[184:187], v12 offset:6144
    ds_read_b128 v[188:191], v12 offset:7168
    s_waitcnt lgkmcnt(7)
    buffer_store_dwordx4 v[160:163], v5, s[12:15], s30 offen offset:0 sc1
    s_waitcnt lgkmcnt(6)
    buffer_store_dwordx4 v[164:167], v5, s[12:15], s30 offen offset:1024 sc1
    s_waitcnt lgkmcnt(5)
    buffer_store_dwordx4 v[168:171], v5, s[12:15], s31 offen offset:0 sc1
    s_waitcnt lgkmcnt(4)
    buffer_store_dwordx4 v[172:175], v5, s[12:15], s31 offen offset:1024 sc1
    s_waitcnt lgkmcnt(3)
    buffer_store_dwordx4 v[176:179], v5, s[12:15], s30 offen offset:2048 sc1
    s_waitcnt lgkmcnt(2)
    buffer_store_dwordx4 v[180:183], v5, s[12:15], s30 offen offset:3072 sc1
    s_waitcnt lgkmcnt(1)
    buffer_store_dwordx4 v[184:187], v5, s[12:15], s31 offen offset:2048 sc1
    s_waitcnt lgkmcnt(0)
    buffer_store_dwordx4 v[188:191], v5, s[12:15], s31 offen offset:3072 sc1
    s_mov_b64 exec, 0xff
    buffer_load_dwordx2 v[24:25], v11, s[12:15], s32 offen sc1
    s_mov_b64 exec, -1

    s_mov_b64 exec, 1
    s_waitcnt vmcnt(0)
    buffer_store_dwordx2 v[14:15], v10, s[12:15], s35 offen sc1
    s_mov_b64 exec, -1

    s_mov_b32 s23, 1
    s_mov_b32 s22, 1
    s_branch fa_e0
fa_l0:
    s_mov_b32 s22, s23
    s_waitcnt vmcnt(0)
fa_e0:
    s_cmp_ge_u32 s23, 4
    s_cbranch_scc1 fa_d0
    v_cmp_eq_u32 vcc, v24, v14
    v_cmp_eq_u32 s[24:25], v25, v15
    s_nop 1
    s_and_b32 s34, vcc_lo, s24
    s_sub_u32 s70, s70, 1
    s_cselect_b32 s34, -1, s34
    s_and_b32 s34, s34, s69

    s_mov_b64 exec, 0xff
    buffer_load_dwordx2 v[24:25], v11, s[12:15], s32 offen sc1
    s_mov_b64 exec, -1

    s_cmp_eq_u32 s34, 0
    s_cbranch_scc1 fa_d0
fa_n0:
    s_and_b32 s33, s23, 3
    s_lshl_b32 s33, s33, 15
    s_add_u32 s33, s33, s27
    s_add_u32 s23, s23, 1

    s_ff1_i32_b32 s26, s34
    s_bitset0_b32 s34, s26
    s_bitset0_b32 s69, s26
    s_lshl_b32 s26, s26, 14
    s_add_u32 s26, s26, s28
    s_add_u32 s30, s26, 9437184
    s_mov_b32 m0, s33
    s_add_u32 s31, s26, 13629440
    buffer_load_dwordx4 v5, s[12:15], s30 offen  lds
    buffer_load_dwordx4 v5, s[12:15], s30 offen offset:1024  lds
    buffer_load_dwordx4 v5, s[12:15], s31 offen offset:2048  lds
    buffer_load_dwordx4 v5, s[12:15], s31 offen offset:3072  lds
    s_add_u32 m0, s33, 2048
    s_add_u32 s31, s31, 2048
    s_add_u32 s33, s33, 32768
    buffer_load_dwordx4 v5, s[12:15], s30 offen offset:2048  lds
    buffer_load_dwordx4 v5, s[12:15], s30 offen offset:3072  lds
    s_add_u32 m0, s33, -28672
    s_nop 0
    buffer_load_dwordx4 v5, s[12:15], s31 offen offset:2048  lds
    buffer_load_dwordx4 v5, s[12:15], s31 offen offset:3072  lds

    s_cmp_ge_u32 s23, 4
    s_cbranch_scc1 fa_d0
    s_cmp_lg_u32 s34, 0
    s_cbranch_scc1 fa_n0
    fa_d0:
    s_cmp_lt_u32 s22, 2
    s_cbranch_scc1 fa_l0
    s_barrier

    s_branch fa_q2
fa_q0:
    s_mov_b64 exec, 0xff
    buffer_load_dwordx2 v[24:25], v11, s[12:15], s32 offen sc1
    s_mov_b64 exec, -1

    s_waitcnt vmcnt(0)
    v_cmp_eq_u32 vcc, v24, v14
    v_cmp_eq_u32 s[24:25], v25, v15
    s_nop 1
    s_and_b32 s34, vcc_lo, s24
    s_sub_u32 s70, s70, 1
    s_cselect_b32 s34, -1, s34
    s_and_b32 s34, s34, s69

fa_q1:
    s_cmp_ge_u32 s23, 4
    s_cbranch_scc1 fa_q2
    s_cmp_eq_u32 s34, 0
    s_cbranch_scc1 fa_q0
    s_and_b32 s33, s23, 3
    s_lshl_b32 s33, s33, 15
    s_add_u32 s33, s33, s27
    s_add_u32 s23, s23, 1

    s_ff1_i32_b32 s26, s34
    s_bitset0_b32 s34, s26
    s_bitset0_b32 s69, s26
    s_lshl_b32 s26, s26, 14
    s_add_u32 s26, s26, s28
    s_add_u32 s30, s26, 9437184
    s_mov_b32 m0, s33
    s_add_u32 s31, s26, 13629440
    buffer_load_dwordx4 v5, s[12:15], s30 offen  lds
    buffer_load_dwordx4 v5, s[12:15], s30 offen offset:1024  lds
    buffer_load_dwordx4 v5, s[12:15], s31 offen offset:2048  lds
    buffer_load_dwordx4 v5, s[12:15], s31 offen offset:3072  lds
    s_add_u32 m0, s33, 2048
    s_add_u32 s31, s31, 2048
    s_add_u32 s33, s33, 32768
    buffer_load_dwordx4 v5, s[12:15], s30 offen offset:2048  lds
    buffer_load_dwordx4 v5, s[12:15], s30 offen offset:3072  lds
    s_add_u32 m0, s33, -28672
    s_nop 0
    buffer_load_dwordx4 v5, s[12:15], s31 offen offset:2048  lds
    buffer_load_dwordx4 v5, s[12:15], s31 offen offset:3072  lds

    s_branch fa_q1
fa_q2:
    s_cmp_lt_u32 s23, 4
    s_cbranch_scc1 fa_q0
    s_cmp_lg_u32 s34, s69
    s_cbranch_scc1 fa_q0

    s_setprio 0
    buffer_load_dwordx4 v[160:163], v6, s[40:43], s64 offen offset:0
    buffer_load_dwordx4 v[164:167], v6, s[40:43], s64 offen offset:128
    buffer_load_dwordx4 v[168:171], v6, s[40:43], s64 offen offset:256
    buffer_load_dwordx4 v[96:99], v17, s[52:55], s29 offen
    s_add_u32 s29, s29, 12288
    buffer_load_dwordx4 v[100:103], v17, s[52:55], s29 offen
    s_add_u32 s29, s29, 12288
    buffer_load_dwordx4 v[104:107], v17, s[52:55], s29 offen
    s_add_u32 s29, s29, 12288
    buffer_load_dwordx4 v[108:111], v17, s[52:55], s29 offen
    s_add_u32 s29, s29, 12288
    buffer_load_dwordx4 v[112:115], v17, s[52:55], s29 offen
    s_add_u32 s29, s29, 12288
    buffer_load_dwordx4 v[116:119], v17, s[52:55], s29 offen
    s_add_u32 s29, s29, 12288
    buffer_load_dwordx4 v[120:123], v17, s[52:55], s29 offen
    s_add_u32 s29, s29, 12288
    buffer_load_dwordx4 v[124:127], v17, s[52:55], s29 offen
    s_add_u32 s29, s29, 12288
    s_waitcnt vmcnt(19)
    s_barrier
    s_and_b32 s33, s23, 3
    s_lshl_b32 s33, s33, 15
    s_add_u32 s33, s33, s27
    s_add_u32 s23, s23, 1

    s_ff1_i32_b32 s26, s34
    s_bitset0_b32 s34, s26
    s_bitset0_b32 s69, s26
    s_lshl_b32 s26, s26, 14
    s_add_u32 s26, s26, s28
    s_add_u32 s30, s26, 9437184
    s_mov_b32 m0, s33
    s_add_u32 s31, s26, 13629440
    buffer_load_dwordx4 v5, s[12:15], s30 offen  lds
    buffer_load_dwordx4 v5, s[12:15], s30 offen offset:1024  lds
    buffer_load_dwordx4 v5, s[12:15], s31 offen offset:2048  lds
    buffer_load_dwordx4 v5, s[12:15], s31 offen offset:3072  lds
    s_add_u32 m0, s33, 2048
    s_add_u32 s31, s31, 2048
    s_add_u32 s33, s33, 32768
    buffer_load_dwordx4 v5, s[12:15], s30 offen offset:2048  lds
    buffer_load_dwordx4 v5, s[12:15], s30 offen offset:3072  lds
    s_add_u32 m0, s33, -28672
    s_nop 0
    buffer_load_dwordx4 v5, s[12:15], s31 offen offset:2048  lds
    buffer_load_dwordx4 v5, s[12:15], s31 offen offset:3072  lds

    buffer_load_dwordx4 v[172:175], v6, s[40:43], s64 offen offset:384
    buffer_load_dwordx4 v[176:179], v6, s[40:43], s64 offen offset:512
    buffer_load_dwordx4 v[180:183], v6, s[40:43], s64 offen offset:640
    buffer_load_dword v240, v8, s[44:47], s67 offen
    s_add_u32 s67, s67, 4096
    s_waitcnt vmcnt(23)
    s_barrier
    s_and_b32 s33, s23, 3
    s_lshl_b32 s33, s33, 15
    s_add_u32 s33, s33, s27
    s_add_u32 s23, s23, 1

    s_ff1_i32_b32 s26, s34
    s_bitset0_b32 s34, s26
    s_bitset0_b32 s69, s26
    s_lshl_b32 s26, s26, 14
    s_add_u32 s26, s26, s28
    s_add_u32 s30, s26, 9437184
    s_mov_b32 m0, s33
    s_add_u32 s31, s26, 13629440
    buffer_load_dwordx4 v5, s[12:15], s30 offen  lds
    buffer_load_dwordx4 v5, s[12:15], s30 offen offset:1024  lds
    buffer_load_dwordx4 v5, s[12:15], s31 offen offset:2048  lds
    buffer_load_dwordx4 v5, s[12:15], s31 offen offset:3072  lds
    s_add_u32 m0, s33, 2048
    s_add_u32 s31, s31, 2048
    s_add_u32 s33, s33, 32768
    buffer_load_dwordx4 v5, s[12:15], s30 offen offset:2048  lds
    buffer_load_dwordx4 v5, s[12:15], s30 offen offset:3072  lds
    s_add_u32 m0, s33, -28672
    s_nop 0
    buffer_load_dwordx4 v5, s[12:15], s31 offen offset:2048  lds
    buffer_load_dwordx4 v5, s[12:15], s31 offen offset:3072  lds

    s_waitcnt vmcnt(28)
    s_add_u32 s26, s66, 0
    buffer_store_dwordx4 v[160:163], v7, s[12:15], s26 offen offset:0 sc1
    s_add_u32 s26, s66, 131072
    buffer_store_dwordx4 v[164:167], v7, s[12:15], s26 offen offset:0 sc1
    s_add_u32 s26, s66, 262144
    buffer_store_dwordx4 v[168:171], v7, s[12:15], s26 offen offset:0 sc1
    buffer_load_dwordx4 v[184:187], v6, s[40:43], s64 offen offset:768
    buffer_load_dwordx4 v[188:191], v6, s[40:43], s65 offen offset:0
    buffer_load_dwordx4 v[192:195], v6, s[40:43], s65 offen offset:128
    buffer_load_dword v240, v8, s[44:47], s67 offen
    s_add_u32 s67, s67, 4096
    s_waitcnt vmcnt(34)
    v_lshlrev_b32 v148, 16, v96
    v_and_b32 v149, 0xffff0000, v96
    v_mul_f32 v132, v140, v148
    v_mul_f32 v133, v140, v149
    v_lshlrev_b32 v150, 16, v97
    v_and_b32 v151, 0xffff0000, v97
    v_mul_f32 v134, v140, v150
    v_mul_f32 v135, v140, v151
    v_lshlrev_b32 v148, 16, v98
    v_and_b32 v149, 0xffff0000, v98
    v_mul_f32 v136, v140, v148
    v_mul_f32 v137, v140, v149
    v_lshlrev_b32 v150, 16, v99
    v_and_b32 v151, 0xffff0000, v99
    v_mul_f32 v138, v140, v150
    v_mul_f32 v139, v140, v151
    s_waitcnt vmcnt(33)
    v_lshlrev_b32 v148, 16, v100
    v_and_b32 v149, 0xffff0000, v100
    v_fmac_f32 v132, v141, v148
    v_fmac_f32 v133, v141, v149
    v_lshlrev_b32 v150, 16, v101
    v_and_b32 v151, 0xffff0000, v101
    v_fmac_f32 v134, v141, v150
    v_fmac_f32 v135, v141, v151
    v_lshlrev_b32 v148, 16, v102
    v_and_b32 v149, 0xffff0000, v102
    v_fmac_f32 v136, v141, v148
    v_fmac_f32 v137, v141, v149
    v_lshlrev_b32 v150, 16, v103
    v_and_b32 v151, 0xffff0000, v103
    v_fmac_f32 v138, v141, v150
    v_fmac_f32 v139, v141, v151
    s_waitcnt vmcnt(32)
    v_lshlrev_b32 v148, 16, v104
    v_and_b32 v149, 0xffff0000, v104
    v_fmac_f32 v132, v142, v148
    v_fmac_f32 v133, v142, v149
    v_lshlrev_b32 v150, 16, v105
    v_and_b32 v151, 0xffff0000, v105
    v_fmac_f32 v134, v142, v150
    v_fmac_f32 v135, v142, v151
    v_lshlrev_b32 v148, 16, v106
    v_and_b32 v149, 0xffff0000, v106
    v_fmac_f32 v136, v142, v148
    v_fmac_f32 v137, v142, v149
    v_lshlrev_b32 v150, 16, v107
    v_and_b32 v151, 0xffff0000, v107
    v_fmac_f32 v138, v142, v150
    v_fmac_f32 v139, v142, v151
    s_waitcnt vmcnt(31)
    v_lshlrev_b32 v148, 16, v108
    v_and_b32 v149, 0xffff0000, v108
    v_fmac_f32 v132, v143, v148
    v_fmac_f32 v133, v143, v149
    v_lshlrev_b32 v150, 16, v109
    v_and_b32 v151, 0xffff0000, v109
    v_fmac_f32 v134, v143, v150
    v_fmac_f32 v135, v143, v151
    v_lshlrev_b32 v148, 16, v110
    v_and_b32 v149, 0xffff0000, v110
    v_fmac_f32 v136, v143, v148
    v_fmac_f32 v137, v143, v149
    v_lshlrev_b32 v150, 16, v111
    v_and_b32 v151, 0xffff0000, v111
    v_fmac_f32 v138, v143, v150
    v_fmac_f32 v139, v143, v151
    s_waitcnt vmcnt(30)
    v_lshlrev_b32 v148, 16, v112
    v_and_b32 v149, 0xffff0000, v112
    v_fmac_f32 v132, v144, v148
    v_fmac_f32 v133, v144, v149
    v_lshlrev_b32 v150, 16, v113
    v_and_b32 v151, 0xffff0000, v113
    v_fmac_f32 v134, v144, v150
    v_fmac_f32 v135, v144, v151
    v_lshlrev_b32 v148, 16, v114
    v_and_b32 v149, 0xffff0000, v114
    v_fmac_f32 v136, v144, v148
    v_fmac_f32 v137, v144, v149
    v_lshlrev_b32 v150, 16, v115
    v_and_b32 v151, 0xffff0000, v115
    v_fmac_f32 v138, v144, v150
    v_fmac_f32 v139, v144, v151
    s_waitcnt vmcnt(29)
    v_lshlrev_b32 v148, 16, v116
    v_and_b32 v149, 0xffff0000, v116
    v_fmac_f32 v132, v145, v148
    v_fmac_f32 v133, v145, v149
    v_lshlrev_b32 v150, 16, v117
    v_and_b32 v151, 0xffff0000, v117
    v_fmac_f32 v134, v145, v150
    v_fmac_f32 v135, v145, v151
    v_lshlrev_b32 v148, 16, v118
    v_and_b32 v149, 0xffff0000, v118
    v_fmac_f32 v136, v145, v148
    v_fmac_f32 v137, v145, v149
    v_lshlrev_b32 v150, 16, v119
    v_and_b32 v151, 0xffff0000, v119
    v_fmac_f32 v138, v145, v150
    v_fmac_f32 v139, v145, v151
    s_waitcnt vmcnt(28)
    v_lshlrev_b32 v148, 16, v120
    v_and_b32 v149, 0xffff0000, v120
    v_fmac_f32 v132, v146, v148
    v_fmac_f32 v133, v146, v149
    v_lshlrev_b32 v150, 16, v121
    v_and_b32 v151, 0xffff0000, v121
    v_fmac_f32 v134, v146, v150
    v_fmac_f32 v135, v146, v151
    v_lshlrev_b32 v148, 16, v122
    v_and_b32 v149, 0xffff0000, v122
    v_fmac_f32 v136, v146, v148
    v_fmac_f32 v137, v146, v149
    v_lshlrev_b32 v150, 16, v123
    v_and_b32 v151, 0xffff0000, v123
    v_fmac_f32 v138, v146, v150
    v_fmac_f32 v139, v146, v151
    s_waitcnt vmcnt(27)
    v_lshlrev_b32 v148, 16, v124
    v_and_b32 v149, 0xffff0000, v124
    v_fmac_f32 v132, v147, v148
    v_fmac_f32 v133, v147, v149
    v_lshlrev_b32 v150, 16, v125
    v_and_b32 v151, 0xffff0000, v125
    v_fmac_f32 v134, v147, v150
    v_fmac_f32 v135, v147, v151
    v_lshlrev_b32 v148, 16, v126
    v_and_b32 v149, 0xffff0000, v126
    v_fmac_f32 v136, v147, v148
    v_fmac_f32 v137, v147, v149
    v_lshlrev_b32 v150, 16, v127
    v_and_b32 v151, 0xffff0000, v127
    v_fmac_f32 v138, v147, v150
    v_fmac_f32 v139, v147, v151
    v_mov_b32 v140, v132
    v_mov_b32 v141, v133
    v_mov_b32 v142, v134
    v_mov_b32 v143, v135
    v_mov_b32 v144, v136
    v_mov_b32 v145, v137
    v_mov_b32 v146, v138
    v_mov_b32 v147, v139
    v_permlane16_swap_b32 v132, v140
    v_permlane16_swap_b32 v133, v141
    v_permlane16_swap_b32 v134, v142
    v_permlane16_swap_b32 v135, v143
    v_permlane16_swap_b32 v136, v144
    v_permlane16_swap_b32 v137, v145
    v_permlane16_swap_b32 v138, v146
    v_permlane16_swap_b32 v139, v147
    v_add_f32 v132, v132, v140
    v_add_f32 v133, v133, v141
    v_add_f32 v134, v134, v142
    v_add_f32 v135, v135, v143
    v_add_f32 v136, v136, v144
    v_add_f32 v137, v137, v145
    v_add_f32 v138, v138, v146
    v_add_f32 v139, v139, v147
    v_mov_b32 v140, v132
    v_mov_b32 v141, v133
    v_mov_b32 v142, v134
    v_mov_b32 v143, v135
    v_mov_b32 v144, v136
    v_mov_b32 v145, v137
    v_mov_b32 v146, v138
    v_mov_b32 v147, v139
    v_permlane32_swap_b32 v132, v140
    v_permlane32_swap_b32 v133, v141
    v_permlane32_swap_b32 v134, v142
    v_permlane32_swap_b32 v135, v143
    v_permlane32_swap_b32 v136, v144
    v_permlane32_swap_b32 v137, v145
    v_permlane32_swap_b32 v138, v146
    v_permlane32_swap_b32 v139, v147
    v_add_f32 v132, v132, v140
    v_add_f32 v133, v133, v141
    v_add_f32 v134, v134, v142
    v_add_f32 v135, v135, v143
    v_add_f32 v136, v136, v144
    v_add_f32 v137, v137, v145
    v_add_f32 v138, v138, v146
    v_add_f32 v139, v139, v147
    s_lshl_b32 s26, s19, 9
    s_add_u32 s26, s26, 147456
    v_lshl_add_u32 v24, v2, 5, s26
    s_mov_b64 exec, 0xffff
    ds_write_b128 v24, v[132:135]
    ds_write_b128 v24, v[136:139] offset:16
    s_mov_b64 exec, -1

    s_waitcnt vmcnt(19)
    s_waitcnt lgkmcnt(0)
    s_barrier
    s_and_b32 s33, s23, 3
    s_lshl_b32 s33, s33, 15
    s_add_u32 s33, s33, s27
    s_add_u32 s23, s23, 1

    s_ff1_i32_b32 s26, s34
    s_bitset0_b32 s34, s26
    s_bitset0_b32 s69, s26
    s_lshl_b32 s26, s26, 14
    s_add_u32 s26, s26, s28
    s_add_u32 s30, s26, 9437184
    s_mov_b32 m0, s33
    s_add_u32 s31, s26, 13629440
    buffer_load_dwordx4 v5, s[12:15], s30 offen  lds
    buffer_load_dwordx4 v5, s[12:15], s30 offen offset:1024  lds
    buffer_load_dwordx4 v5, s[12:15], s31 offen offset:2048  lds
    buffer_load_dwordx4 v5, s[12:15], s31 offen offset:3072  lds
    s_add_u32 m0, s33, 2048
    s_add_u32 s31, s31, 2048
    s_add_u32 s33, s33, 32768
    buffer_load_dwordx4 v5, s[12:15], s30 offen offset:2048  lds
    buffer_load_dwordx4 v5, s[12:15], s30 offen offset:3072  lds
    s_add_u32 m0, s33, -28672
    s_nop 0
    buffer_load_dwordx4 v5, s[12:15], s31 offen offset:2048  lds
    buffer_load_dwordx4 v5, s[12:15], s31 offen offset:3072  lds

    s_waitcnt vmcnt(24)
    s_add_u32 s26, s66, 393216
    buffer_store_dwordx4 v[172:175], v7, s[12:15], s26 offen offset:0 sc1
    s_add_u32 s26, s66, 524288
    buffer_store_dwordx4 v[176:179], v7, s[12:15], s26 offen offset:0 sc1
    s_add_u32 s26, s66, 655360
    buffer_store_dwordx4 v[180:183], v7, s[12:15], s26 offen offset:0 sc1
    buffer_load_dwordx4 v[196:199], v6, s[40:43], s65 offen offset:256
    buffer_load_dwordx4 v[200:203], v6, s[40:43], s65 offen offset:384
    buffer_load_dwordx4 v[204:207], v6, s[40:43], s65 offen offset:512
    buffer_load_dword v240, v9, s[48:51], s68 offen
    s_add_u32 s68, s68, 8192
    s_cmp_lg_u32 s19, 0
    s_cbranch_scc1 fa_nf
    v_lshlrev_b32 v24, 3, v2
    v_add_u32 v24, 147456, v24
    ds_read_b64 v[132:133], v24
    ds_read_b64 v[136:137], v24 offset:512
    ds_read_b64 v[138:139], v24 offset:1024
    ds_read_b64 v[140:141], v24 offset:1536
    s_lshl_b32 s26, s21, 13
    s_lshl_b32 s24, s20, 10
    s_add_u32 s26, s26, 75497472
    s_add_u32 s24, s24, s26
    v_mov_b32 v134, v14
    v_mov_b32 v135, v15
    s_waitcnt lgkmcnt(0)
    v_add_f32 v132, v132, v136
    v_add_f32 v133, v133, v137
    v_add_f32 v138, v138, v140
    v_add_f32 v139, v139, v141
    v_add_f32 v132, v132, v138
    v_add_f32 v133, v133, v139
    buffer_store_dwordx4 v[132:135], v5, s[12:15], s24 offen sc1
    fa_nf:

    s_waitcnt vmcnt(22)
    s_barrier
    s_and_b32 s33, s23, 3
    s_lshl_b32 s33, s33, 15
    s_add_u32 s33, s33, s27
    s_add_u32 s23, s23, 1

    s_ff1_i32_b32 s26, s34
    s_bitset0_b32 s34, s26
    s_bitset0_b32 s69, s26
    s_lshl_b32 s26, s26, 14
    s_add_u32 s26, s26, s28
    s_add_u32 s30, s26, 9437184
    s_mov_b32 m0, s33
    s_add_u32 s31, s26, 13629440
    buffer_load_dwordx4 v5, s[12:15], s30 offen  lds
    buffer_load_dwordx4 v5, s[12:15], s30 offen offset:1024  lds
    buffer_load_dwordx4 v5, s[12:15], s31 offen offset:2048  lds
    buffer_load_dwordx4 v5, s[12:15], s31 offen offset:3072  lds
    s_add_u32 m0, s33, 2048
    s_add_u32 s31, s31, 2048
    s_add_u32 s33, s33, 32768
    buffer_load_dwordx4 v5, s[12:15], s30 offen offset:2048  lds
    buffer_load_dwordx4 v5, s[12:15], s30 offen offset:3072  lds
    s_add_u32 m0, s33, -28672
    s_nop 0
    buffer_load_dwordx4 v5, s[12:15], s31 offen offset:2048  lds
    buffer_load_dwordx4 v5, s[12:15], s31 offen offset:3072  lds

    s_waitcnt vmcnt(24)
    s_add_u32 s26, s66, 786432
    buffer_store_dwordx4 v[184:187], v7, s[12:15], s26 offen offset:0 sc1
    s_add_u32 s26, s66, 0
    buffer_store_dwordx4 v[188:191], v7, s[12:15], s26 offen offset:256 sc1
    s_add_u32 s26, s66, 131072
    buffer_store_dwordx4 v[192:195], v7, s[12:15], s26 offen offset:256 sc1
    buffer_load_dwordx4 v[208:211], v6, s[40:43], s65 offen offset:640
    buffer_load_dwordx4 v[212:215], v6, s[40:43], s65 offen offset:768
    buffer_load_dword v240, v9, s[48:51], s68 offen
    s_add_u32 s68, s68, 8192
    s_waitcnt vmcnt(21)
    s_barrier
    s_waitcnt vmcnt(15)
    s_add_u32 s26, s66, 262144
    buffer_store_dwordx4 v[196:199], v7, s[12:15], s26 offen offset:256 sc1
    s_add_u32 s26, s66, 393216
    buffer_store_dwordx4 v[200:203], v7, s[12:15], s26 offen offset:256 sc1
    s_add_u32 s26, s66, 524288
    buffer_store_dwordx4 v[204:207], v7, s[12:15], s26 offen offset:256 sc1
    s_cmp_lg_u32 s19, 0
    s_cbranch_scc1 fa_ng
    v_lshrrev_b32 v24, 3, v2
    v_and_b32 v25, 7, v2
    v_lshlrev_b32 v26, 4, v25
    v_lshl_add_u32 v24, v24, 10, v26
    v_lshlrev_b32 v25, 2, v25
    s_lshl_b32 s29, s21, 13
    s_lshl_b32 s24, s20, 7
    s_add_u32 s29, s29, 75497472
    s_add_u32 s29, s29, s24
    buffer_load_dwordx4 v[140:143], v24, s[12:15], s29 offen sc1
    fa_ng:

    s_cmp_ge_u32 s18, 6
    s_cbranch_scc1 qkv_kernel_hx33
    s_mul_i32 s34, s2, 6144
    s_lshl_b32 s35, s18, 10
    s_add_u32 s34, s34, s35
    s_add_u32 s34, s34, 26214400
    v_mov_b32 v96, -1
    v_mov_b32 v97, -1
    v_mov_b32 v98, -1
    v_mov_b32 v99, -1
    buffer_store_dwordx4 v[96:99], v5, s[12:15], s34 offen sc1

qkv_kernel_hx33:
    s_cmp_ge_u32 s19, 6
    s_cbranch_scc1 qkv_kernel_hx34
    s_mul_i32 s34, s2, 6144
    s_lshl_b32 s35, s19, 10
    s_add_u32 s34, s34, s35
    s_add_u32 s34, s34, 26214400
    v_mov_b32 v96, -1
    v_mov_b32 v97, -1
    v_mov_b32 v98, -1
    v_mov_b32 v99, -1
    buffer_store_dwordx4 v[96:99], v5, s[12:15], s34 offen sc1

qkv_kernel_hx34:
    s_waitcnt vmcnt(9)
    s_barrier
    s_waitcnt vmcnt(4)
    s_add_u32 s26, s66, 655360
    buffer_store_dwordx4 v[208:211], v7, s[12:15], s26 offen offset:256 sc1
    s_add_u32 s26, s66, 786432
    buffer_store_dwordx4 v[212:215], v7, s[12:15], s26 offen offset:256 sc1
    s_cmp_lg_u32 s19, 0
    s_cbranch_scc1 fa_end
    s_lshl_b32 s26, s21, 8
    s_lshl_b32 s24, s20, 5
    s_add_u32 s26, s26, s24
    s_add_u32 s26, s26, 4096
    fa_gl:
    s_waitcnt vmcnt(0)
    v_xor_b32 v26, v142, v14
    v_xor_b32 v27, v143, v15
    v_or_b32 v26, v26, v27
    v_cmp_ne_u32 vcc, 0, v26
    s_sub_u32 s70, s70, 1
    s_cbranch_scc1 fa_gok
    s_cbranch_vccz fa_gok
    buffer_load_dwordx4 v[140:143], v24, s[12:15], s29 offen sc1
    s_branch fa_gl
    fa_gok:
    v_add_f32_dpp v132, v140, v140 row_ror:8 row_mask:0xf bank_mask:0xf
    v_add_f32_dpp v133, v141, v141 row_ror:8 row_mask:0xf bank_mask:0xf

    v_mov_b32 v140, v132
    v_mov_b32 v141, v133
    s_nop 0
    v_permlane16_swap_b32 v132, v140
    v_permlane16_swap_b32 v133, v141
    s_nop 0
    v_add_f32 v132, v132, v140
    v_add_f32 v133, v133, v141

    v_mov_b32 v140, v132
    v_mov_b32 v141, v133
    s_nop 0
    v_permlane32_swap_b32 v132, v140
    v_permlane32_swap_b32 v133, v141
    s_nop 0
    v_add_f32 v132, v132, v140
    v_add_f32 v133, v133, v141

    v_cvt_pk_bf16_f32 v132, v132, v133
    s_mov_b64 exec, 0xff
    buffer_store_dword v132, v25, s[12:15], s26 offen sc1
    s_mov_b64 exec, -1
    fa_end:

    s_waitcnt vmcnt(0)
    s_barrier
    s_cmp_lg_u32 s19, 0
    s_cbranch_scc1 fa_nsf
    s_lshl_b32 s26, s2, 3
    s_add_u32 s26, s26, 3440640
    v_mov_b32 v24, 0
    s_mov_b64 exec, 1
    buffer_store_dwordx2 v[14:15], v24, s[12:15], s26 offen sc1
    s_mov_b64 exec, -1
    fa_nsf:

    s_branch tail_entry
qkv_kernel_end:
    s_endpgm
.section .rodata,"a"
.p2align 6
.amdhsa_kernel qkv_kernel
  .amdhsa_next_free_vgpr 256
  .amdhsa_next_free_sgpr 102
  .amdhsa_accum_offset 256
  .amdhsa_group_segment_fixed_size 0
  .amdhsa_kernarg_size 104
  .amdhsa_user_sgpr_count 2
  .amdhsa_user_sgpr_kernarg_segment_ptr 1
  .amdhsa_system_sgpr_workgroup_id_x 1
  .amdhsa_float_denorm_mode_32 3
.end_amdhsa_kernel
```
